```python
import torch

def _softmax(x, axis=-1):
    return torch.softmax(x, dim=axis)

def _gelu(x):
    return torch.nn.functional.gelu(x, approximate='tanh')

def _silu(x):
    return torch.nn.functional.silu(x)

def _sigmoid(x):
    return torch.sigmoid(x)

def _layernorm(x, axis=-1, eps=1e-05):
    m = x.mean(dim=axis, keepdim=True)
    v = x.var(dim=axis, keepdim=True, unbiased=False)
    return (x - m) / torch.sqrt(v + eps)

def _scatter_add(tgt, idx, src, axis=0):
    return tgt.clone().index_add_(axis, idx, src)

def _segment_sum(src, seg, n):
    out = torch.zeros((n,) + src.shape[1:], dtype=src.dtype)
    return out.index_add_(0, seg, src)

def _pad(x, pw):
    flat = tuple((v for pair in reversed(pw) for v in pair))
    return torch.nn.functional.pad(x, flat)
kernel_name = 'adaLN_cond__linear_kernel_hedgehog__glu_gated_geglu__prompt'

def setup_inputs():

    _w = lambda a: (lambda t: t.to(torch.bfloat16) if t.is_floating_point() else t)(torch.as_tensor(a))

    def _A_setup():
        B, S, D, H = (1, 2048, 576, 32)
        Dh = D // H
        return {'x': _w((lambda *s: torch.randn(*s, dtype=torch.bfloat16) * 0.05)(B, S, D)), 'wqkv': _w((lambda *s: torch.randn(*s, dtype=torch.bfloat16) * 0.4)(D, 3 * D)), 'w_phi': _w((lambda *s: torch.randn(*s, dtype=torch.bfloat16) * 0.4)(H, Dh, Dh) * Dh ** (-0.5)), 'wo': _w((lambda *s: torch.randn(*s, dtype=torch.bfloat16) * 0.05)(D, D))}
    _A_in = _A_setup()

    def _B_setup():
        B, S, Dm, Df = (1, 2048, 576, 4608)
        return {'x': _w((lambda *s: torch.randn(*s, dtype=torch.bfloat16) * 0.05)(B, S, Dm)), 'w_gate': _w((lambda *s: torch.randn(*s, dtype=torch.bfloat16) * 1.6)(Dm, Df) * Dm ** (-0.5)), 'w_up': _w((lambda *s: torch.randn(*s, dtype=torch.bfloat16) * 1.6)(Dm, Df) * Dm ** (-0.5)), 'w_down': _w((lambda *s: torch.randn(*s, dtype=torch.bfloat16) * 1.6)(Df, Dm) * Df ** (-0.5))}
    _B_in = _B_setup()
    return {'A_x': _A_in['x'], 'A_wqkv': _A_in['wqkv'], 'A_w_phi': _A_in['w_phi'], 'A_wo': _A_in['wo'], 'B_x': _B_in['x'], 'B_w_gate': _B_in['w_gate'], 'B_w_up': _B_in['w_up'], 'B_w_down': _B_in['w_down'], 'c': _w((lambda *s: torch.randn(*s, dtype=torch.bfloat16) * 0.1)(1, 576) * 8.0), 'w_mod': _w((lambda *s: torch.randn(*s, dtype=torch.bfloat16) * 0.1)(576, 6 * 576) * 576 ** (-0.5) * 8.0)}

def reference(A_x, A_wqkv, A_w_phi, A_wo, B_x, B_w_gate, B_w_up, B_w_down, c, w_mod):

    def _A_ref(x, wqkv, w_phi, wo):
        B, S, D = x.shape
        H = 32
        Dh = D // H
        qkv = (lambda x, *d: x.permute(*d))((x @ wqkv).reshape(B, S, 3, H, Dh), 2, 0, 3, 1, 4)
        q, k, v = (qkv[0], qkv[1], qkv[2])
        pq = torch.einsum('bhsd,hdf->bhsf', q, w_phi)
        pk = torch.einsum('bhsd,hdf->bhsf', k, w_phi)
        phi_q = torch.concatenate([_softmax(pq, axis=-1), _softmax(-pq, axis=-1)], axis=-1)
        phi_k = torch.concatenate([_softmax(pk, axis=-1), _softmax(-pk, axis=-1)], axis=-1)
        kv = torch.einsum('bhsf,bhsd->bhfd', phi_k, v)
        z = torch.einsum('bhsf->bhf', phi_k)
        num = torch.einsum('bhqf,bhfd->bhqd', phi_q, kv)
        den = torch.einsum('bhqf,bhf->bhq', phi_q, z)[..., None] + 1e-06
        o = num / den
        return (lambda x, *d: x.permute(*d))(o, 0, 2, 1, 3).reshape(B, S, D) @ wo

    def _B_ref(x, w_gate, w_up, w_down):
        g = torch.einsum('bsd,df->bsf', x, w_gate)
        u = torch.einsum('bsd,df->bsf', x, w_up)
        h = _gelu(g) * u
        return torch.einsum('bsf,fd->bsd', h, w_down)
    x = A_x
    mod = (_silu(c) @ w_mod).reshape(c.shape[0], 6, 1, -1)
    sa, ca, ga, sb, cb, gb = (mod[:, 0].clone(), mod[:, 1].clone(), mod[:, 2].clone(), mod[:, 3].clone(), mod[:, 4].clone(), mod[:, 5].clone())
    h = _layernorm(x, axis=-1) * (1 + ca) + sa
    x = x + ga * _A_ref(h, A_wqkv, A_w_phi, A_wo)
    h = _layernorm(x, axis=-1) * (1 + cb) + sb
    x = x + gb * _B_ref(h, B_w_gate, B_w_up, B_w_down)
    return x
```

```asm
; @launch kernel=k0_kernel grid=(265,1,1) block=(256,1,1) lds=8192
; @launch kernel=k1_kernel grid=(256,1,1) block=(256,1,1) lds=154112
; @launch kernel=k2_kernel grid=(256,1,1) block=(256,1,1) lds=163840
; @launch kernel=k3_kernel grid=(256,1,1) block=(512,1,1) lds=149504
; @launch kernel=k4_kernel grid=(256,1,1) block=(512,1,1) lds=151552
; @launch kernel=k5_kernel grid=(1152,1,1) block=(256,1,1) lds=0
.amdgcn_target "amdgcn-amd-amdhsa--gfx950"
.text
.globl k0_kernel
.p2align 8
.type k0_kernel,@function
k0_kernel:
    s_cmp_ge_u32 s2, 265
    s_cbranch_scc1 K0_END
    s_cmp_ge_u32 s2, 172
    s_cbranch_scc1 K0_COPY
    s_load_dwordx2 s[4:5], s[0:1], 96
    s_load_dwordx2 s[6:7], s[0:1], 64
    s_load_dwordx2 s[8:9], s[0:1], 72
    s_load_dwordx2 s[10:11], s[0:1], 0
    s_waitcnt lgkmcnt(0)
    s_cmp_ge_u32 s2, 108
    s_cbranch_scc1 K0_LN
    s_mov_b32 s12, s6
    s_and_b32 s13, s7, 0xffff
    s_mov_b32 s14, 1152
    s_mov_b32 s15, 0x00020000
    s_mov_b32 s16, s8
    s_and_b32 s17, s9, 0xffff
    s_mov_b32 s18, 3981312
    s_mov_b32 s19, 0x00020000
    s_add_u32 s20, s4, 0
    s_addc_u32 s21, s5, 0
    s_and_b32 s21, s21, 0xffff
    s_mov_b32 s22, 13824
    s_mov_b32 s23, 0x00020000
    v_and_b32 v1, 15, v0
    v_lshrrev_b32 v2, 4, v0
    v_mul_u32_u24 v3, 6912, v2
    v_lshl_add_u32 v3, v1, 2, v3
    s_lshl_b32 s24, s2, 6
    v_add_u32 v3, s24, v3
    s_mov_b32 s25, 0
    buffer_load_dword v10, v3, s[16:19], s25 offen
    s_add_u32 s25, s25, 110592
    buffer_load_dword v11, v3, s[16:19], s25 offen
    s_add_u32 s25, s25, 110592
    buffer_load_dword v12, v3, s[16:19], s25 offen
    s_add_u32 s25, s25, 110592
    buffer_load_dword v13, v3, s[16:19], s25 offen
    s_add_u32 s25, s25, 110592
    buffer_load_dword v14, v3, s[16:19], s25 offen
    s_add_u32 s25, s25, 110592
    buffer_load_dword v15, v3, s[16:19], s25 offen
    s_add_u32 s25, s25, 110592
    buffer_load_dword v16, v3, s[16:19], s25 offen
    s_add_u32 s25, s25, 110592
    buffer_load_dword v17, v3, s[16:19], s25 offen
    s_add_u32 s25, s25, 110592
    buffer_load_dword v18, v3, s[16:19], s25 offen
    s_add_u32 s25, s25, 110592
    buffer_load_dword v19, v3, s[16:19], s25 offen
    s_add_u32 s25, s25, 110592
    buffer_load_dword v20, v3, s[16:19], s25 offen
    s_add_u32 s25, s25, 110592
    buffer_load_dword v21, v3, s[16:19], s25 offen
    s_add_u32 s25, s25, 110592
    buffer_load_dword v22, v3, s[16:19], s25 offen
    s_add_u32 s25, s25, 110592
    buffer_load_dword v23, v3, s[16:19], s25 offen
    s_add_u32 s25, s25, 110592
    buffer_load_dword v24, v3, s[16:19], s25 offen
    s_add_u32 s25, s25, 110592
    buffer_load_dword v25, v3, s[16:19], s25 offen
    s_add_u32 s25, s25, 110592
    buffer_load_dword v26, v3, s[16:19], s25 offen
    s_add_u32 s25, s25, 110592
    buffer_load_dword v27, v3, s[16:19], s25 offen
    s_add_u32 s25, s25, 110592
    buffer_load_dword v28, v3, s[16:19], s25 offen
    s_add_u32 s25, s25, 110592
    buffer_load_dword v29, v3, s[16:19], s25 offen
    s_add_u32 s25, s25, 110592
    buffer_load_dword v30, v3, s[16:19], s25 offen
    s_add_u32 s25, s25, 110592
    buffer_load_dword v31, v3, s[16:19], s25 offen
    s_add_u32 s25, s25, 110592
    buffer_load_dword v32, v3, s[16:19], s25 offen
    s_add_u32 s25, s25, 110592
    buffer_load_dword v33, v3, s[16:19], s25 offen
    s_add_u32 s25, s25, 110592
    buffer_load_dword v34, v3, s[16:19], s25 offen
    s_add_u32 s25, s25, 110592
    buffer_load_dword v35, v3, s[16:19], s25 offen
    s_add_u32 s25, s25, 110592
    buffer_load_dword v36, v3, s[16:19], s25 offen
    s_add_u32 s25, s25, 110592
    buffer_load_dword v37, v3, s[16:19], s25 offen
    s_add_u32 s25, s25, 110592
    buffer_load_dword v38, v3, s[16:19], s25 offen
    s_add_u32 s25, s25, 110592
    buffer_load_dword v39, v3, s[16:19], s25 offen
    s_add_u32 s25, s25, 110592
    buffer_load_dword v40, v3, s[16:19], s25 offen
    s_add_u32 s25, s25, 110592
    buffer_load_dword v41, v3, s[16:19], s25 offen
    s_add_u32 s25, s25, 110592
    buffer_load_dword v42, v3, s[16:19], s25 offen
    s_add_u32 s25, s25, 110592
    buffer_load_dword v43, v3, s[16:19], s25 offen
    s_add_u32 s25, s25, 110592
    buffer_load_dword v44, v3, s[16:19], s25 offen
    s_add_u32 s25, s25, 110592
    buffer_load_dword v45, v3, s[16:19], s25 offen
    s_add_u32 s25, s25, 110592
    v_lshlrev_b32 v4, 1, v0
    buffer_load_ushort v50, v4, s[12:15], 0 offen
    buffer_load_ushort v51, v4, s[12:15], 0 offen offset:512
    buffer_load_ushort v52, v4, s[12:15], 0 offen offset:1024
    s_waitcnt vmcnt(0)
    s_mov_b32 s26, 1069066811
    v_lshlrev_b32 v50, 16, v50
    v_mul_f32 v53, s26, v50
    v_sub_f32 v53, 0, v53
    v_exp_f32 v53, v53
    s_nop 0
    v_add_f32 v53, 1.0, v53
    v_rcp_f32 v53, v53
    s_nop 0
    v_mul_f32 v50, v50, v53
    v_cvt_pk_bf16_f32 v50, v50, v50
    v_and_b32 v50, 0xffff0000, v50
    v_lshlrev_b32 v51, 16, v51
    v_mul_f32 v53, s26, v51
    v_sub_f32 v53, 0, v53
    v_exp_f32 v53, v53
    s_nop 0
    v_add_f32 v53, 1.0, v53
    v_rcp_f32 v53, v53
    s_nop 0
    v_mul_f32 v51, v51, v53
    v_cvt_pk_bf16_f32 v51, v51, v51
    v_and_b32 v51, 0xffff0000, v51
    v_lshlrev_b32 v52, 16, v52
    v_mul_f32 v53, s26, v52
    v_sub_f32 v53, 0, v53
    v_exp_f32 v53, v53
    s_nop 0
    v_add_f32 v53, 1.0, v53
    v_rcp_f32 v53, v53
    s_nop 0
    v_mul_f32 v52, v52, v53
    v_cvt_pk_bf16_f32 v52, v52, v52
    v_and_b32 v52, 0xffff0000, v52
    v_lshlrev_b32 v4, 2, v0
    ds_write_b32 v4, v50
    ds_write_b32 v4, v51 offset:1024
    ds_write_b32 v4, v52 offset:2048
    s_waitcnt lgkmcnt(0)
    s_barrier
    v_lshlrev_b32 v4, 2, v2
    ds_read_b32 v60, v4 offset:0
    ds_read_b32 v61, v4 offset:64
    ds_read_b32 v62, v4 offset:128
    ds_read_b32 v63, v4 offset:192
    ds_read_b32 v64, v4 offset:256
    ds_read_b32 v65, v4 offset:320
    ds_read_b32 v66, v4 offset:384
    ds_read_b32 v67, v4 offset:448
    ds_read_b32 v68, v4 offset:512
    ds_read_b32 v69, v4 offset:576
    ds_read_b32 v70, v4 offset:640
    ds_read_b32 v71, v4 offset:704
    ds_read_b32 v72, v4 offset:768
    ds_read_b32 v73, v4 offset:832
    ds_read_b32 v74, v4 offset:896
    ds_read_b32 v75, v4 offset:960
    ds_read_b32 v76, v4 offset:1024
    ds_read_b32 v77, v4 offset:1088
    ds_read_b32 v78, v4 offset:1152
    ds_read_b32 v79, v4 offset:1216
    ds_read_b32 v80, v4 offset:1280
    ds_read_b32 v81, v4 offset:1344
    ds_read_b32 v82, v4 offset:1408
    ds_read_b32 v83, v4 offset:1472
    ds_read_b32 v84, v4 offset:1536
    ds_read_b32 v85, v4 offset:1600
    ds_read_b32 v86, v4 offset:1664
    ds_read_b32 v87, v4 offset:1728
    ds_read_b32 v88, v4 offset:1792
    ds_read_b32 v89, v4 offset:1856
    ds_read_b32 v90, v4 offset:1920
    ds_read_b32 v91, v4 offset:1984
    ds_read_b32 v92, v4 offset:2048
    ds_read_b32 v93, v4 offset:2112
    ds_read_b32 v94, v4 offset:2176
    ds_read_b32 v95, v4 offset:2240
    v_mov_b32 v98, 0
    v_mov_b32 v99, 0
    s_waitcnt lgkmcnt(0)
    v_lshlrev_b32 v7, 16, v10
    v_and_b32 v8, 0xffff0000, v10
    v_fmac_f32 v98, v7, v60
    v_fmac_f32 v99, v8, v60
    v_lshlrev_b32 v7, 16, v11
    v_and_b32 v8, 0xffff0000, v11
    v_fmac_f32 v98, v7, v61
    v_fmac_f32 v99, v8, v61
    v_lshlrev_b32 v7, 16, v12
    v_and_b32 v8, 0xffff0000, v12
    v_fmac_f32 v98, v7, v62
    v_fmac_f32 v99, v8, v62
    v_lshlrev_b32 v7, 16, v13
    v_and_b32 v8, 0xffff0000, v13
    v_fmac_f32 v98, v7, v63
    v_fmac_f32 v99, v8, v63
    v_lshlrev_b32 v7, 16, v14
    v_and_b32 v8, 0xffff0000, v14
    v_fmac_f32 v98, v7, v64
    v_fmac_f32 v99, v8, v64
    v_lshlrev_b32 v7, 16, v15
    v_and_b32 v8, 0xffff0000, v15
    v_fmac_f32 v98, v7, v65
    v_fmac_f32 v99, v8, v65
    v_lshlrev_b32 v7, 16, v16
    v_and_b32 v8, 0xffff0000, v16
    v_fmac_f32 v98, v7, v66
    v_fmac_f32 v99, v8, v66
    v_lshlrev_b32 v7, 16, v17
    v_and_b32 v8, 0xffff0000, v17
    v_fmac_f32 v98, v7, v67
    v_fmac_f32 v99, v8, v67
    v_lshlrev_b32 v7, 16, v18
    v_and_b32 v8, 0xffff0000, v18
    v_fmac_f32 v98, v7, v68
    v_fmac_f32 v99, v8, v68
    v_lshlrev_b32 v7, 16, v19
    v_and_b32 v8, 0xffff0000, v19
    v_fmac_f32 v98, v7, v69
    v_fmac_f32 v99, v8, v69
    v_lshlrev_b32 v7, 16, v20
    v_and_b32 v8, 0xffff0000, v20
    v_fmac_f32 v98, v7, v70
    v_fmac_f32 v99, v8, v70
    v_lshlrev_b32 v7, 16, v21
    v_and_b32 v8, 0xffff0000, v21
    v_fmac_f32 v98, v7, v71
    v_fmac_f32 v99, v8, v71
    v_lshlrev_b32 v7, 16, v22
    v_and_b32 v8, 0xffff0000, v22
    v_fmac_f32 v98, v7, v72
    v_fmac_f32 v99, v8, v72
    v_lshlrev_b32 v7, 16, v23
    v_and_b32 v8, 0xffff0000, v23
    v_fmac_f32 v98, v7, v73
    v_fmac_f32 v99, v8, v73
    v_lshlrev_b32 v7, 16, v24
    v_and_b32 v8, 0xffff0000, v24
    v_fmac_f32 v98, v7, v74
    v_fmac_f32 v99, v8, v74
    v_lshlrev_b32 v7, 16, v25
    v_and_b32 v8, 0xffff0000, v25
    v_fmac_f32 v98, v7, v75
    v_fmac_f32 v99, v8, v75
    v_lshlrev_b32 v7, 16, v26
    v_and_b32 v8, 0xffff0000, v26
    v_fmac_f32 v98, v7, v76
    v_fmac_f32 v99, v8, v76
    v_lshlrev_b32 v7, 16, v27
    v_and_b32 v8, 0xffff0000, v27
    v_fmac_f32 v98, v7, v77
    v_fmac_f32 v99, v8, v77
    v_lshlrev_b32 v7, 16, v28
    v_and_b32 v8, 0xffff0000, v28
    v_fmac_f32 v98, v7, v78
    v_fmac_f32 v99, v8, v78
    v_lshlrev_b32 v7, 16, v29
    v_and_b32 v8, 0xffff0000, v29
    v_fmac_f32 v98, v7, v79
    v_fmac_f32 v99, v8, v79
    v_lshlrev_b32 v7, 16, v30
    v_and_b32 v8, 0xffff0000, v30
    v_fmac_f32 v98, v7, v80
    v_fmac_f32 v99, v8, v80
    v_lshlrev_b32 v7, 16, v31
    v_and_b32 v8, 0xffff0000, v31
    v_fmac_f32 v98, v7, v81
    v_fmac_f32 v99, v8, v81
    v_lshlrev_b32 v7, 16, v32
    v_and_b32 v8, 0xffff0000, v32
    v_fmac_f32 v98, v7, v82
    v_fmac_f32 v99, v8, v82
    v_lshlrev_b32 v7, 16, v33
    v_and_b32 v8, 0xffff0000, v33
    v_fmac_f32 v98, v7, v83
    v_fmac_f32 v99, v8, v83
    v_lshlrev_b32 v7, 16, v34
    v_and_b32 v8, 0xffff0000, v34
    v_fmac_f32 v98, v7, v84
    v_fmac_f32 v99, v8, v84
    v_lshlrev_b32 v7, 16, v35
    v_and_b32 v8, 0xffff0000, v35
    v_fmac_f32 v98, v7, v85
    v_fmac_f32 v99, v8, v85
    v_lshlrev_b32 v7, 16, v36
    v_and_b32 v8, 0xffff0000, v36
    v_fmac_f32 v98, v7, v86
    v_fmac_f32 v99, v8, v86
    v_lshlrev_b32 v7, 16, v37
    v_and_b32 v8, 0xffff0000, v37
    v_fmac_f32 v98, v7, v87
    v_fmac_f32 v99, v8, v87
    v_lshlrev_b32 v7, 16, v38
    v_and_b32 v8, 0xffff0000, v38
    v_fmac_f32 v98, v7, v88
    v_fmac_f32 v99, v8, v88
    v_lshlrev_b32 v7, 16, v39
    v_and_b32 v8, 0xffff0000, v39
    v_fmac_f32 v98, v7, v89
    v_fmac_f32 v99, v8, v89
    v_lshlrev_b32 v7, 16, v40
    v_and_b32 v8, 0xffff0000, v40
    v_fmac_f32 v98, v7, v90
    v_fmac_f32 v99, v8, v90
    v_lshlrev_b32 v7, 16, v41
    v_and_b32 v8, 0xffff0000, v41
    v_fmac_f32 v98, v7, v91
    v_fmac_f32 v99, v8, v91
    v_lshlrev_b32 v7, 16, v42
    v_and_b32 v8, 0xffff0000, v42
    v_fmac_f32 v98, v7, v92
    v_fmac_f32 v99, v8, v92
    v_lshlrev_b32 v7, 16, v43
    v_and_b32 v8, 0xffff0000, v43
    v_fmac_f32 v98, v7, v93
    v_fmac_f32 v99, v8, v93
    v_lshlrev_b32 v7, 16, v44
    v_and_b32 v8, 0xffff0000, v44
    v_fmac_f32 v98, v7, v94
    v_fmac_f32 v99, v8, v94
    v_lshlrev_b32 v7, 16, v45
    v_and_b32 v8, 0xffff0000, v45
    v_fmac_f32 v98, v7, v95
    v_fmac_f32 v99, v8, v95
    v_lshlrev_b32 v4, 7, v2
    v_lshl_add_u32 v4, v1, 3, v4
    ds_write_b64 v4, v[98:99] offset:4096
    s_waitcnt lgkmcnt(0)
    s_barrier
    v_cmp_gt_u32 vcc, 32, v0
    s_and_saveexec_b64 s[28:29], vcc
    s_cbranch_execz K0_END
    v_lshlrev_b32 v4, 2, v0
    ds_read_b32 v10, v4 offset:4096
    ds_read_b32 v11, v4 offset:4224
    ds_read_b32 v12, v4 offset:4352
    ds_read_b32 v13, v4 offset:4480
    ds_read_b32 v14, v4 offset:4608
    ds_read_b32 v15, v4 offset:4736
    ds_read_b32 v16, v4 offset:4864
    ds_read_b32 v17, v4 offset:4992
    ds_read_b32 v18, v4 offset:5120
    ds_read_b32 v19, v4 offset:5248
    ds_read_b32 v20, v4 offset:5376
    ds_read_b32 v21, v4 offset:5504
    ds_read_b32 v22, v4 offset:5632
    ds_read_b32 v23, v4 offset:5760
    ds_read_b32 v24, v4 offset:5888
    ds_read_b32 v25, v4 offset:6016
    s_waitcnt lgkmcnt(0)
    v_add_f32 v10, v10, v11
    v_add_f32 v10, v10, v12
    v_add_f32 v10, v10, v13
    v_add_f32 v10, v10, v14
    v_add_f32 v10, v10, v15
    v_add_f32 v10, v10, v16
    v_add_f32 v10, v10, v17
    v_add_f32 v10, v10, v18
    v_add_f32 v10, v10, v19
    v_add_f32 v10, v10, v20
    v_add_f32 v10, v10, v21
    v_add_f32 v10, v10, v22
    v_add_f32 v10, v10, v23
    v_add_f32 v10, v10, v24
    v_add_f32 v10, v10, v25
    v_cvt_pk_bf16_f32 v10, v10, v10
    v_and_b32 v10, 0xffff0000, v10
    s_mov_b32 s27, 0
    s_cmp_ge_u32 s2, 18
    s_cselect_b32 s27, 1, 0
    s_cmp_ge_u32 s2, 36
    s_cselect_b32 s27, 0, s27
    s_cmp_ge_u32 s2, 72
    s_cselect_b32 s27, 1, s27
    s_cmp_ge_u32 s2, 90
    s_cselect_b32 s27, 0, s27
    s_cmp_eq_u32 s27, 0
    s_cbranch_scc1 K0_MODST
    v_add_f32 v10, 1.0, v10
    v_cvt_pk_bf16_f32 v10, v10, v10
    v_and_b32 v10, 0xffff0000, v10
K0_MODST:
    s_lshl_b32 s24, s2, 7
    v_add_u32 v4, s24, v4
    buffer_store_dword v10, v4, s[20:23], 0 offen
    s_endpgm
K0_LN:
    s_sub_u32 s3, s2, 108
    s_mov_b32 s12, s10
    s_and_b32 s13, s11, 0xffff
    s_mov_b32 s14, 2359296
    s_mov_b32 s15, 0x00020000
    s_add_u32 s16, s4, 131072
    s_addc_u32 s17, s5, 0
    s_and_b32 s17, s17, 0xffff
    s_mov_b32 s18, 2359296
    s_mov_b32 s19, 0x00020000
    s_add_u32 s20, s4, 16384
    s_addc_u32 s21, s5, 0
    s_and_b32 s21, s21, 0xffff
    s_mov_b32 s22, 102400
    s_mov_b32 s23, 0x00020000
    s_lshl_b32 s24, s3, 12
    v_lshl_add_u32 v1, v0, 4, s24
    v_mov_b32 v4, 0
    v_mov_b32 v5, 0
    v_mov_b32 v6, 0
    v_mov_b32 v7, 0
    buffer_store_dwordx4 v[4:7], v1, s[20:23], 0 offen
    v_lshrrev_b32 v1, 3, v0
    s_lshl_b32 s24, s3, 5
    v_add_u32 v1, s24, v1
    v_mul_u32_u24 v1, 1152, v1
    v_and_b32 v2, 7, v0
    v_lshl_add_u32 v1, v2, 4, v1
    buffer_load_dwordx4 v[12:15], v1, s[12:15], 0 offen offset:0
    buffer_load_dwordx4 v[16:19], v1, s[12:15], 0 offen offset:128
    buffer_load_dwordx4 v[20:23], v1, s[12:15], 0 offen offset:256
    buffer_load_dwordx4 v[24:27], v1, s[12:15], 0 offen offset:384
    buffer_load_dwordx4 v[28:31], v1, s[12:15], 0 offen offset:512
    buffer_load_dwordx4 v[32:35], v1, s[12:15], 0 offen offset:640
    buffer_load_dwordx4 v[36:39], v1, s[12:15], 0 offen offset:768
    buffer_load_dwordx4 v[40:43], v1, s[12:15], 0 offen offset:896
    buffer_load_dwordx4 v[44:47], v1, s[12:15], 0 offen offset:1024
    s_waitcnt vmcnt(0)
    v_lshlrev_b32 v48, 16, v12
    v_and_b32 v49, 0xffff0000, v12
    v_lshlrev_b32 v50, 16, v13
    v_and_b32 v51, 0xffff0000, v13
    v_lshlrev_b32 v52, 16, v14
    v_and_b32 v53, 0xffff0000, v14
    v_lshlrev_b32 v54, 16, v15
    v_and_b32 v55, 0xffff0000, v15
    v_lshlrev_b32 v56, 16, v16
    v_and_b32 v57, 0xffff0000, v16
    v_lshlrev_b32 v58, 16, v17
    v_and_b32 v59, 0xffff0000, v17
    v_lshlrev_b32 v60, 16, v18
    v_and_b32 v61, 0xffff0000, v18
    v_lshlrev_b32 v62, 16, v19
    v_and_b32 v63, 0xffff0000, v19
    v_lshlrev_b32 v64, 16, v20
    v_and_b32 v65, 0xffff0000, v20
    v_lshlrev_b32 v66, 16, v21
    v_and_b32 v67, 0xffff0000, v21
    v_lshlrev_b32 v68, 16, v22
    v_and_b32 v69, 0xffff0000, v22
    v_lshlrev_b32 v70, 16, v23
    v_and_b32 v71, 0xffff0000, v23
    v_lshlrev_b32 v72, 16, v24
    v_and_b32 v73, 0xffff0000, v24
    v_lshlrev_b32 v74, 16, v25
    v_and_b32 v75, 0xffff0000, v25
    v_lshlrev_b32 v76, 16, v26
    v_and_b32 v77, 0xffff0000, v26
    v_lshlrev_b32 v78, 16, v27
    v_and_b32 v79, 0xffff0000, v27
    v_lshlrev_b32 v80, 16, v28
    v_and_b32 v81, 0xffff0000, v28
    v_lshlrev_b32 v82, 16, v29
    v_and_b32 v83, 0xffff0000, v29
    v_lshlrev_b32 v84, 16, v30
    v_and_b32 v85, 0xffff0000, v30
    v_lshlrev_b32 v86, 16, v31
    v_and_b32 v87, 0xffff0000, v31
    v_lshlrev_b32 v88, 16, v32
    v_and_b32 v89, 0xffff0000, v32
    v_lshlrev_b32 v90, 16, v33
    v_and_b32 v91, 0xffff0000, v33
    v_lshlrev_b32 v92, 16, v34
    v_and_b32 v93, 0xffff0000, v34
    v_lshlrev_b32 v94, 16, v35
    v_and_b32 v95, 0xffff0000, v35
    v_lshlrev_b32 v96, 16, v36
    v_and_b32 v97, 0xffff0000, v36
    v_lshlrev_b32 v98, 16, v37
    v_and_b32 v99, 0xffff0000, v37
    v_lshlrev_b32 v100, 16, v38
    v_and_b32 v101, 0xffff0000, v38
    v_lshlrev_b32 v102, 16, v39
    v_and_b32 v103, 0xffff0000, v39
    v_lshlrev_b32 v104, 16, v40
    v_and_b32 v105, 0xffff0000, v40
    v_lshlrev_b32 v106, 16, v41
    v_and_b32 v107, 0xffff0000, v41
    v_lshlrev_b32 v108, 16, v42
    v_and_b32 v109, 0xffff0000, v42
    v_lshlrev_b32 v110, 16, v43
    v_and_b32 v111, 0xffff0000, v43
    v_lshlrev_b32 v112, 16, v44
    v_and_b32 v113, 0xffff0000, v44
    v_lshlrev_b32 v114, 16, v45
    v_and_b32 v115, 0xffff0000, v45
    v_lshlrev_b32 v116, 16, v46
    v_and_b32 v117, 0xffff0000, v46
    v_lshlrev_b32 v118, 16, v47
    v_and_b32 v119, 0xffff0000, v47
    v_mov_b32 v3, 0
    v_mov_b32 v4, 0
    v_add_f32 v3, v3, v48
    v_add_f32 v4, v4, v49
    v_add_f32 v3, v3, v50
    v_add_f32 v4, v4, v51
    v_add_f32 v3, v3, v52
    v_add_f32 v4, v4, v53
    v_add_f32 v3, v3, v54
    v_add_f32 v4, v4, v55
    v_add_f32 v3, v3, v56
    v_add_f32 v4, v4, v57
    v_add_f32 v3, v3, v58
    v_add_f32 v4, v4, v59
    v_add_f32 v3, v3, v60
    v_add_f32 v4, v4, v61
    v_add_f32 v3, v3, v62
    v_add_f32 v4, v4, v63
    v_add_f32 v3, v3, v64
    v_add_f32 v4, v4, v65
    v_add_f32 v3, v3, v66
    v_add_f32 v4, v4, v67
    v_add_f32 v3, v3, v68
    v_add_f32 v4, v4, v69
    v_add_f32 v3, v3, v70
    v_add_f32 v4, v4, v71
    v_add_f32 v3, v3, v72
    v_add_f32 v4, v4, v73
    v_add_f32 v3, v3, v74
    v_add_f32 v4, v4, v75
    v_add_f32 v3, v3, v76
    v_add_f32 v4, v4, v77
    v_add_f32 v3, v3, v78
    v_add_f32 v4, v4, v79
    v_add_f32 v3, v3, v80
    v_add_f32 v4, v4, v81
    v_add_f32 v3, v3, v82
    v_add_f32 v4, v4, v83
    v_add_f32 v3, v3, v84
    v_add_f32 v4, v4, v85
    v_add_f32 v3, v3, v86
    v_add_f32 v4, v4, v87
    v_add_f32 v3, v3, v88
    v_add_f32 v4, v4, v89
    v_add_f32 v3, v3, v90
    v_add_f32 v4, v4, v91
    v_add_f32 v3, v3, v92
    v_add_f32 v4, v4, v93
    v_add_f32 v3, v3, v94
    v_add_f32 v4, v4, v95
    v_add_f32 v3, v3, v96
    v_add_f32 v4, v4, v97
    v_add_f32 v3, v3, v98
    v_add_f32 v4, v4, v99
    v_add_f32 v3, v3, v100
    v_add_f32 v4, v4, v101
    v_add_f32 v3, v3, v102
    v_add_f32 v4, v4, v103
    v_add_f32 v3, v3, v104
    v_add_f32 v4, v4, v105
    v_add_f32 v3, v3, v106
    v_add_f32 v4, v4, v107
    v_add_f32 v3, v3, v108
    v_add_f32 v4, v4, v109
    v_add_f32 v3, v3, v110
    v_add_f32 v4, v4, v111
    v_add_f32 v3, v3, v112
    v_add_f32 v4, v4, v113
    v_add_f32 v3, v3, v114
    v_add_f32 v4, v4, v115
    v_add_f32 v3, v3, v116
    v_add_f32 v4, v4, v117
    v_add_f32 v3, v3, v118
    v_add_f32 v4, v4, v119
    v_add_f32 v3, v3, v4
    ds_swizzle_b32 v5, v3 offset:1055
    s_waitcnt lgkmcnt(0)
    v_add_f32 v3, v3, v5
    ds_swizzle_b32 v5, v3 offset:2079
    s_waitcnt lgkmcnt(0)
    v_add_f32 v3, v3, v5
    ds_swizzle_b32 v5, v3 offset:4127
    s_waitcnt lgkmcnt(0)
    v_add_f32 v3, v3, v5
    s_mov_b32 s25, 0x3ae38e39
    v_mul_f32 v3, s25, v3
    v_mov_b32 v4, 0
    v_mov_b32 v6, 0
    v_sub_f32 v7, v48, v3
    v_sub_f32 v8, v49, v3
    v_fmac_f32 v4, v7, v7
    v_fmac_f32 v6, v8, v8
    v_sub_f32 v7, v50, v3
    v_sub_f32 v8, v51, v3
    v_fmac_f32 v4, v7, v7
    v_fmac_f32 v6, v8, v8
    v_sub_f32 v7, v52, v3
    v_sub_f32 v8, v53, v3
    v_fmac_f32 v4, v7, v7
    v_fmac_f32 v6, v8, v8
    v_sub_f32 v7, v54, v3
    v_sub_f32 v8, v55, v3
    v_fmac_f32 v4, v7, v7
    v_fmac_f32 v6, v8, v8
    v_sub_f32 v7, v56, v3
    v_sub_f32 v8, v57, v3
    v_fmac_f32 v4, v7, v7
    v_fmac_f32 v6, v8, v8
    v_sub_f32 v7, v58, v3
    v_sub_f32 v8, v59, v3
    v_fmac_f32 v4, v7, v7
    v_fmac_f32 v6, v8, v8
    v_sub_f32 v7, v60, v3
    v_sub_f32 v8, v61, v3
    v_fmac_f32 v4, v7, v7
    v_fmac_f32 v6, v8, v8
    v_sub_f32 v7, v62, v3
    v_sub_f32 v8, v63, v3
    v_fmac_f32 v4, v7, v7
    v_fmac_f32 v6, v8, v8
    v_sub_f32 v7, v64, v3
    v_sub_f32 v8, v65, v3
    v_fmac_f32 v4, v7, v7
    v_fmac_f32 v6, v8, v8
    v_sub_f32 v7, v66, v3
    v_sub_f32 v8, v67, v3
    v_fmac_f32 v4, v7, v7
    v_fmac_f32 v6, v8, v8
    v_sub_f32 v7, v68, v3
    v_sub_f32 v8, v69, v3
    v_fmac_f32 v4, v7, v7
    v_fmac_f32 v6, v8, v8
    v_sub_f32 v7, v70, v3
    v_sub_f32 v8, v71, v3
    v_fmac_f32 v4, v7, v7
    v_fmac_f32 v6, v8, v8
    v_sub_f32 v7, v72, v3
    v_sub_f32 v8, v73, v3
    v_fmac_f32 v4, v7, v7
    v_fmac_f32 v6, v8, v8
    v_sub_f32 v7, v74, v3
    v_sub_f32 v8, v75, v3
    v_fmac_f32 v4, v7, v7
    v_fmac_f32 v6, v8, v8
    v_sub_f32 v7, v76, v3
    v_sub_f32 v8, v77, v3
    v_fmac_f32 v4, v7, v7
    v_fmac_f32 v6, v8, v8
    v_sub_f32 v7, v78, v3
    v_sub_f32 v8, v79, v3
    v_fmac_f32 v4, v7, v7
    v_fmac_f32 v6, v8, v8
    v_sub_f32 v7, v80, v3
    v_sub_f32 v8, v81, v3
    v_fmac_f32 v4, v7, v7
    v_fmac_f32 v6, v8, v8
    v_sub_f32 v7, v82, v3
    v_sub_f32 v8, v83, v3
    v_fmac_f32 v4, v7, v7
    v_fmac_f32 v6, v8, v8
    v_sub_f32 v7, v84, v3
    v_sub_f32 v8, v85, v3
    v_fmac_f32 v4, v7, v7
    v_fmac_f32 v6, v8, v8
    v_sub_f32 v7, v86, v3
    v_sub_f32 v8, v87, v3
    v_fmac_f32 v4, v7, v7
    v_fmac_f32 v6, v8, v8
    v_sub_f32 v7, v88, v3
    v_sub_f32 v8, v89, v3
    v_fmac_f32 v4, v7, v7
    v_fmac_f32 v6, v8, v8
    v_sub_f32 v7, v90, v3
    v_sub_f32 v8, v91, v3
    v_fmac_f32 v4, v7, v7
    v_fmac_f32 v6, v8, v8
    v_sub_f32 v7, v92, v3
    v_sub_f32 v8, v93, v3
    v_fmac_f32 v4, v7, v7
    v_fmac_f32 v6, v8, v8
    v_sub_f32 v7, v94, v3
    v_sub_f32 v8, v95, v3
    v_fmac_f32 v4, v7, v7
    v_fmac_f32 v6, v8, v8
    v_sub_f32 v7, v96, v3
    v_sub_f32 v8, v97, v3
    v_fmac_f32 v4, v7, v7
    v_fmac_f32 v6, v8, v8
    v_sub_f32 v7, v98, v3
    v_sub_f32 v8, v99, v3
    v_fmac_f32 v4, v7, v7
    v_fmac_f32 v6, v8, v8
    v_sub_f32 v7, v100, v3
    v_sub_f32 v8, v101, v3
    v_fmac_f32 v4, v7, v7
    v_fmac_f32 v6, v8, v8
    v_sub_f32 v7, v102, v3
    v_sub_f32 v8, v103, v3
    v_fmac_f32 v4, v7, v7
    v_fmac_f32 v6, v8, v8
    v_sub_f32 v7, v104, v3
    v_sub_f32 v8, v105, v3
    v_fmac_f32 v4, v7, v7
    v_fmac_f32 v6, v8, v8
    v_sub_f32 v7, v106, v3
    v_sub_f32 v8, v107, v3
    v_fmac_f32 v4, v7, v7
    v_fmac_f32 v6, v8, v8
    v_sub_f32 v7, v108, v3
    v_sub_f32 v8, v109, v3
    v_fmac_f32 v4, v7, v7
    v_fmac_f32 v6, v8, v8
    v_sub_f32 v7, v110, v3
    v_sub_f32 v8, v111, v3
    v_fmac_f32 v4, v7, v7
    v_fmac_f32 v6, v8, v8
    v_sub_f32 v7, v112, v3
    v_sub_f32 v8, v113, v3
    v_fmac_f32 v4, v7, v7
    v_fmac_f32 v6, v8, v8
    v_sub_f32 v7, v114, v3
    v_sub_f32 v8, v115, v3
    v_fmac_f32 v4, v7, v7
    v_fmac_f32 v6, v8, v8
    v_sub_f32 v7, v116, v3
    v_sub_f32 v8, v117, v3
    v_fmac_f32 v4, v7, v7
    v_fmac_f32 v6, v8, v8
    v_sub_f32 v7, v118, v3
    v_sub_f32 v8, v119, v3
    v_fmac_f32 v4, v7, v7
    v_fmac_f32 v6, v8, v8
    v_add_f32 v4, v4, v6
    ds_swizzle_b32 v5, v4 offset:1055
    s_waitcnt lgkmcnt(0)
    v_add_f32 v4, v4, v5
    ds_swizzle_b32 v5, v4 offset:2079
    s_waitcnt lgkmcnt(0)
    v_add_f32 v4, v4, v5
    ds_swizzle_b32 v5, v4 offset:4127
    s_waitcnt lgkmcnt(0)
    v_add_f32 v4, v4, v5
    v_mul_f32 v4, s25, v4
    v_cvt_pk_bf16_f32 v3, v3, v3
    v_and_b32 v3, 0xffff0000, v3
    v_cvt_pk_bf16_f32 v4, v4, v4
    v_and_b32 v4, 0xffff0000, v4
    v_add_f32 v4, 0x3727c5ac, v4
    v_cvt_pk_bf16_f32 v4, v4, v4
    v_and_b32 v4, 0xffff0000, v4
    v_sqrt_f32 v4, v4
    s_nop 0
    v_cvt_pk_bf16_f32 v4, v4, v4
    v_and_b32 v4, 0xffff0000, v4
    v_rcp_f32 v4, v4
    s_nop 0
    v_sub_f32 v7, v48, v3
    v_sub_f32 v8, v49, v3
    v_cvt_pk_bf16_f32 v7, v7, v8
    v_and_b32 v8, 0xffff0000, v7
    v_lshlrev_b32 v7, 16, v7
    v_mul_f32 v7, v7, v4
    v_mul_f32 v8, v8, v4
    v_cvt_pk_bf16_f32 v12, v7, v8
    v_sub_f32 v7, v50, v3
    v_sub_f32 v8, v51, v3
    v_cvt_pk_bf16_f32 v7, v7, v8
    v_and_b32 v8, 0xffff0000, v7
    v_lshlrev_b32 v7, 16, v7
    v_mul_f32 v7, v7, v4
    v_mul_f32 v8, v8, v4
    v_cvt_pk_bf16_f32 v13, v7, v8
    v_sub_f32 v7, v52, v3
    v_sub_f32 v8, v53, v3
    v_cvt_pk_bf16_f32 v7, v7, v8
    v_and_b32 v8, 0xffff0000, v7
    v_lshlrev_b32 v7, 16, v7
    v_mul_f32 v7, v7, v4
    v_mul_f32 v8, v8, v4
    v_cvt_pk_bf16_f32 v14, v7, v8
    v_sub_f32 v7, v54, v3
    v_sub_f32 v8, v55, v3
    v_cvt_pk_bf16_f32 v7, v7, v8
    v_and_b32 v8, 0xffff0000, v7
    v_lshlrev_b32 v7, 16, v7
    v_mul_f32 v7, v7, v4
    v_mul_f32 v8, v8, v4
    v_cvt_pk_bf16_f32 v15, v7, v8
    v_sub_f32 v7, v56, v3
    v_sub_f32 v8, v57, v3
    v_cvt_pk_bf16_f32 v7, v7, v8
    v_and_b32 v8, 0xffff0000, v7
    v_lshlrev_b32 v7, 16, v7
    v_mul_f32 v7, v7, v4
    v_mul_f32 v8, v8, v4
    v_cvt_pk_bf16_f32 v16, v7, v8
    v_sub_f32 v7, v58, v3
    v_sub_f32 v8, v59, v3
    v_cvt_pk_bf16_f32 v7, v7, v8
    v_and_b32 v8, 0xffff0000, v7
    v_lshlrev_b32 v7, 16, v7
    v_mul_f32 v7, v7, v4
    v_mul_f32 v8, v8, v4
    v_cvt_pk_bf16_f32 v17, v7, v8
    v_sub_f32 v7, v60, v3
    v_sub_f32 v8, v61, v3
    v_cvt_pk_bf16_f32 v7, v7, v8
    v_and_b32 v8, 0xffff0000, v7
    v_lshlrev_b32 v7, 16, v7
    v_mul_f32 v7, v7, v4
    v_mul_f32 v8, v8, v4
    v_cvt_pk_bf16_f32 v18, v7, v8
    v_sub_f32 v7, v62, v3
    v_sub_f32 v8, v63, v3
    v_cvt_pk_bf16_f32 v7, v7, v8
    v_and_b32 v8, 0xffff0000, v7
    v_lshlrev_b32 v7, 16, v7
    v_mul_f32 v7, v7, v4
    v_mul_f32 v8, v8, v4
    v_cvt_pk_bf16_f32 v19, v7, v8
    v_sub_f32 v7, v64, v3
    v_sub_f32 v8, v65, v3
    v_cvt_pk_bf16_f32 v7, v7, v8
    v_and_b32 v8, 0xffff0000, v7
    v_lshlrev_b32 v7, 16, v7
    v_mul_f32 v7, v7, v4
    v_mul_f32 v8, v8, v4
    v_cvt_pk_bf16_f32 v20, v7, v8
    v_sub_f32 v7, v66, v3
    v_sub_f32 v8, v67, v3
    v_cvt_pk_bf16_f32 v7, v7, v8
    v_and_b32 v8, 0xffff0000, v7
    v_lshlrev_b32 v7, 16, v7
    v_mul_f32 v7, v7, v4
    v_mul_f32 v8, v8, v4
    v_cvt_pk_bf16_f32 v21, v7, v8
    v_sub_f32 v7, v68, v3
    v_sub_f32 v8, v69, v3
    v_cvt_pk_bf16_f32 v7, v7, v8
    v_and_b32 v8, 0xffff0000, v7
    v_lshlrev_b32 v7, 16, v7
    v_mul_f32 v7, v7, v4
    v_mul_f32 v8, v8, v4
    v_cvt_pk_bf16_f32 v22, v7, v8
    v_sub_f32 v7, v70, v3
    v_sub_f32 v8, v71, v3
    v_cvt_pk_bf16_f32 v7, v7, v8
    v_and_b32 v8, 0xffff0000, v7
    v_lshlrev_b32 v7, 16, v7
    v_mul_f32 v7, v7, v4
    v_mul_f32 v8, v8, v4
    v_cvt_pk_bf16_f32 v23, v7, v8
    v_sub_f32 v7, v72, v3
    v_sub_f32 v8, v73, v3
    v_cvt_pk_bf16_f32 v7, v7, v8
    v_and_b32 v8, 0xffff0000, v7
    v_lshlrev_b32 v7, 16, v7
    v_mul_f32 v7, v7, v4
    v_mul_f32 v8, v8, v4
    v_cvt_pk_bf16_f32 v24, v7, v8
    v_sub_f32 v7, v74, v3
    v_sub_f32 v8, v75, v3
    v_cvt_pk_bf16_f32 v7, v7, v8
    v_and_b32 v8, 0xffff0000, v7
    v_lshlrev_b32 v7, 16, v7
    v_mul_f32 v7, v7, v4
    v_mul_f32 v8, v8, v4
    v_cvt_pk_bf16_f32 v25, v7, v8
    v_sub_f32 v7, v76, v3
    v_sub_f32 v8, v77, v3
    v_cvt_pk_bf16_f32 v7, v7, v8
    v_and_b32 v8, 0xffff0000, v7
    v_lshlrev_b32 v7, 16, v7
    v_mul_f32 v7, v7, v4
    v_mul_f32 v8, v8, v4
    v_cvt_pk_bf16_f32 v26, v7, v8
    v_sub_f32 v7, v78, v3
    v_sub_f32 v8, v79, v3
    v_cvt_pk_bf16_f32 v7, v7, v8
    v_and_b32 v8, 0xffff0000, v7
    v_lshlrev_b32 v7, 16, v7
    v_mul_f32 v7, v7, v4
    v_mul_f32 v8, v8, v4
    v_cvt_pk_bf16_f32 v27, v7, v8
    v_sub_f32 v7, v80, v3
    v_sub_f32 v8, v81, v3
    v_cvt_pk_bf16_f32 v7, v7, v8
    v_and_b32 v8, 0xffff0000, v7
    v_lshlrev_b32 v7, 16, v7
    v_mul_f32 v7, v7, v4
    v_mul_f32 v8, v8, v4
    v_cvt_pk_bf16_f32 v28, v7, v8
    v_sub_f32 v7, v82, v3
    v_sub_f32 v8, v83, v3
    v_cvt_pk_bf16_f32 v7, v7, v8
    v_and_b32 v8, 0xffff0000, v7
    v_lshlrev_b32 v7, 16, v7
    v_mul_f32 v7, v7, v4
    v_mul_f32 v8, v8, v4
    v_cvt_pk_bf16_f32 v29, v7, v8
    v_sub_f32 v7, v84, v3
    v_sub_f32 v8, v85, v3
    v_cvt_pk_bf16_f32 v7, v7, v8
    v_and_b32 v8, 0xffff0000, v7
    v_lshlrev_b32 v7, 16, v7
    v_mul_f32 v7, v7, v4
    v_mul_f32 v8, v8, v4
    v_cvt_pk_bf16_f32 v30, v7, v8
    v_sub_f32 v7, v86, v3
    v_sub_f32 v8, v87, v3
    v_cvt_pk_bf16_f32 v7, v7, v8
    v_and_b32 v8, 0xffff0000, v7
    v_lshlrev_b32 v7, 16, v7
    v_mul_f32 v7, v7, v4
    v_mul_f32 v8, v8, v4
    v_cvt_pk_bf16_f32 v31, v7, v8
    v_sub_f32 v7, v88, v3
    v_sub_f32 v8, v89, v3
    v_cvt_pk_bf16_f32 v7, v7, v8
    v_and_b32 v8, 0xffff0000, v7
    v_lshlrev_b32 v7, 16, v7
    v_mul_f32 v7, v7, v4
    v_mul_f32 v8, v8, v4
    v_cvt_pk_bf16_f32 v32, v7, v8
    v_sub_f32 v7, v90, v3
    v_sub_f32 v8, v91, v3
    v_cvt_pk_bf16_f32 v7, v7, v8
    v_and_b32 v8, 0xffff0000, v7
    v_lshlrev_b32 v7, 16, v7
    v_mul_f32 v7, v7, v4
    v_mul_f32 v8, v8, v4
    v_cvt_pk_bf16_f32 v33, v7, v8
    v_sub_f32 v7, v92, v3
    v_sub_f32 v8, v93, v3
    v_cvt_pk_bf16_f32 v7, v7, v8
    v_and_b32 v8, 0xffff0000, v7
    v_lshlrev_b32 v7, 16, v7
    v_mul_f32 v7, v7, v4
    v_mul_f32 v8, v8, v4
    v_cvt_pk_bf16_f32 v34, v7, v8
    v_sub_f32 v7, v94, v3
    v_sub_f32 v8, v95, v3
    v_cvt_pk_bf16_f32 v7, v7, v8
    v_and_b32 v8, 0xffff0000, v7
    v_lshlrev_b32 v7, 16, v7
    v_mul_f32 v7, v7, v4
    v_mul_f32 v8, v8, v4
    v_cvt_pk_bf16_f32 v35, v7, v8
    v_sub_f32 v7, v96, v3
    v_sub_f32 v8, v97, v3
    v_cvt_pk_bf16_f32 v7, v7, v8
    v_and_b32 v8, 0xffff0000, v7
    v_lshlrev_b32 v7, 16, v7
    v_mul_f32 v7, v7, v4
    v_mul_f32 v8, v8, v4
    v_cvt_pk_bf16_f32 v36, v7, v8
    v_sub_f32 v7, v98, v3
    v_sub_f32 v8, v99, v3
    v_cvt_pk_bf16_f32 v7, v7, v8
    v_and_b32 v8, 0xffff0000, v7
    v_lshlrev_b32 v7, 16, v7
    v_mul_f32 v7, v7, v4
    v_mul_f32 v8, v8, v4
    v_cvt_pk_bf16_f32 v37, v7, v8
    v_sub_f32 v7, v100, v3
    v_sub_f32 v8, v101, v3
    v_cvt_pk_bf16_f32 v7, v7, v8
    v_and_b32 v8, 0xffff0000, v7
    v_lshlrev_b32 v7, 16, v7
    v_mul_f32 v7, v7, v4
    v_mul_f32 v8, v8, v4
    v_cvt_pk_bf16_f32 v38, v7, v8
    v_sub_f32 v7, v102, v3
    v_sub_f32 v8, v103, v3
    v_cvt_pk_bf16_f32 v7, v7, v8
    v_and_b32 v8, 0xffff0000, v7
    v_lshlrev_b32 v7, 16, v7
    v_mul_f32 v7, v7, v4
    v_mul_f32 v8, v8, v4
    v_cvt_pk_bf16_f32 v39, v7, v8
    v_sub_f32 v7, v104, v3
    v_sub_f32 v8, v105, v3
    v_cvt_pk_bf16_f32 v7, v7, v8
    v_and_b32 v8, 0xffff0000, v7
    v_lshlrev_b32 v7, 16, v7
    v_mul_f32 v7, v7, v4
    v_mul_f32 v8, v8, v4
    v_cvt_pk_bf16_f32 v40, v7, v8
    v_sub_f32 v7, v106, v3
    v_sub_f32 v8, v107, v3
    v_cvt_pk_bf16_f32 v7, v7, v8
    v_and_b32 v8, 0xffff0000, v7
    v_lshlrev_b32 v7, 16, v7
    v_mul_f32 v7, v7, v4
    v_mul_f32 v8, v8, v4
    v_cvt_pk_bf16_f32 v41, v7, v8
    v_sub_f32 v7, v108, v3
    v_sub_f32 v8, v109, v3
    v_cvt_pk_bf16_f32 v7, v7, v8
    v_and_b32 v8, 0xffff0000, v7
    v_lshlrev_b32 v7, 16, v7
    v_mul_f32 v7, v7, v4
    v_mul_f32 v8, v8, v4
    v_cvt_pk_bf16_f32 v42, v7, v8
    v_sub_f32 v7, v110, v3
    v_sub_f32 v8, v111, v3
    v_cvt_pk_bf16_f32 v7, v7, v8
    v_and_b32 v8, 0xffff0000, v7
    v_lshlrev_b32 v7, 16, v7
    v_mul_f32 v7, v7, v4
    v_mul_f32 v8, v8, v4
    v_cvt_pk_bf16_f32 v43, v7, v8
    v_sub_f32 v7, v112, v3
    v_sub_f32 v8, v113, v3
    v_cvt_pk_bf16_f32 v7, v7, v8
    v_and_b32 v8, 0xffff0000, v7
    v_lshlrev_b32 v7, 16, v7
    v_mul_f32 v7, v7, v4
    v_mul_f32 v8, v8, v4
    v_cvt_pk_bf16_f32 v44, v7, v8
    v_sub_f32 v7, v114, v3
    v_sub_f32 v8, v115, v3
    v_cvt_pk_bf16_f32 v7, v7, v8
    v_and_b32 v8, 0xffff0000, v7
    v_lshlrev_b32 v7, 16, v7
    v_mul_f32 v7, v7, v4
    v_mul_f32 v8, v8, v4
    v_cvt_pk_bf16_f32 v45, v7, v8
    v_sub_f32 v7, v116, v3
    v_sub_f32 v8, v117, v3
    v_cvt_pk_bf16_f32 v7, v7, v8
    v_and_b32 v8, 0xffff0000, v7
    v_lshlrev_b32 v7, 16, v7
    v_mul_f32 v7, v7, v4
    v_mul_f32 v8, v8, v4
    v_cvt_pk_bf16_f32 v46, v7, v8
    v_sub_f32 v7, v118, v3
    v_sub_f32 v8, v119, v3
    v_cvt_pk_bf16_f32 v7, v7, v8
    v_and_b32 v8, 0xffff0000, v7
    v_lshlrev_b32 v7, 16, v7
    v_mul_f32 v7, v7, v4
    v_mul_f32 v8, v8, v4
    v_cvt_pk_bf16_f32 v47, v7, v8
    v_lshrrev_b32 v1, 3, v0
    v_add_u32 v1, s24, v1
    v_lshrrev_b32 v2, 4, v1
    v_mul_u32_u24 v2, 18432, v2
    v_and_b32 v1, 15, v1
    v_lshl_add_u32 v2, v1, 4, v2
    v_and_b32 v1, 7, v0
    v_lshl_add_u32 v2, v1, 8, v2
    s_mov_b32 s26, 0
    buffer_store_dwordx4 v[12:15], v2, s[16:19], s26 offen
    s_mov_b32 s26, 2048
    buffer_store_dwordx4 v[16:19], v2, s[16:19], s26 offen
    s_mov_b32 s26, 4096
    buffer_store_dwordx4 v[20:23], v2, s[16:19], s26 offen
    s_mov_b32 s26, 6144
    buffer_store_dwordx4 v[24:27], v2, s[16:19], s26 offen
    s_mov_b32 s26, 8192
    buffer_store_dwordx4 v[28:31], v2, s[16:19], s26 offen
    s_mov_b32 s26, 10240
    buffer_store_dwordx4 v[32:35], v2, s[16:19], s26 offen
    s_mov_b32 s26, 12288
    buffer_store_dwordx4 v[36:39], v2, s[16:19], s26 offen
    s_mov_b32 s26, 14336
    buffer_store_dwordx4 v[40:43], v2, s[16:19], s26 offen
    s_mov_b32 s26, 16384
    buffer_store_dwordx4 v[44:47], v2, s[16:19], s26 offen
    s_endpgm
K0_COPY:
    s_load_dwordx2 s[4:5], s[0:1], 96
    s_load_dwordx2 s[6:7], s[0:1], 8
    s_load_dwordx2 s[8:9], s[0:1], 40
    s_load_dwordx2 s[10:11], s[0:1], 48
    s_load_dwordx2 s[12:13], s[0:1], 24
    s_sub_u32 s3, s2, 172
    s_waitcnt lgkmcnt(0)
    s_cmp_ge_u32 s3, 72
    s_cbranch_scc1 K0_C2
    s_mov_b32 s16, s6
    s_and_b32 s17, s7, 0xffff
    s_mov_b32 s18, 1990656
    s_mov_b32 s19, 0x00020000
    s_add_u32 s20, s4, 50200576
    s_addc_u32 s21, s5, 0
    s_and_b32 s21, s21, 0xffff
    s_mov_b32 s22, 2359296
    s_mov_b32 s23, 0x00020000
    s_lshl_b32 s24, s3, 11
    v_add_u32 v2, s24, v0
    s_mov_b32 s24, 466034
    v_mov_b32 v15, 32
    v_add_u32 v3, 0, v2
    v_mul_hi_u32 v5, v3, s24
    v_mul_u32_u24 v6, 9216, v5
    v_sub_u32 v6, v3, v6
    v_lshrrev_b32 v7, 9, v6
    v_bfe_u32 v8, v6, 6, 3
    v_bfe_u32 v9, v6, 5, 1
    v_and_b32 v10, 31, v6
    v_lshrrev_b32 v11, 3, v10
    v_bfe_u32 v12, v10, 1, 2
    v_and_b32 v13, 1, v10
    v_lshlrev_b32 v7, 5, v7
    v_lshl_add_u32 v7, v11, 3, v7
    v_lshl_add_u32 v7, v9, 2, v7
    v_add_u32 v7, v7, v12
    v_mul_u32_u24 v7, 3456, v7
    v_mul_u32_u24 v5, 72, v5
    v_add_u32 v7, v7, v5
    v_mul_u32_u24 v11, 1152, v13
    v_lshl_add_u32 v11, v8, 3, v11
    v_lshlrev_b32 v12, 5, v8
    v_lshl_add_u32 v12, v13, 4, v12
    v_add_u32 v12, 2144, v12
    v_cmp_gt_u32 vcc, 5, v8
    v_mov_b32 v14, 8
    s_nop 0
    v_cndmask_b32 v11, v12, v11, vcc
    v_cndmask_b32 v14, 8, v15, vcc
    v_add_u32 v7, v7, v11
    v_add_u32 v14, v7, v14
    buffer_load_dwordx2 v[16:17], v7, s[16:19], 0 offen
    buffer_load_dwordx2 v[18:19], v14, s[16:19], 0 offen
    v_add_u32 v3, 256, v2
    v_mul_hi_u32 v5, v3, s24
    v_mul_u32_u24 v6, 9216, v5
    v_sub_u32 v6, v3, v6
    v_lshrrev_b32 v7, 9, v6
    v_bfe_u32 v8, v6, 6, 3
    v_bfe_u32 v9, v6, 5, 1
    v_and_b32 v10, 31, v6
    v_lshrrev_b32 v11, 3, v10
    v_bfe_u32 v12, v10, 1, 2
    v_and_b32 v13, 1, v10
    v_lshlrev_b32 v7, 5, v7
    v_lshl_add_u32 v7, v11, 3, v7
    v_lshl_add_u32 v7, v9, 2, v7
    v_add_u32 v7, v7, v12
    v_mul_u32_u24 v7, 3456, v7
    v_mul_u32_u24 v5, 72, v5
    v_add_u32 v7, v7, v5
    v_mul_u32_u24 v11, 1152, v13
    v_lshl_add_u32 v11, v8, 3, v11
    v_lshlrev_b32 v12, 5, v8
    v_lshl_add_u32 v12, v13, 4, v12
    v_add_u32 v12, 2144, v12
    v_cmp_gt_u32 vcc, 5, v8
    v_mov_b32 v14, 8
    s_nop 0
    v_cndmask_b32 v11, v12, v11, vcc
    v_cndmask_b32 v14, 8, v15, vcc
    v_add_u32 v7, v7, v11
    v_add_u32 v14, v7, v14
    buffer_load_dwordx2 v[20:21], v7, s[16:19], 0 offen
    buffer_load_dwordx2 v[22:23], v14, s[16:19], 0 offen
    v_add_u32 v3, 512, v2
    v_mul_hi_u32 v5, v3, s24
    v_mul_u32_u24 v6, 9216, v5
    v_sub_u32 v6, v3, v6
    v_lshrrev_b32 v7, 9, v6
    v_bfe_u32 v8, v6, 6, 3
    v_bfe_u32 v9, v6, 5, 1
    v_and_b32 v10, 31, v6
    v_lshrrev_b32 v11, 3, v10
    v_bfe_u32 v12, v10, 1, 2
    v_and_b32 v13, 1, v10
    v_lshlrev_b32 v7, 5, v7
    v_lshl_add_u32 v7, v11, 3, v7
    v_lshl_add_u32 v7, v9, 2, v7
    v_add_u32 v7, v7, v12
    v_mul_u32_u24 v7, 3456, v7
    v_mul_u32_u24 v5, 72, v5
    v_add_u32 v7, v7, v5
    v_mul_u32_u24 v11, 1152, v13
    v_lshl_add_u32 v11, v8, 3, v11
    v_lshlrev_b32 v12, 5, v8
    v_lshl_add_u32 v12, v13, 4, v12
    v_add_u32 v12, 2144, v12
    v_cmp_gt_u32 vcc, 5, v8
    v_mov_b32 v14, 8
    s_nop 0
    v_cndmask_b32 v11, v12, v11, vcc
    v_cndmask_b32 v14, 8, v15, vcc
    v_add_u32 v7, v7, v11
    v_add_u32 v14, v7, v14
    buffer_load_dwordx2 v[24:25], v7, s[16:19], 0 offen
    buffer_load_dwordx2 v[26:27], v14, s[16:19], 0 offen
    v_add_u32 v3, 768, v2
    v_mul_hi_u32 v5, v3, s24
    v_mul_u32_u24 v6, 9216, v5
    v_sub_u32 v6, v3, v6
    v_lshrrev_b32 v7, 9, v6
    v_bfe_u32 v8, v6, 6, 3
    v_bfe_u32 v9, v6, 5, 1
    v_and_b32 v10, 31, v6
    v_lshrrev_b32 v11, 3, v10
    v_bfe_u32 v12, v10, 1, 2
    v_and_b32 v13, 1, v10
    v_lshlrev_b32 v7, 5, v7
    v_lshl_add_u32 v7, v11, 3, v7
    v_lshl_add_u32 v7, v9, 2, v7
    v_add_u32 v7, v7, v12
    v_mul_u32_u24 v7, 3456, v7
    v_mul_u32_u24 v5, 72, v5
    v_add_u32 v7, v7, v5
    v_mul_u32_u24 v11, 1152, v13
    v_lshl_add_u32 v11, v8, 3, v11
    v_lshlrev_b32 v12, 5, v8
    v_lshl_add_u32 v12, v13, 4, v12
    v_add_u32 v12, 2144, v12
    v_cmp_gt_u32 vcc, 5, v8
    v_mov_b32 v14, 8
    s_nop 0
    v_cndmask_b32 v11, v12, v11, vcc
    v_cndmask_b32 v14, 8, v15, vcc
    v_add_u32 v7, v7, v11
    v_add_u32 v14, v7, v14
    buffer_load_dwordx2 v[28:29], v7, s[16:19], 0 offen
    buffer_load_dwordx2 v[30:31], v14, s[16:19], 0 offen
    v_add_u32 v3, 1024, v2
    v_mul_hi_u32 v5, v3, s24
    v_mul_u32_u24 v6, 9216, v5
    v_sub_u32 v6, v3, v6
    v_lshrrev_b32 v7, 9, v6
    v_bfe_u32 v8, v6, 6, 3
    v_bfe_u32 v9, v6, 5, 1
    v_and_b32 v10, 31, v6
    v_lshrrev_b32 v11, 3, v10
    v_bfe_u32 v12, v10, 1, 2
    v_and_b32 v13, 1, v10
    v_lshlrev_b32 v7, 5, v7
    v_lshl_add_u32 v7, v11, 3, v7
    v_lshl_add_u32 v7, v9, 2, v7
    v_add_u32 v7, v7, v12
    v_mul_u32_u24 v7, 3456, v7
    v_mul_u32_u24 v5, 72, v5
    v_add_u32 v7, v7, v5
    v_mul_u32_u24 v11, 1152, v13
    v_lshl_add_u32 v11, v8, 3, v11
    v_lshlrev_b32 v12, 5, v8
    v_lshl_add_u32 v12, v13, 4, v12
    v_add_u32 v12, 2144, v12
    v_cmp_gt_u32 vcc, 5, v8
    v_mov_b32 v14, 8
    s_nop 0
    v_cndmask_b32 v11, v12, v11, vcc
    v_cndmask_b32 v14, 8, v15, vcc
    v_add_u32 v7, v7, v11
    v_add_u32 v14, v7, v14
    buffer_load_dwordx2 v[32:33], v7, s[16:19], 0 offen
    buffer_load_dwordx2 v[34:35], v14, s[16:19], 0 offen
    v_add_u32 v3, 1280, v2
    v_mul_hi_u32 v5, v3, s24
    v_mul_u32_u24 v6, 9216, v5
    v_sub_u32 v6, v3, v6
    v_lshrrev_b32 v7, 9, v6
    v_bfe_u32 v8, v6, 6, 3
    v_bfe_u32 v9, v6, 5, 1
    v_and_b32 v10, 31, v6
    v_lshrrev_b32 v11, 3, v10
    v_bfe_u32 v12, v10, 1, 2
    v_and_b32 v13, 1, v10
    v_lshlrev_b32 v7, 5, v7
    v_lshl_add_u32 v7, v11, 3, v7
    v_lshl_add_u32 v7, v9, 2, v7
    v_add_u32 v7, v7, v12
    v_mul_u32_u24 v7, 3456, v7
    v_mul_u32_u24 v5, 72, v5
    v_add_u32 v7, v7, v5
    v_mul_u32_u24 v11, 1152, v13
    v_lshl_add_u32 v11, v8, 3, v11
    v_lshlrev_b32 v12, 5, v8
    v_lshl_add_u32 v12, v13, 4, v12
    v_add_u32 v12, 2144, v12
    v_cmp_gt_u32 vcc, 5, v8
    v_mov_b32 v14, 8
    s_nop 0
    v_cndmask_b32 v11, v12, v11, vcc
    v_cndmask_b32 v14, 8, v15, vcc
    v_add_u32 v7, v7, v11
    v_add_u32 v14, v7, v14
    buffer_load_dwordx2 v[36:37], v7, s[16:19], 0 offen
    buffer_load_dwordx2 v[38:39], v14, s[16:19], 0 offen
    v_add_u32 v3, 1536, v2
    v_mul_hi_u32 v5, v3, s24
    v_mul_u32_u24 v6, 9216, v5
    v_sub_u32 v6, v3, v6
    v_lshrrev_b32 v7, 9, v6
    v_bfe_u32 v8, v6, 6, 3
    v_bfe_u32 v9, v6, 5, 1
    v_and_b32 v10, 31, v6
    v_lshrrev_b32 v11, 3, v10
    v_bfe_u32 v12, v10, 1, 2
    v_and_b32 v13, 1, v10
    v_lshlrev_b32 v7, 5, v7
    v_lshl_add_u32 v7, v11, 3, v7
    v_lshl_add_u32 v7, v9, 2, v7
    v_add_u32 v7, v7, v12
    v_mul_u32_u24 v7, 3456, v7
    v_mul_u32_u24 v5, 72, v5
    v_add_u32 v7, v7, v5
    v_mul_u32_u24 v11, 1152, v13
    v_lshl_add_u32 v11, v8, 3, v11
    v_lshlrev_b32 v12, 5, v8
    v_lshl_add_u32 v12, v13, 4, v12
    v_add_u32 v12, 2144, v12
    v_cmp_gt_u32 vcc, 5, v8
    v_mov_b32 v14, 8
    s_nop 0
    v_cndmask_b32 v11, v12, v11, vcc
    v_cndmask_b32 v14, 8, v15, vcc
    v_add_u32 v7, v7, v11
    v_add_u32 v14, v7, v14
    buffer_load_dwordx2 v[40:41], v7, s[16:19], 0 offen
    buffer_load_dwordx2 v[42:43], v14, s[16:19], 0 offen
    v_add_u32 v3, 1792, v2
    v_mul_hi_u32 v5, v3, s24
    v_mul_u32_u24 v6, 9216, v5
    v_sub_u32 v6, v3, v6
    v_lshrrev_b32 v7, 9, v6
    v_bfe_u32 v8, v6, 6, 3
    v_bfe_u32 v9, v6, 5, 1
    v_and_b32 v10, 31, v6
    v_lshrrev_b32 v11, 3, v10
    v_bfe_u32 v12, v10, 1, 2
    v_and_b32 v13, 1, v10
    v_lshlrev_b32 v7, 5, v7
    v_lshl_add_u32 v7, v11, 3, v7
    v_lshl_add_u32 v7, v9, 2, v7
    v_add_u32 v7, v7, v12
    v_mul_u32_u24 v7, 3456, v7
    v_mul_u32_u24 v5, 72, v5
    v_add_u32 v7, v7, v5
    v_mul_u32_u24 v11, 1152, v13
    v_lshl_add_u32 v11, v8, 3, v11
    v_lshlrev_b32 v12, 5, v8
    v_lshl_add_u32 v12, v13, 4, v12
    v_add_u32 v12, 2144, v12
    v_cmp_gt_u32 vcc, 5, v8
    v_mov_b32 v14, 8
    s_nop 0
    v_cndmask_b32 v11, v12, v11, vcc
    v_cndmask_b32 v14, 8, v15, vcc
    v_add_u32 v7, v7, v11
    v_add_u32 v14, v7, v14
    buffer_load_dwordx2 v[44:45], v7, s[16:19], 0 offen
    buffer_load_dwordx2 v[46:47], v14, s[16:19], 0 offen
    v_lshlrev_b32 v2, 4, v2
    s_waitcnt vmcnt(0)
    s_mov_b32 s26, 0
    buffer_store_dwordx4 v[16:19], v2, s[20:23], s26 offen
    s_mov_b32 s26, 4096
    buffer_store_dwordx4 v[20:23], v2, s[20:23], s26 offen
    s_mov_b32 s26, 8192
    buffer_store_dwordx4 v[24:27], v2, s[20:23], s26 offen
    s_mov_b32 s26, 12288
    buffer_store_dwordx4 v[28:31], v2, s[20:23], s26 offen
    s_mov_b32 s26, 16384
    buffer_store_dwordx4 v[32:35], v2, s[20:23], s26 offen
    s_mov_b32 s26, 20480
    buffer_store_dwordx4 v[36:39], v2, s[20:23], s26 offen
    s_mov_b32 s26, 24576
    buffer_store_dwordx4 v[40:43], v2, s[20:23], s26 offen
    s_mov_b32 s26, 28672
    buffer_store_dwordx4 v[44:47], v2, s[20:23], s26 offen
    s_endpgm
K0_C2:
    s_sub_u32 s3, s3, 72
    s_mov_b32 s16, s12
    s_and_b32 s17, s13, 0xffff
    s_mov_b32 s18, 663552
    s_mov_b32 s19, 0x00020000
    s_add_u32 s20, s4, 68485120
    s_addc_u32 s21, s5, 0
    s_and_b32 s21, s21, 0xffff
    s_mov_b32 s22, 663552
    s_mov_b32 s23, 0x00020000
    s_lshl_b32 s24, s3, 11
    v_add_u32 v2, s24, v0
    s_mov_b32 s24, 1864136
    v_add_u32 v3, 0, v2
    v_mul_hi_u32 v5, v3, s24
    v_mul_u32_u24 v6, 2304, v5
    v_sub_u32 v6, v3, v6
    v_lshrrev_b32 v7, 6, v6
    v_bfe_u32 v8, v6, 5, 1
    v_bfe_u32 v9, v6, 3, 2
    v_bfe_u32 v10, v6, 1, 2
    v_and_b32 v11, 1, v6
    v_lshlrev_b32 v5, 5, v5
    v_lshl_add_u32 v5, v9, 3, v5
    v_lshl_add_u32 v5, v8, 2, v5
    v_add_u32 v5, v5, v10
    v_mul_u32_u24 v5, 1152, v5
    v_lshl_add_u32 v5, v7, 5, v5
    v_lshl_add_u32 v4, v11, 4, v5
    buffer_load_dwordx4 v[16:19], v4, s[16:19], 0 offen
    v_add_u32 v3, 256, v2
    v_mul_hi_u32 v5, v3, s24
    v_mul_u32_u24 v6, 2304, v5
    v_sub_u32 v6, v3, v6
    v_lshrrev_b32 v7, 6, v6
    v_bfe_u32 v8, v6, 5, 1
    v_bfe_u32 v9, v6, 3, 2
    v_bfe_u32 v10, v6, 1, 2
    v_and_b32 v11, 1, v6
    v_lshlrev_b32 v5, 5, v5
    v_lshl_add_u32 v5, v9, 3, v5
    v_lshl_add_u32 v5, v8, 2, v5
    v_add_u32 v5, v5, v10
    v_mul_u32_u24 v5, 1152, v5
    v_lshl_add_u32 v5, v7, 5, v5
    v_lshl_add_u32 v4, v11, 4, v5
    buffer_load_dwordx4 v[20:23], v4, s[16:19], 0 offen
    v_add_u32 v3, 512, v2
    v_mul_hi_u32 v5, v3, s24
    v_mul_u32_u24 v6, 2304, v5
    v_sub_u32 v6, v3, v6
    v_lshrrev_b32 v7, 6, v6
    v_bfe_u32 v8, v6, 5, 1
    v_bfe_u32 v9, v6, 3, 2
    v_bfe_u32 v10, v6, 1, 2
    v_and_b32 v11, 1, v6
    v_lshlrev_b32 v5, 5, v5
    v_lshl_add_u32 v5, v9, 3, v5
    v_lshl_add_u32 v5, v8, 2, v5
    v_add_u32 v5, v5, v10
    v_mul_u32_u24 v5, 1152, v5
    v_lshl_add_u32 v5, v7, 5, v5
    v_lshl_add_u32 v4, v11, 4, v5
    buffer_load_dwordx4 v[24:27], v4, s[16:19], 0 offen
    v_add_u32 v3, 768, v2
    v_mul_hi_u32 v5, v3, s24
    v_mul_u32_u24 v6, 2304, v5
    v_sub_u32 v6, v3, v6
    v_lshrrev_b32 v7, 6, v6
    v_bfe_u32 v8, v6, 5, 1
    v_bfe_u32 v9, v6, 3, 2
    v_bfe_u32 v10, v6, 1, 2
    v_and_b32 v11, 1, v6
    v_lshlrev_b32 v5, 5, v5
    v_lshl_add_u32 v5, v9, 3, v5
    v_lshl_add_u32 v5, v8, 2, v5
    v_add_u32 v5, v5, v10
    v_mul_u32_u24 v5, 1152, v5
    v_lshl_add_u32 v5, v7, 5, v5
    v_lshl_add_u32 v4, v11, 4, v5
    buffer_load_dwordx4 v[28:31], v4, s[16:19], 0 offen
    v_add_u32 v3, 1024, v2
    v_mul_hi_u32 v5, v3, s24
    v_mul_u32_u24 v6, 2304, v5
    v_sub_u32 v6, v3, v6
    v_lshrrev_b32 v7, 6, v6
    v_bfe_u32 v8, v6, 5, 1
    v_bfe_u32 v9, v6, 3, 2
    v_bfe_u32 v10, v6, 1, 2
    v_and_b32 v11, 1, v6
    v_lshlrev_b32 v5, 5, v5
    v_lshl_add_u32 v5, v9, 3, v5
    v_lshl_add_u32 v5, v8, 2, v5
    v_add_u32 v5, v5, v10
    v_mul_u32_u24 v5, 1152, v5
    v_lshl_add_u32 v5, v7, 5, v5
    v_lshl_add_u32 v4, v11, 4, v5
    buffer_load_dwordx4 v[32:35], v4, s[16:19], 0 offen
    v_add_u32 v3, 1280, v2
    v_mul_hi_u32 v5, v3, s24
    v_mul_u32_u24 v6, 2304, v5
    v_sub_u32 v6, v3, v6
    v_lshrrev_b32 v7, 6, v6
    v_bfe_u32 v8, v6, 5, 1
    v_bfe_u32 v9, v6, 3, 2
    v_bfe_u32 v10, v6, 1, 2
    v_and_b32 v11, 1, v6
    v_lshlrev_b32 v5, 5, v5
    v_lshl_add_u32 v5, v9, 3, v5
    v_lshl_add_u32 v5, v8, 2, v5
    v_add_u32 v5, v5, v10
    v_mul_u32_u24 v5, 1152, v5
    v_lshl_add_u32 v5, v7, 5, v5
    v_lshl_add_u32 v4, v11, 4, v5
    buffer_load_dwordx4 v[36:39], v4, s[16:19], 0 offen
    v_add_u32 v3, 1536, v2
    v_mul_hi_u32 v5, v3, s24
    v_mul_u32_u24 v6, 2304, v5
    v_sub_u32 v6, v3, v6
    v_lshrrev_b32 v7, 6, v6
    v_bfe_u32 v8, v6, 5, 1
    v_bfe_u32 v9, v6, 3, 2
    v_bfe_u32 v10, v6, 1, 2
    v_and_b32 v11, 1, v6
    v_lshlrev_b32 v5, 5, v5
    v_lshl_add_u32 v5, v9, 3, v5
    v_lshl_add_u32 v5, v8, 2, v5
    v_add_u32 v5, v5, v10
    v_mul_u32_u24 v5, 1152, v5
    v_lshl_add_u32 v5, v7, 5, v5
    v_lshl_add_u32 v4, v11, 4, v5
    buffer_load_dwordx4 v[40:43], v4, s[16:19], 0 offen
    v_add_u32 v3, 1792, v2
    v_mul_hi_u32 v5, v3, s24
    v_mul_u32_u24 v6, 2304, v5
    v_sub_u32 v6, v3, v6
    v_lshrrev_b32 v7, 6, v6
    v_bfe_u32 v8, v6, 5, 1
    v_bfe_u32 v9, v6, 3, 2
    v_bfe_u32 v10, v6, 1, 2
    v_and_b32 v11, 1, v6
    v_lshlrev_b32 v5, 5, v5
    v_lshl_add_u32 v5, v9, 3, v5
    v_lshl_add_u32 v5, v8, 2, v5
    v_add_u32 v5, v5, v10
    v_mul_u32_u24 v5, 1152, v5
    v_lshl_add_u32 v5, v7, 5, v5
    v_lshl_add_u32 v4, v11, 4, v5
    buffer_load_dwordx4 v[44:47], v4, s[16:19], 0 offen
    v_lshlrev_b32 v2, 4, v2
    s_waitcnt vmcnt(0)
    s_mov_b32 s26, 0
    buffer_store_dwordx4 v[16:19], v2, s[20:23], s26 offen
    s_mov_b32 s26, 4096
    buffer_store_dwordx4 v[20:23], v2, s[20:23], s26 offen
    s_mov_b32 s26, 8192
    buffer_store_dwordx4 v[24:27], v2, s[20:23], s26 offen
    s_mov_b32 s26, 12288
    buffer_store_dwordx4 v[28:31], v2, s[20:23], s26 offen
    s_mov_b32 s26, 16384
    buffer_store_dwordx4 v[32:35], v2, s[20:23], s26 offen
    s_mov_b32 s26, 20480
    buffer_store_dwordx4 v[36:39], v2, s[20:23], s26 offen
    s_mov_b32 s26, 24576
    buffer_store_dwordx4 v[40:43], v2, s[20:23], s26 offen
    s_mov_b32 s26, 28672
    buffer_store_dwordx4 v[44:47], v2, s[20:23], s26 offen
    s_endpgm
K0_END:
    s_endpgm
.globl k1_kernel
.p2align 8
.type k1_kernel,@function
k1_kernel:
    s_cmp_ge_u32 s2, 256
    s_cbranch_scc1 K1_END
    s_load_dwordx2 s[4:5], s[0:1], 96
    s_load_dwordx2 s[6:7], s[0:1], 8
    s_load_dwordx2 s[8:9], s[0:1], 16
    v_lshrrev_b32 v2, 6, v0
    v_and_b32 v1, 63, v0
    s_nop 0
    v_readfirstlane_b32 s3, v2
    s_and_b32 s40, s2, 15
    s_lshr_b32 s41, s2, 4
    s_waitcnt lgkmcnt(0)
    s_add_u32 s12, s4, 50200576
    s_addc_u32 s13, s5, 0
    s_and_b32 s13, s13, 0xffff
    s_mov_b32 s14, 2359296
    s_mov_b32 s15, 0x00020000
    s_add_u32 s16, s4, 131072
    s_addc_u32 s17, s5, 0
    s_and_b32 s17, s17, 0xffff
    s_mov_b32 s18, 2359296
    s_mov_b32 s19, 0x00020000
    s_add_u32 s20, s4, 0
    s_addc_u32 s21, s5, 0
    s_and_b32 s21, s21, 0xffff
    s_mov_b32 s22, 13824
    s_mov_b32 s23, 0x00020000
    s_mov_b32 s24, s8
    s_and_b32 s25, s9, 0xffff
    s_mov_b32 s26, 20736
    s_mov_b32 s27, 0x00020000
    s_add_u32 s28, s4, 2490368
    s_addc_u32 s29, s5, 0
    s_and_b32 s29, s29, 0xffff
    s_mov_b32 s30, 5242880
    s_mov_b32 s31, 0x00020000
    s_add_u32 s32, s4, 16384
    s_addc_u32 s33, s5, 0
    s_and_b32 s33, s33, 0xffff
    s_mov_b32 s34, 102400
    s_mov_b32 s35, 0x00020000
    v_mov_b32 v255, 0x80000000
    v_and_b32 v3, 15, v1
    v_lshrrev_b32 v4, 4, v1
    v_lshlrev_b32 v5, 4, v0
    buffer_load_dwordx4 v[24:27], v5, s[20:23], 0 offen
    v_add_u32 v6, 4096, v5
    v_cmp_gt_u32 vcc, 32, v0
    s_nop 1
    v_cndmask_b32 v6, v255, v6, vcc
    buffer_load_dwordx4 v[28:31], v6, s[20:23], 0 offen
    s_lshl_b32 s42, s40, 7
    s_lshl_b32 s43, s3, 5
    s_add_u32 s42, s42, s43
    s_lshr_b32 s43, s42, 4
    s_mul_i32 s43, s43, 18432
    v_lshlrev_b32 v6, 4, v1
    v_add_u32 v6, s43, v6
    s_mul_i32 s46, s41, 147456
    s_mul_i32 s50, s3, 12288
    s_add_u32 s46, s46, s50
    v_lshlrev_b32 v76, 4, v1
    v_add_u32 v76, s46, v76
    s_add_u32 s51, s50, 6656
    s_mov_b32 s43, 0
    buffer_load_dwordx4 v[100:103], v6, s[16:19], s43 offen offset:0
    buffer_load_dwordx4 v[104:107], v6, s[16:19], s43 offen offset:1024
    buffer_load_dwordx4 v[108:111], v6, s[16:19], s43 offen offset:2048
    s_mov_b32 s43, 3072
    buffer_load_dwordx4 v[112:115], v6, s[16:19], s43 offen offset:0
    buffer_load_dwordx4 v[116:119], v6, s[16:19], s43 offen offset:1024
    buffer_load_dwordx4 v[120:123], v6, s[16:19], s43 offen offset:2048
    s_mov_b32 s43, 18432
    buffer_load_dwordx4 v[172:175], v6, s[16:19], s43 offen offset:0
    buffer_load_dwordx4 v[176:179], v6, s[16:19], s43 offen offset:1024
    buffer_load_dwordx4 v[180:183], v6, s[16:19], s43 offen offset:2048
    s_mov_b32 s43, 21504
    buffer_load_dwordx4 v[184:187], v6, s[16:19], s43 offen offset:0
    buffer_load_dwordx4 v[188:191], v6, s[16:19], s43 offen offset:1024
    buffer_load_dwordx4 v[192:195], v6, s[16:19], s43 offen offset:2048
    s_mov_b32 s50, 0
    s_add_u32 m0, s51, 0
    s_nop 0
    buffer_load_dwordx4 v76, s[12:15], s50 offen lds
    s_mov_b32 s50, 1024
    s_add_u32 m0, s51, 1024
    s_nop 0
    buffer_load_dwordx4 v76, s[12:15], s50 offen lds
    s_mov_b32 s50, 2048
    s_add_u32 m0, s51, 2048
    s_nop 0
    buffer_load_dwordx4 v76, s[12:15], s50 offen lds
    s_mov_b32 s50, 3072
    s_add_u32 m0, s51, 3072
    s_nop 0
    buffer_load_dwordx4 v76, s[12:15], s50 offen lds
    s_mov_b32 s50, 4096
    s_add_u32 m0, s51, 4096
    s_nop 0
    buffer_load_dwordx4 v76, s[12:15], s50 offen lds
    s_mov_b32 s50, 5120
    s_add_u32 m0, s51, 5120
    s_nop 0
    buffer_load_dwordx4 v76, s[12:15], s50 offen lds
    s_mov_b32 s50, 6144
    s_add_u32 m0, s51, 6144
    s_nop 0
    buffer_load_dwordx4 v76, s[12:15], s50 offen lds
    s_mov_b32 s50, 7168
    s_add_u32 m0, s51, 7168
    s_nop 0
    buffer_load_dwordx4 v76, s[12:15], s50 offen lds
    s_mov_b32 s50, 8192
    s_add_u32 m0, s51, 8192
    s_nop 0
    buffer_load_dwordx4 v76, s[12:15], s50 offen lds
    s_mov_b32 s50, 9216
    s_add_u32 m0, s51, 9216
    s_nop 0
    buffer_load_dwordx4 v76, s[12:15], s50 offen lds
    s_mov_b32 s50, 10240
    s_add_u32 m0, s51, 10240
    s_nop 0
    buffer_load_dwordx4 v76, s[12:15], s50 offen lds
    s_mov_b32 s50, 11264
    s_add_u32 m0, s51, 11264
    s_nop 0
    buffer_load_dwordx4 v76, s[12:15], s50 offen lds
    s_mov_b32 s44, 8947849
    s_mov_b32 s45, 178956971
    s_mul_i32 s46, s41, 648*2
    v_add_u32 v8, 0, v0
    v_mul_hi_u32 v9, v8, s44
    v_mul_u32_u24 v10, 480, v9
    v_sub_u32 v10, v8, v10
    v_mul_hi_u32 v11, v10, s45
    v_mul_u32_u24 v12, 24, v11
    v_sub_u32 v12, v10, v12
    v_lshlrev_b32 v13, 1, v9
    v_sub_u32 v12, v12, v13
    v_mul_u32_u24 v13, 324, v9
    v_mul_u32_u24 v14, 18, v12
    v_add3_u32 v13, v13, v14, v11
    v_lshl_add_u32 v13, v13, 1, s46
    v_cmp_gt_u32 vcc, 18, v12
    v_cmp_gt_u32 s[48:49], 18, v11
    s_nop 1
    v_cndmask_b32 v13, v255, v13, vcc
    v_cndmask_b32 v13, v255, v13, s[48:49]
    buffer_load_ushort v92, v13, s[24:27], 0 offen
    v_add_u32 v8, 256, v0
    v_mul_hi_u32 v9, v8, s44
    v_mul_u32_u24 v10, 480, v9
    v_sub_u32 v10, v8, v10
    v_mul_hi_u32 v11, v10, s45
    v_mul_u32_u24 v12, 24, v11
    v_sub_u32 v12, v10, v12
    v_lshlrev_b32 v13, 1, v9
    v_sub_u32 v12, v12, v13
    v_mul_u32_u24 v13, 324, v9
    v_mul_u32_u24 v14, 18, v12
    v_add3_u32 v13, v13, v14, v11
    v_lshl_add_u32 v13, v13, 1, s46
    v_cmp_gt_u32 vcc, 18, v12
    v_cmp_gt_u32 s[48:49], 18, v11
    s_nop 1
    v_cndmask_b32 v13, v255, v13, vcc
    v_cndmask_b32 v13, v255, v13, s[48:49]
    buffer_load_ushort v93, v13, s[24:27], 0 offen
    v_add_u32 v8, 512, v0
    v_mul_hi_u32 v9, v8, s44
    v_mul_u32_u24 v10, 480, v9
    v_sub_u32 v10, v8, v10
    v_mul_hi_u32 v11, v10, s45
    v_mul_u32_u24 v12, 24, v11
    v_sub_u32 v12, v10, v12
    v_lshlrev_b32 v13, 1, v9
    v_sub_u32 v12, v12, v13
    v_mul_u32_u24 v13, 324, v9
    v_mul_u32_u24 v14, 18, v12
    v_add3_u32 v13, v13, v14, v11
    v_lshl_add_u32 v13, v13, 1, s46
    v_cmp_gt_u32 vcc, 18, v12
    v_cmp_gt_u32 s[48:49], 18, v11
    s_nop 1
    v_cndmask_b32 v13, v255, v13, vcc
    v_cndmask_b32 v13, v255, v13, s[48:49]
    buffer_load_ushort v94, v13, s[24:27], 0 offen
    v_add_u32 v8, 768, v0
    v_mul_hi_u32 v9, v8, s44
    v_mul_u32_u24 v10, 480, v9
    v_sub_u32 v10, v8, v10
    v_mul_hi_u32 v11, v10, s45
    v_mul_u32_u24 v12, 24, v11
    v_sub_u32 v12, v10, v12
    v_lshlrev_b32 v13, 1, v9
    v_sub_u32 v12, v12, v13
    v_mul_u32_u24 v13, 324, v9
    v_mul_u32_u24 v14, 18, v12
    v_add3_u32 v13, v13, v14, v11
    v_lshl_add_u32 v13, v13, 1, s46
    v_cmp_gt_u32 vcc, 18, v12
    v_cmp_gt_u32 s[48:49], 18, v11
    s_nop 1
    v_cndmask_b32 v13, v255, v13, vcc
    v_cndmask_b32 v13, v255, v13, s[48:49]
    v_cmp_gt_u32 vcc, 960, v8
    s_nop 1
    v_cndmask_b32 v13, v255, v13, vcc
    buffer_load_ushort v95, v13, s[24:27], 0 offen
    s_mov_b32 s43, 6144
    buffer_load_dwordx4 v[124:127], v6, s[16:19], s43 offen offset:0
    buffer_load_dwordx4 v[128:131], v6, s[16:19], s43 offen offset:1024
    buffer_load_dwordx4 v[132:135], v6, s[16:19], s43 offen offset:2048
    s_mov_b32 s43, 9216
    buffer_load_dwordx4 v[136:139], v6, s[16:19], s43 offen offset:0
    buffer_load_dwordx4 v[140:143], v6, s[16:19], s43 offen offset:1024
    buffer_load_dwordx4 v[144:147], v6, s[16:19], s43 offen offset:2048
    s_mov_b32 s43, 24576
    buffer_load_dwordx4 v[196:199], v6, s[16:19], s43 offen offset:0
    buffer_load_dwordx4 v[200:203], v6, s[16:19], s43 offen offset:1024
    buffer_load_dwordx4 v[204:207], v6, s[16:19], s43 offen offset:2048
    s_mov_b32 s43, 27648
    buffer_load_dwordx4 v[208:211], v6, s[16:19], s43 offen offset:0
    buffer_load_dwordx4 v[212:215], v6, s[16:19], s43 offen offset:1024
    buffer_load_dwordx4 v[216:219], v6, s[16:19], s43 offen offset:2048
    s_mov_b32 s50, 49152
    s_add_u32 m0, s51, 49152
    s_nop 0
    buffer_load_dwordx4 v76, s[12:15], s50 offen lds
    s_mov_b32 s50, 50176
    s_add_u32 m0, s51, 50176
    s_nop 0
    buffer_load_dwordx4 v76, s[12:15], s50 offen lds
    s_mov_b32 s50, 51200
    s_add_u32 m0, s51, 51200
    s_nop 0
    buffer_load_dwordx4 v76, s[12:15], s50 offen lds
    s_mov_b32 s50, 52224
    s_add_u32 m0, s51, 52224
    s_nop 0
    buffer_load_dwordx4 v76, s[12:15], s50 offen lds
    s_mov_b32 s50, 53248
    s_add_u32 m0, s51, 53248
    s_nop 0
    buffer_load_dwordx4 v76, s[12:15], s50 offen lds
    s_mov_b32 s50, 54272
    s_add_u32 m0, s51, 54272
    s_nop 0
    buffer_load_dwordx4 v76, s[12:15], s50 offen lds
    s_mov_b32 s50, 55296
    s_add_u32 m0, s51, 55296
    s_nop 0
    buffer_load_dwordx4 v76, s[12:15], s50 offen lds
    s_mov_b32 s50, 56320
    s_add_u32 m0, s51, 56320
    s_nop 0
    buffer_load_dwordx4 v76, s[12:15], s50 offen lds
    s_mov_b32 s50, 57344
    s_add_u32 m0, s51, 57344
    s_nop 0
    buffer_load_dwordx4 v76, s[12:15], s50 offen lds
    s_mov_b32 s50, 58368
    s_add_u32 m0, s51, 58368
    s_nop 0
    buffer_load_dwordx4 v76, s[12:15], s50 offen lds
    s_mov_b32 s50, 59392
    s_add_u32 m0, s51, 59392
    s_nop 0
    buffer_load_dwordx4 v76, s[12:15], s50 offen lds
    s_mov_b32 s50, 60416
    s_add_u32 m0, s51, 60416
    s_nop 0
    buffer_load_dwordx4 v76, s[12:15], s50 offen lds
    s_waitcnt vmcnt(52)
    ds_write_b128 v5, v[24:27] offset:2048
    v_cmp_gt_u32 vcc, 32, v0
    s_and_saveexec_b64 s[48:49], vcc
    ds_write_b128 v5, v[28:31] offset:6144
    s_mov_b64 exec, s[48:49]
    s_waitcnt lgkmcnt(0)
    s_barrier
    v_lshlrev_b32 v88, 3, v1
    v_add_u32 v88, 6656, v88
    v_lshlrev_b32 v90, 5, v4
    s_waitcnt vmcnt(24)
    v_lshlrev_b32 v8, 1, v0
    ds_write_b16 v8, v92 offset:0
    ds_write_b16 v8, v93 offset:512
    ds_write_b16 v8, v94 offset:1024
    ds_write_b16 v8, v95 offset:1536
    s_waitcnt lgkmcnt(0)
    ds_read_b128 v[244:247], v90 offset:2048
    ds_read_b128 v[248:251], v90 offset:2064
    ds_read_b128 v[92:95], v90 offset:4352
    ds_read_b128 v[96:99], v90 offset:4368
    s_waitcnt lgkmcnt(0)
    v_lshlrev_b32 v252, 16, v100
    v_and_b32 v253, 0xffff0000, v100
    v_fma_f32 v252, v252, v92, v244
    v_fma_f32 v253, v253, v93, v245
    v_cvt_pk_bf16_f32 v100, v252, v253
    v_lshlrev_b32 v252, 16, v101
    v_and_b32 v253, 0xffff0000, v101
    v_fma_f32 v252, v252, v94, v246
    v_fma_f32 v253, v253, v95, v247
    v_cvt_pk_bf16_f32 v101, v252, v253
    v_lshlrev_b32 v252, 16, v102
    v_and_b32 v253, 0xffff0000, v102
    v_fma_f32 v252, v252, v96, v248
    v_fma_f32 v253, v253, v97, v249
    v_cvt_pk_bf16_f32 v102, v252, v253
    v_lshlrev_b32 v252, 16, v103
    v_and_b32 v253, 0xffff0000, v103
    v_fma_f32 v252, v252, v98, v250
    v_fma_f32 v253, v253, v99, v251
    v_cvt_pk_bf16_f32 v103, v252, v253
    v_lshlrev_b32 v252, 16, v172
    v_and_b32 v253, 0xffff0000, v172
    v_fma_f32 v252, v252, v92, v244
    v_fma_f32 v253, v253, v93, v245
    v_cvt_pk_bf16_f32 v172, v252, v253
    v_lshlrev_b32 v252, 16, v173
    v_and_b32 v253, 0xffff0000, v173
    v_fma_f32 v252, v252, v94, v246
    v_fma_f32 v253, v253, v95, v247
    v_cvt_pk_bf16_f32 v173, v252, v253
    v_lshlrev_b32 v252, 16, v174
    v_and_b32 v253, 0xffff0000, v174
    v_fma_f32 v252, v252, v96, v248
    v_fma_f32 v253, v253, v97, v249
    v_cvt_pk_bf16_f32 v174, v252, v253
    v_lshlrev_b32 v252, 16, v175
    v_and_b32 v253, 0xffff0000, v175
    v_fma_f32 v252, v252, v98, v250
    v_fma_f32 v253, v253, v99, v251
    v_cvt_pk_bf16_f32 v175, v252, v253
    ds_read_b128 v[244:247], v90 offset:2176
    ds_read_b128 v[248:251], v90 offset:2192
    ds_read_b128 v[92:95], v90 offset:4480
    ds_read_b128 v[96:99], v90 offset:4496
    s_waitcnt lgkmcnt(0)
    v_lshlrev_b32 v252, 16, v104
    v_and_b32 v253, 0xffff0000, v104
    v_fma_f32 v252, v252, v92, v244
    v_fma_f32 v253, v253, v93, v245
    v_cvt_pk_bf16_f32 v104, v252, v253
    v_lshlrev_b32 v252, 16, v105
    v_and_b32 v253, 0xffff0000, v105
    v_fma_f32 v252, v252, v94, v246
    v_fma_f32 v253, v253, v95, v247
    v_cvt_pk_bf16_f32 v105, v252, v253
    v_lshlrev_b32 v252, 16, v106
    v_and_b32 v253, 0xffff0000, v106
    v_fma_f32 v252, v252, v96, v248
    v_fma_f32 v253, v253, v97, v249
    v_cvt_pk_bf16_f32 v106, v252, v253
    v_lshlrev_b32 v252, 16, v107
    v_and_b32 v253, 0xffff0000, v107
    v_fma_f32 v252, v252, v98, v250
    v_fma_f32 v253, v253, v99, v251
    v_cvt_pk_bf16_f32 v107, v252, v253
    v_lshlrev_b32 v252, 16, v176
    v_and_b32 v253, 0xffff0000, v176
    v_fma_f32 v252, v252, v92, v244
    v_fma_f32 v253, v253, v93, v245
    v_cvt_pk_bf16_f32 v176, v252, v253
    v_lshlrev_b32 v252, 16, v177
    v_and_b32 v253, 0xffff0000, v177
    v_fma_f32 v252, v252, v94, v246
    v_fma_f32 v253, v253, v95, v247
    v_cvt_pk_bf16_f32 v177, v252, v253
    v_lshlrev_b32 v252, 16, v178
    v_and_b32 v253, 0xffff0000, v178
    v_fma_f32 v252, v252, v96, v248
    v_fma_f32 v253, v253, v97, v249
    v_cvt_pk_bf16_f32 v178, v252, v253
    v_lshlrev_b32 v252, 16, v179
    v_and_b32 v253, 0xffff0000, v179
    v_fma_f32 v252, v252, v98, v250
    v_fma_f32 v253, v253, v99, v251
    v_cvt_pk_bf16_f32 v179, v252, v253
    ds_read_b128 v[244:247], v90 offset:2304
    ds_read_b128 v[248:251], v90 offset:2320
    ds_read_b128 v[92:95], v90 offset:4608
    ds_read_b128 v[96:99], v90 offset:4624
    s_waitcnt lgkmcnt(0)
    v_lshlrev_b32 v252, 16, v108
    v_and_b32 v253, 0xffff0000, v108
    v_fma_f32 v252, v252, v92, v244
    v_fma_f32 v253, v253, v93, v245
    v_cvt_pk_bf16_f32 v108, v252, v253
    v_lshlrev_b32 v252, 16, v109
    v_and_b32 v253, 0xffff0000, v109
    v_fma_f32 v252, v252, v94, v246
    v_fma_f32 v253, v253, v95, v247
    v_cvt_pk_bf16_f32 v109, v252, v253
    v_lshlrev_b32 v252, 16, v110
    v_and_b32 v253, 0xffff0000, v110
    v_fma_f32 v252, v252, v96, v248
    v_fma_f32 v253, v253, v97, v249
    v_cvt_pk_bf16_f32 v110, v252, v253
    v_lshlrev_b32 v252, 16, v111
    v_and_b32 v253, 0xffff0000, v111
    v_fma_f32 v252, v252, v98, v250
    v_fma_f32 v253, v253, v99, v251
    v_cvt_pk_bf16_f32 v111, v252, v253
    v_lshlrev_b32 v252, 16, v180
    v_and_b32 v253, 0xffff0000, v180
    v_fma_f32 v252, v252, v92, v244
    v_fma_f32 v253, v253, v93, v245
    v_cvt_pk_bf16_f32 v180, v252, v253
    v_lshlrev_b32 v252, 16, v181
    v_and_b32 v253, 0xffff0000, v181
    v_fma_f32 v252, v252, v94, v246
    v_fma_f32 v253, v253, v95, v247
    v_cvt_pk_bf16_f32 v181, v252, v253
    v_lshlrev_b32 v252, 16, v182
    v_and_b32 v253, 0xffff0000, v182
    v_fma_f32 v252, v252, v96, v248
    v_fma_f32 v253, v253, v97, v249
    v_cvt_pk_bf16_f32 v182, v252, v253
    v_lshlrev_b32 v252, 16, v183
    v_and_b32 v253, 0xffff0000, v183
    v_fma_f32 v252, v252, v98, v250
    v_fma_f32 v253, v253, v99, v251
    v_cvt_pk_bf16_f32 v183, v252, v253
    ds_read_b128 v[244:247], v90 offset:2432
    ds_read_b128 v[248:251], v90 offset:2448
    ds_read_b128 v[92:95], v90 offset:4736
    ds_read_b128 v[96:99], v90 offset:4752
    s_waitcnt lgkmcnt(0)
    v_lshlrev_b32 v252, 16, v112
    v_and_b32 v253, 0xffff0000, v112
    v_fma_f32 v252, v252, v92, v244
    v_fma_f32 v253, v253, v93, v245
    v_cvt_pk_bf16_f32 v112, v252, v253
    v_lshlrev_b32 v252, 16, v113
    v_and_b32 v253, 0xffff0000, v113
    v_fma_f32 v252, v252, v94, v246
    v_fma_f32 v253, v253, v95, v247
    v_cvt_pk_bf16_f32 v113, v252, v253
    v_lshlrev_b32 v252, 16, v114
    v_and_b32 v253, 0xffff0000, v114
    v_fma_f32 v252, v252, v96, v248
    v_fma_f32 v253, v253, v97, v249
    v_cvt_pk_bf16_f32 v114, v252, v253
    v_lshlrev_b32 v252, 16, v115
    v_and_b32 v253, 0xffff0000, v115
    v_fma_f32 v252, v252, v98, v250
    v_fma_f32 v253, v253, v99, v251
    v_cvt_pk_bf16_f32 v115, v252, v253
    v_lshlrev_b32 v252, 16, v184
    v_and_b32 v253, 0xffff0000, v184
    v_fma_f32 v252, v252, v92, v244
    v_fma_f32 v253, v253, v93, v245
    v_cvt_pk_bf16_f32 v184, v252, v253
    v_lshlrev_b32 v252, 16, v185
    v_and_b32 v253, 0xffff0000, v185
    v_fma_f32 v252, v252, v94, v246
    v_fma_f32 v253, v253, v95, v247
    v_cvt_pk_bf16_f32 v185, v252, v253
    v_lshlrev_b32 v252, 16, v186
    v_and_b32 v253, 0xffff0000, v186
    v_fma_f32 v252, v252, v96, v248
    v_fma_f32 v253, v253, v97, v249
    v_cvt_pk_bf16_f32 v186, v252, v253
    v_lshlrev_b32 v252, 16, v187
    v_and_b32 v253, 0xffff0000, v187
    v_fma_f32 v252, v252, v98, v250
    v_fma_f32 v253, v253, v99, v251
    v_cvt_pk_bf16_f32 v187, v252, v253
    ds_read_b128 v[244:247], v90 offset:2560
    ds_read_b128 v[248:251], v90 offset:2576
    ds_read_b128 v[92:95], v90 offset:4864
    ds_read_b128 v[96:99], v90 offset:4880
    s_waitcnt lgkmcnt(0)
    v_lshlrev_b32 v252, 16, v116
    v_and_b32 v253, 0xffff0000, v116
    v_fma_f32 v252, v252, v92, v244
    v_fma_f32 v253, v253, v93, v245
    v_cvt_pk_bf16_f32 v116, v252, v253
    v_lshlrev_b32 v252, 16, v117
    v_and_b32 v253, 0xffff0000, v117
    v_fma_f32 v252, v252, v94, v246
    v_fma_f32 v253, v253, v95, v247
    v_cvt_pk_bf16_f32 v117, v252, v253
    v_lshlrev_b32 v252, 16, v118
    v_and_b32 v253, 0xffff0000, v118
    v_fma_f32 v252, v252, v96, v248
    v_fma_f32 v253, v253, v97, v249
    v_cvt_pk_bf16_f32 v118, v252, v253
    v_lshlrev_b32 v252, 16, v119
    v_and_b32 v253, 0xffff0000, v119
    v_fma_f32 v252, v252, v98, v250
    v_fma_f32 v253, v253, v99, v251
    v_cvt_pk_bf16_f32 v119, v252, v253
    v_lshlrev_b32 v252, 16, v188
    v_and_b32 v253, 0xffff0000, v188
    v_fma_f32 v252, v252, v92, v244
    v_fma_f32 v253, v253, v93, v245
    v_cvt_pk_bf16_f32 v188, v252, v253
    v_lshlrev_b32 v252, 16, v189
    v_and_b32 v253, 0xffff0000, v189
    v_fma_f32 v252, v252, v94, v246
    v_fma_f32 v253, v253, v95, v247
    v_cvt_pk_bf16_f32 v189, v252, v253
    v_lshlrev_b32 v252, 16, v190
    v_and_b32 v253, 0xffff0000, v190
    v_fma_f32 v252, v252, v96, v248
    v_fma_f32 v253, v253, v97, v249
    v_cvt_pk_bf16_f32 v190, v252, v253
    v_lshlrev_b32 v252, 16, v191
    v_and_b32 v253, 0xffff0000, v191
    v_fma_f32 v252, v252, v98, v250
    v_fma_f32 v253, v253, v99, v251
    v_cvt_pk_bf16_f32 v191, v252, v253
    ds_read_b128 v[244:247], v90 offset:2688
    ds_read_b128 v[248:251], v90 offset:2704
    ds_read_b128 v[92:95], v90 offset:4992
    ds_read_b128 v[96:99], v90 offset:5008
    s_waitcnt lgkmcnt(0)
    v_lshlrev_b32 v252, 16, v120
    v_and_b32 v253, 0xffff0000, v120
    v_fma_f32 v252, v252, v92, v244
    v_fma_f32 v253, v253, v93, v245
    v_cvt_pk_bf16_f32 v120, v252, v253
    v_lshlrev_b32 v252, 16, v121
    v_and_b32 v253, 0xffff0000, v121
    v_fma_f32 v252, v252, v94, v246
    v_fma_f32 v253, v253, v95, v247
    v_cvt_pk_bf16_f32 v121, v252, v253
    v_lshlrev_b32 v252, 16, v122
    v_and_b32 v253, 0xffff0000, v122
    v_fma_f32 v252, v252, v96, v248
    v_fma_f32 v253, v253, v97, v249
    v_cvt_pk_bf16_f32 v122, v252, v253
    v_lshlrev_b32 v252, 16, v123
    v_and_b32 v253, 0xffff0000, v123
    v_fma_f32 v252, v252, v98, v250
    v_fma_f32 v253, v253, v99, v251
    v_cvt_pk_bf16_f32 v123, v252, v253
    v_lshlrev_b32 v252, 16, v192
    v_and_b32 v253, 0xffff0000, v192
    v_fma_f32 v252, v252, v92, v244
    v_fma_f32 v253, v253, v93, v245
    v_cvt_pk_bf16_f32 v192, v252, v253
    v_lshlrev_b32 v252, 16, v193
    v_and_b32 v253, 0xffff0000, v193
    v_fma_f32 v252, v252, v94, v246
    v_fma_f32 v253, v253, v95, v247
    v_cvt_pk_bf16_f32 v193, v252, v253
    v_lshlrev_b32 v252, 16, v194
    v_and_b32 v253, 0xffff0000, v194
    v_fma_f32 v252, v252, v96, v248
    v_fma_f32 v253, v253, v97, v249
    v_cvt_pk_bf16_f32 v194, v252, v253
    v_lshlrev_b32 v252, 16, v195
    v_and_b32 v253, 0xffff0000, v195
    v_fma_f32 v252, v252, v98, v250
    v_fma_f32 v253, v253, v99, v251
    v_cvt_pk_bf16_f32 v195, v252, v253
    s_barrier
    s_mov_b32 s43, 12288
    buffer_load_dwordx4 v[148:151], v6, s[16:19], s43 offen offset:0
    buffer_load_dwordx4 v[152:155], v6, s[16:19], s43 offen offset:1024
    buffer_load_dwordx4 v[156:159], v6, s[16:19], s43 offen offset:2048
    s_mov_b32 s43, 15360
    buffer_load_dwordx4 v[160:163], v6, s[16:19], s43 offen offset:0
    buffer_load_dwordx4 v[164:167], v6, s[16:19], s43 offen offset:1024
    buffer_load_dwordx4 v[168:171], v6, s[16:19], s43 offen offset:2048
    s_mov_b32 s43, 30720
    buffer_load_dwordx4 v[220:223], v6, s[16:19], s43 offen offset:0
    buffer_load_dwordx4 v[224:227], v6, s[16:19], s43 offen offset:1024
    buffer_load_dwordx4 v[228:231], v6, s[16:19], s43 offen offset:2048
    s_mov_b32 s43, 33792
    buffer_load_dwordx4 v[232:235], v6, s[16:19], s43 offen offset:0
    buffer_load_dwordx4 v[236:239], v6, s[16:19], s43 offen offset:1024
    buffer_load_dwordx4 v[240:243], v6, s[16:19], s43 offen offset:2048
    s_mov_b32 s50, 98304
    s_add_u32 m0, s51, 98304
    s_nop 0
    buffer_load_dwordx4 v76, s[12:15], s50 offen lds
    s_mov_b32 s50, 99328
    s_add_u32 m0, s51, 99328
    s_nop 0
    buffer_load_dwordx4 v76, s[12:15], s50 offen lds
    s_mov_b32 s50, 100352
    s_add_u32 m0, s51, 100352
    s_nop 0
    buffer_load_dwordx4 v76, s[12:15], s50 offen lds
    s_mov_b32 s50, 101376
    s_add_u32 m0, s51, 101376
    s_nop 0
    buffer_load_dwordx4 v76, s[12:15], s50 offen lds
    s_mov_b32 s50, 102400
    s_add_u32 m0, s51, 102400
    s_nop 0
    buffer_load_dwordx4 v76, s[12:15], s50 offen lds
    s_mov_b32 s50, 103424
    s_add_u32 m0, s51, 103424
    s_nop 0
    buffer_load_dwordx4 v76, s[12:15], s50 offen lds
    s_mov_b32 s50, 104448
    s_add_u32 m0, s51, 104448
    s_nop 0
    buffer_load_dwordx4 v76, s[12:15], s50 offen lds
    s_mov_b32 s50, 105472
    s_add_u32 m0, s51, 105472
    s_nop 0
    buffer_load_dwordx4 v76, s[12:15], s50 offen lds
    s_mov_b32 s50, 106496
    s_add_u32 m0, s51, 106496
    s_nop 0
    buffer_load_dwordx4 v76, s[12:15], s50 offen lds
    s_mov_b32 s50, 107520
    s_add_u32 m0, s51, 107520
    s_nop 0
    buffer_load_dwordx4 v76, s[12:15], s50 offen lds
    s_mov_b32 s50, 108544
    s_add_u32 m0, s51, 108544
    s_nop 0
    buffer_load_dwordx4 v76, s[12:15], s50 offen lds
    s_mov_b32 s50, 109568
    s_add_u32 m0, s51, 109568
    s_nop 0
    buffer_load_dwordx4 v76, s[12:15], s50 offen lds
    s_waitcnt vmcnt(36)
    ds_read_b64_tr_b16 v[8:9], v88 offset:0
    ds_read_b64_tr_b16 v[10:11], v88 offset:512
    ds_read_b64_tr_b16 v[12:13], v88 offset:1024
    ds_read_b64_tr_b16 v[14:15], v88 offset:1536
    ds_read_b64_tr_b16 v[16:17], v88 offset:2048
    ds_read_b64_tr_b16 v[18:19], v88 offset:2560
    ds_read_b64_tr_b16 v[20:21], v88 offset:3072
    ds_read_b64_tr_b16 v[22:23], v88 offset:3584
    s_waitcnt lgkmcnt(6)
    v_mfma_f32_16x16x32_bf16 v[24:27], v[8:11], v[100:103], 0
    v_mfma_f32_16x16x32_bf16 v[28:31], v[8:11], v[172:175], 0
    ds_read_b128 v[244:247], v90 offset:2816
    ds_read_b128 v[248:251], v90 offset:2832
    ds_read_b128 v[92:95], v90 offset:5120
    ds_read_b128 v[96:99], v90 offset:5136
    s_waitcnt lgkmcnt(0)
    v_lshlrev_b32 v252, 16, v124
    v_and_b32 v253, 0xffff0000, v124
    ds_read_b64_tr_b16 v[8:9], v88 offset:4096
    ds_read_b64_tr_b16 v[10:11], v88 offset:4608
    v_mfma_f32_16x16x32_bf16 v[32:35], v[12:15], v[100:103], 0
    v_mfma_f32_16x16x32_bf16 v[36:39], v[12:15], v[172:175], 0
    v_fma_f32 v252, v252, v92, v244
    v_fma_f32 v253, v253, v93, v245
    v_cvt_pk_bf16_f32 v124, v252, v253
    v_lshlrev_b32 v252, 16, v125
    v_and_b32 v253, 0xffff0000, v125
    v_fma_f32 v252, v252, v94, v246
    v_fma_f32 v253, v253, v95, v247
    ds_read_b64_tr_b16 v[12:13], v88 offset:5120
    ds_read_b64_tr_b16 v[14:15], v88 offset:5632
    v_mfma_f32_16x16x32_bf16 v[40:43], v[16:19], v[100:103], 0
    v_mfma_f32_16x16x32_bf16 v[44:47], v[16:19], v[172:175], 0
    v_cvt_pk_bf16_f32 v125, v252, v253
    v_lshlrev_b32 v252, 16, v126
    v_and_b32 v253, 0xffff0000, v126
    v_fma_f32 v252, v252, v96, v248
    v_fma_f32 v253, v253, v97, v249
    v_cvt_pk_bf16_f32 v126, v252, v253
    v_lshlrev_b32 v252, 16, v127
    ds_read_b64_tr_b16 v[16:17], v88 offset:6144
    ds_read_b64_tr_b16 v[18:19], v88 offset:6656
    v_mfma_f32_16x16x32_bf16 v[48:51], v[20:23], v[100:103], 0
    v_mfma_f32_16x16x32_bf16 v[52:55], v[20:23], v[172:175], 0
    v_and_b32 v253, 0xffff0000, v127
    v_fma_f32 v252, v252, v98, v250
    v_fma_f32 v253, v253, v99, v251
    v_cvt_pk_bf16_f32 v127, v252, v253
    v_lshlrev_b32 v252, 16, v196
    v_and_b32 v253, 0xffff0000, v196
    v_fma_f32 v252, v252, v92, v244
    ds_read_b64_tr_b16 v[20:21], v88 offset:7168
    ds_read_b64_tr_b16 v[22:23], v88 offset:7680
    s_waitcnt lgkmcnt(6)
    v_mfma_f32_16x16x32_bf16 v[56:59], v[8:11], v[100:103], 0
    v_mfma_f32_16x16x32_bf16 v[60:63], v[8:11], v[172:175], 0
    v_fma_f32 v253, v253, v93, v245
    v_cvt_pk_bf16_f32 v196, v252, v253
    v_lshlrev_b32 v252, 16, v197
    v_and_b32 v253, 0xffff0000, v197
    v_fma_f32 v252, v252, v94, v246
    v_fma_f32 v253, v253, v95, v247
    v_cvt_pk_bf16_f32 v197, v252, v253
    ds_read_b64_tr_b16 v[8:9], v88 offset:8192
    ds_read_b64_tr_b16 v[10:11], v88 offset:8704
    s_waitcnt lgkmcnt(6)
    v_mfma_f32_16x16x32_bf16 v[64:67], v[12:15], v[100:103], 0
    v_mfma_f32_16x16x32_bf16 v[68:71], v[12:15], v[172:175], 0
    v_lshlrev_b32 v252, 16, v198
    v_and_b32 v253, 0xffff0000, v198
    v_fma_f32 v252, v252, v96, v248
    v_fma_f32 v253, v253, v97, v249
    v_cvt_pk_bf16_f32 v198, v252, v253
    v_lshlrev_b32 v252, 16, v199
    v_and_b32 v253, 0xffff0000, v199
    ds_read_b64_tr_b16 v[12:13], v88 offset:9216
    ds_read_b64_tr_b16 v[14:15], v88 offset:9728
    s_waitcnt lgkmcnt(6)
    v_mfma_f32_16x16x32_bf16 v[72:75], v[16:19], v[100:103], 0
    v_mfma_f32_16x16x32_bf16 v[76:79], v[16:19], v[172:175], 0
    v_fma_f32 v252, v252, v98, v250
    v_fma_f32 v253, v253, v99, v251
    v_cvt_pk_bf16_f32 v199, v252, v253
    ds_read_b128 v[244:247], v90 offset:2944
    ds_read_b128 v[248:251], v90 offset:2960
    ds_read_b128 v[92:95], v90 offset:5248
    ds_read_b128 v[96:99], v90 offset:5264
    ds_read_b64_tr_b16 v[16:17], v88 offset:10240
    ds_read_b64_tr_b16 v[18:19], v88 offset:10752
    s_waitcnt lgkmcnt(10)
    v_mfma_f32_16x16x32_bf16 v[80:83], v[20:23], v[100:103], 0
    v_mfma_f32_16x16x32_bf16 v[84:87], v[20:23], v[172:175], 0
    s_waitcnt lgkmcnt(2)
    v_lshlrev_b32 v252, 16, v128
    v_and_b32 v253, 0xffff0000, v128
    v_fma_f32 v252, v252, v92, v244
    v_fma_f32 v253, v253, v93, v245
    v_cvt_pk_bf16_f32 v128, v252, v253
    v_lshlrev_b32 v252, 16, v129
    ds_read_b64_tr_b16 v[20:21], v88 offset:11264
    ds_read_b64_tr_b16 v[22:23], v88 offset:11776
    v_mfma_f32_16x16x32_bf16 v[24:27], v[8:11], v[104:107], v[24:27]
    v_mfma_f32_16x16x32_bf16 v[28:31], v[8:11], v[176:179], v[28:31]
    v_and_b32 v253, 0xffff0000, v129
    v_fma_f32 v252, v252, v94, v246
    v_fma_f32 v253, v253, v95, v247
    v_cvt_pk_bf16_f32 v129, v252, v253
    v_lshlrev_b32 v252, 16, v130
    v_and_b32 v253, 0xffff0000, v130
    v_fma_f32 v252, v252, v96, v248
    ds_read_b64_tr_b16 v[8:9], v88 offset:12288
    ds_read_b64_tr_b16 v[10:11], v88 offset:12800
    v_mfma_f32_16x16x32_bf16 v[32:35], v[12:15], v[104:107], v[32:35]
    v_mfma_f32_16x16x32_bf16 v[36:39], v[12:15], v[176:179], v[36:39]
    v_fma_f32 v253, v253, v97, v249
    v_cvt_pk_bf16_f32 v130, v252, v253
    v_lshlrev_b32 v252, 16, v131
    v_and_b32 v253, 0xffff0000, v131
    v_fma_f32 v252, v252, v98, v250
    v_fma_f32 v253, v253, v99, v251
    v_cvt_pk_bf16_f32 v131, v252, v253
    ds_read_b64_tr_b16 v[12:13], v88 offset:13312
    ds_read_b64_tr_b16 v[14:15], v88 offset:13824
    s_waitcnt lgkmcnt(6)
    v_mfma_f32_16x16x32_bf16 v[40:43], v[16:19], v[104:107], v[40:43]
    v_mfma_f32_16x16x32_bf16 v[44:47], v[16:19], v[176:179], v[44:47]
    v_lshlrev_b32 v252, 16, v200
    v_and_b32 v253, 0xffff0000, v200
    v_fma_f32 v252, v252, v92, v244
    v_fma_f32 v253, v253, v93, v245
    v_cvt_pk_bf16_f32 v200, v252, v253
    v_lshlrev_b32 v252, 16, v201
    v_and_b32 v253, 0xffff0000, v201
    ds_read_b64_tr_b16 v[16:17], v88 offset:14336
    ds_read_b64_tr_b16 v[18:19], v88 offset:14848
    s_waitcnt lgkmcnt(6)
    v_mfma_f32_16x16x32_bf16 v[48:51], v[20:23], v[104:107], v[48:51]
    v_mfma_f32_16x16x32_bf16 v[52:55], v[20:23], v[176:179], v[52:55]
    v_fma_f32 v252, v252, v94, v246
    v_fma_f32 v253, v253, v95, v247
    v_cvt_pk_bf16_f32 v201, v252, v253
    v_lshlrev_b32 v252, 16, v202
    v_and_b32 v253, 0xffff0000, v202
    v_fma_f32 v252, v252, v96, v248
    v_fma_f32 v253, v253, v97, v249
    ds_read_b64_tr_b16 v[20:21], v88 offset:15360
    ds_read_b64_tr_b16 v[22:23], v88 offset:15872
    s_waitcnt lgkmcnt(6)
    v_mfma_f32_16x16x32_bf16 v[56:59], v[8:11], v[104:107], v[56:59]
    v_mfma_f32_16x16x32_bf16 v[60:63], v[8:11], v[176:179], v[60:63]
    v_cvt_pk_bf16_f32 v202, v252, v253
    v_lshlrev_b32 v252, 16, v203
    v_and_b32 v253, 0xffff0000, v203
    v_fma_f32 v252, v252, v98, v250
    v_fma_f32 v253, v253, v99, v251
    v_cvt_pk_bf16_f32 v203, v252, v253
    ds_read_b128 v[244:247], v90 offset:3072
    ds_read_b64_tr_b16 v[8:9], v88 offset:16384
    ds_read_b64_tr_b16 v[10:11], v88 offset:16896
    s_waitcnt lgkmcnt(7)
    v_mfma_f32_16x16x32_bf16 v[64:67], v[12:15], v[104:107], v[64:67]
    v_mfma_f32_16x16x32_bf16 v[68:71], v[12:15], v[176:179], v[68:71]
    ds_read_b128 v[248:251], v90 offset:3088
    ds_read_b128 v[92:95], v90 offset:5376
    ds_read_b128 v[96:99], v90 offset:5392
    s_waitcnt lgkmcnt(0)
    v_lshlrev_b32 v252, 16, v132
    v_and_b32 v253, 0xffff0000, v132
    v_fma_f32 v252, v252, v92, v244
    ds_read_b64_tr_b16 v[12:13], v88 offset:17408
    ds_read_b64_tr_b16 v[14:15], v88 offset:17920
    v_mfma_f32_16x16x32_bf16 v[72:75], v[16:19], v[104:107], v[72:75]
    v_mfma_f32_16x16x32_bf16 v[76:79], v[16:19], v[176:179], v[76:79]
    v_fma_f32 v253, v253, v93, v245
    v_cvt_pk_bf16_f32 v132, v252, v253
    v_lshlrev_b32 v252, 16, v133
    v_and_b32 v253, 0xffff0000, v133
    v_fma_f32 v252, v252, v94, v246
    v_fma_f32 v253, v253, v95, v247
    v_cvt_pk_bf16_f32 v133, v252, v253
    ds_read_b64_tr_b16 v[16:17], v88 offset:18432
    ds_read_b64_tr_b16 v[18:19], v88 offset:18944
    v_mfma_f32_16x16x32_bf16 v[80:83], v[20:23], v[104:107], v[80:83]
    v_mfma_f32_16x16x32_bf16 v[84:87], v[20:23], v[176:179], v[84:87]
    v_lshlrev_b32 v252, 16, v134
    v_and_b32 v253, 0xffff0000, v134
    v_fma_f32 v252, v252, v96, v248
    v_fma_f32 v253, v253, v97, v249
    v_cvt_pk_bf16_f32 v134, v252, v253
    v_lshlrev_b32 v252, 16, v135
    v_and_b32 v253, 0xffff0000, v135
    ds_read_b64_tr_b16 v[20:21], v88 offset:19456
    ds_read_b64_tr_b16 v[22:23], v88 offset:19968
    v_mfma_f32_16x16x32_bf16 v[24:27], v[8:11], v[108:111], v[24:27]
    v_mfma_f32_16x16x32_bf16 v[28:31], v[8:11], v[180:183], v[28:31]
    v_fma_f32 v252, v252, v98, v250
    v_fma_f32 v253, v253, v99, v251
    v_cvt_pk_bf16_f32 v135, v252, v253
    v_lshlrev_b32 v252, 16, v204
    v_and_b32 v253, 0xffff0000, v204
    v_fma_f32 v252, v252, v92, v244
    v_fma_f32 v253, v253, v93, v245
    ds_read_b64_tr_b16 v[8:9], v88 offset:20480
    ds_read_b64_tr_b16 v[10:11], v88 offset:20992
    s_waitcnt lgkmcnt(6)
    v_mfma_f32_16x16x32_bf16 v[32:35], v[12:15], v[108:111], v[32:35]
    v_mfma_f32_16x16x32_bf16 v[36:39], v[12:15], v[180:183], v[36:39]
    v_cvt_pk_bf16_f32 v204, v252, v253
    v_lshlrev_b32 v252, 16, v205
    v_and_b32 v253, 0xffff0000, v205
    v_fma_f32 v252, v252, v94, v246
    v_fma_f32 v253, v253, v95, v247
    v_cvt_pk_bf16_f32 v205, v252, v253
    v_lshlrev_b32 v252, 16, v206
    ds_read_b64_tr_b16 v[12:13], v88 offset:21504
    ds_read_b64_tr_b16 v[14:15], v88 offset:22016
    s_waitcnt lgkmcnt(6)
    v_mfma_f32_16x16x32_bf16 v[40:43], v[16:19], v[108:111], v[40:43]
    v_mfma_f32_16x16x32_bf16 v[44:47], v[16:19], v[180:183], v[44:47]
    v_and_b32 v253, 0xffff0000, v206
    v_fma_f32 v252, v252, v96, v248
    v_fma_f32 v253, v253, v97, v249
    v_cvt_pk_bf16_f32 v206, v252, v253
    v_lshlrev_b32 v252, 16, v207
    v_and_b32 v253, 0xffff0000, v207
    v_fma_f32 v252, v252, v98, v250
    ds_read_b64_tr_b16 v[16:17], v88 offset:22528
    ds_read_b64_tr_b16 v[18:19], v88 offset:23040
    s_waitcnt lgkmcnt(6)
    v_mfma_f32_16x16x32_bf16 v[48:51], v[20:23], v[108:111], v[48:51]
    v_mfma_f32_16x16x32_bf16 v[52:55], v[20:23], v[180:183], v[52:55]
    v_fma_f32 v253, v253, v99, v251
    v_cvt_pk_bf16_f32 v207, v252, v253
    ds_read_b128 v[244:247], v90 offset:3200
    ds_read_b128 v[248:251], v90 offset:3216
    ds_read_b128 v[92:95], v90 offset:5504
    ds_read_b128 v[96:99], v90 offset:5520
    s_waitcnt lgkmcnt(0)
    ds_read_b64_tr_b16 v[20:21], v88 offset:23552
    ds_read_b64_tr_b16 v[22:23], v88 offset:24064
    v_mfma_f32_16x16x32_bf16 v[56:59], v[8:11], v[108:111], v[56:59]
    v_mfma_f32_16x16x32_bf16 v[60:63], v[8:11], v[180:183], v[60:63]
    v_lshlrev_b32 v252, 16, v136
    v_and_b32 v253, 0xffff0000, v136
    v_fma_f32 v252, v252, v92, v244
    v_fma_f32 v253, v253, v93, v245
    v_cvt_pk_bf16_f32 v136, v252, v253
    v_lshlrev_b32 v252, 16, v137
    v_and_b32 v253, 0xffff0000, v137
    ds_read_b64_tr_b16 v[8:9], v88 offset:24576
    ds_read_b64_tr_b16 v[10:11], v88 offset:25088
    v_mfma_f32_16x16x32_bf16 v[64:67], v[12:15], v[108:111], v[64:67]
    v_mfma_f32_16x16x32_bf16 v[68:71], v[12:15], v[180:183], v[68:71]
    v_fma_f32 v252, v252, v94, v246
    v_fma_f32 v253, v253, v95, v247
    v_cvt_pk_bf16_f32 v137, v252, v253
    v_lshlrev_b32 v252, 16, v138
    v_and_b32 v253, 0xffff0000, v138
    v_fma_f32 v252, v252, v96, v248
    v_fma_f32 v253, v253, v97, v249
    ds_read_b64_tr_b16 v[12:13], v88 offset:25600
    ds_read_b64_tr_b16 v[14:15], v88 offset:26112
    v_mfma_f32_16x16x32_bf16 v[72:75], v[16:19], v[108:111], v[72:75]
    v_mfma_f32_16x16x32_bf16 v[76:79], v[16:19], v[180:183], v[76:79]
    v_cvt_pk_bf16_f32 v138, v252, v253
    v_lshlrev_b32 v252, 16, v139
    v_and_b32 v253, 0xffff0000, v139
    v_fma_f32 v252, v252, v98, v250
    v_fma_f32 v253, v253, v99, v251
    v_cvt_pk_bf16_f32 v139, v252, v253
    v_lshlrev_b32 v252, 16, v208
    ds_read_b64_tr_b16 v[16:17], v88 offset:26624
    ds_read_b64_tr_b16 v[18:19], v88 offset:27136
    s_waitcnt lgkmcnt(6)
    v_mfma_f32_16x16x32_bf16 v[80:83], v[20:23], v[108:111], v[80:83]
    v_mfma_f32_16x16x32_bf16 v[84:87], v[20:23], v[180:183], v[84:87]
    v_and_b32 v253, 0xffff0000, v208
    v_fma_f32 v252, v252, v92, v244
    v_fma_f32 v253, v253, v93, v245
    v_cvt_pk_bf16_f32 v208, v252, v253
    v_lshlrev_b32 v252, 16, v209
    v_and_b32 v253, 0xffff0000, v209
    v_fma_f32 v252, v252, v94, v246
    ds_read_b64_tr_b16 v[20:21], v88 offset:27648
    ds_read_b64_tr_b16 v[22:23], v88 offset:28160
    s_waitcnt lgkmcnt(6)
    v_mfma_f32_16x16x32_bf16 v[24:27], v[8:11], v[112:115], v[24:27]
    v_mfma_f32_16x16x32_bf16 v[28:31], v[8:11], v[184:187], v[28:31]
    v_fma_f32 v253, v253, v95, v247
    v_cvt_pk_bf16_f32 v209, v252, v253
    v_lshlrev_b32 v252, 16, v210
    v_and_b32 v253, 0xffff0000, v210
    v_fma_f32 v252, v252, v96, v248
    v_fma_f32 v253, v253, v97, v249
    v_cvt_pk_bf16_f32 v210, v252, v253
    ds_read_b64_tr_b16 v[8:9], v88 offset:28672
    ds_read_b64_tr_b16 v[10:11], v88 offset:29184
    s_waitcnt lgkmcnt(6)
    v_mfma_f32_16x16x32_bf16 v[32:35], v[12:15], v[112:115], v[32:35]
    v_mfma_f32_16x16x32_bf16 v[36:39], v[12:15], v[184:187], v[36:39]
    v_lshlrev_b32 v252, 16, v211
    v_and_b32 v253, 0xffff0000, v211
    v_fma_f32 v252, v252, v98, v250
    v_fma_f32 v253, v253, v99, v251
    v_cvt_pk_bf16_f32 v211, v252, v253
    ds_read_b128 v[244:247], v90 offset:3328
    ds_read_b128 v[248:251], v90 offset:3344
    ds_read_b64_tr_b16 v[12:13], v88 offset:29696
    ds_read_b64_tr_b16 v[14:15], v88 offset:30208
    s_waitcnt lgkmcnt(8)
    v_mfma_f32_16x16x32_bf16 v[40:43], v[16:19], v[112:115], v[40:43]
    v_mfma_f32_16x16x32_bf16 v[44:47], v[16:19], v[184:187], v[44:47]
    ds_read_b128 v[92:95], v90 offset:5632
    ds_read_b128 v[96:99], v90 offset:5648
    s_waitcnt lgkmcnt(0)
    v_lshlrev_b32 v252, 16, v140
    v_and_b32 v253, 0xffff0000, v140
    v_fma_f32 v252, v252, v92, v244
    v_fma_f32 v253, v253, v93, v245
    ds_read_b64_tr_b16 v[16:17], v88 offset:30720
    ds_read_b64_tr_b16 v[18:19], v88 offset:31232
    v_mfma_f32_16x16x32_bf16 v[48:51], v[20:23], v[112:115], v[48:51]
    v_mfma_f32_16x16x32_bf16 v[52:55], v[20:23], v[184:187], v[52:55]
    v_cvt_pk_bf16_f32 v140, v252, v253
    v_lshlrev_b32 v252, 16, v141
    v_and_b32 v253, 0xffff0000, v141
    v_fma_f32 v252, v252, v94, v246
    v_fma_f32 v253, v253, v95, v247
    v_cvt_pk_bf16_f32 v141, v252, v253
    v_lshlrev_b32 v252, 16, v142
    ds_read_b64_tr_b16 v[20:21], v88 offset:31744
    ds_read_b64_tr_b16 v[22:23], v88 offset:32256
    v_mfma_f32_16x16x32_bf16 v[56:59], v[8:11], v[112:115], v[56:59]
    v_mfma_f32_16x16x32_bf16 v[60:63], v[8:11], v[184:187], v[60:63]
    v_and_b32 v253, 0xffff0000, v142
    v_fma_f32 v252, v252, v96, v248
    v_fma_f32 v253, v253, v97, v249
    v_cvt_pk_bf16_f32 v142, v252, v253
    v_lshlrev_b32 v252, 16, v143
    v_and_b32 v253, 0xffff0000, v143
    v_fma_f32 v252, v252, v98, v250
    ds_read_b64_tr_b16 v[8:9], v88 offset:32768
    ds_read_b64_tr_b16 v[10:11], v88 offset:33280
    v_mfma_f32_16x16x32_bf16 v[64:67], v[12:15], v[112:115], v[64:67]
    v_mfma_f32_16x16x32_bf16 v[68:71], v[12:15], v[184:187], v[68:71]
    v_fma_f32 v253, v253, v99, v251
    v_cvt_pk_bf16_f32 v143, v252, v253
    v_lshlrev_b32 v252, 16, v212
    v_and_b32 v253, 0xffff0000, v212
    v_fma_f32 v252, v252, v92, v244
    v_fma_f32 v253, v253, v93, v245
    v_cvt_pk_bf16_f32 v212, v252, v253
    ds_read_b64_tr_b16 v[12:13], v88 offset:33792
    ds_read_b64_tr_b16 v[14:15], v88 offset:34304
    s_waitcnt lgkmcnt(6)
    v_mfma_f32_16x16x32_bf16 v[72:75], v[16:19], v[112:115], v[72:75]
    v_mfma_f32_16x16x32_bf16 v[76:79], v[16:19], v[184:187], v[76:79]
    v_lshlrev_b32 v252, 16, v213
    v_and_b32 v253, 0xffff0000, v213
    v_fma_f32 v252, v252, v94, v246
    v_fma_f32 v253, v253, v95, v247
    v_cvt_pk_bf16_f32 v213, v252, v253
    v_lshlrev_b32 v252, 16, v214
    v_and_b32 v253, 0xffff0000, v214
    ds_read_b64_tr_b16 v[16:17], v88 offset:34816
    ds_read_b64_tr_b16 v[18:19], v88 offset:35328
    s_waitcnt lgkmcnt(6)
    v_mfma_f32_16x16x32_bf16 v[80:83], v[20:23], v[112:115], v[80:83]
    v_mfma_f32_16x16x32_bf16 v[84:87], v[20:23], v[184:187], v[84:87]
    v_fma_f32 v252, v252, v96, v248
    v_fma_f32 v253, v253, v97, v249
    v_cvt_pk_bf16_f32 v214, v252, v253
    v_lshlrev_b32 v252, 16, v215
    v_and_b32 v253, 0xffff0000, v215
    v_fma_f32 v252, v252, v98, v250
    v_fma_f32 v253, v253, v99, v251
    ds_read_b64_tr_b16 v[20:21], v88 offset:35840
    ds_read_b64_tr_b16 v[22:23], v88 offset:36352
    s_waitcnt lgkmcnt(6)
    v_mfma_f32_16x16x32_bf16 v[24:27], v[8:11], v[116:119], v[24:27]
    v_mfma_f32_16x16x32_bf16 v[28:31], v[8:11], v[188:191], v[28:31]
    v_cvt_pk_bf16_f32 v215, v252, v253
    ds_read_b128 v[244:247], v90 offset:3456
    ds_read_b128 v[248:251], v90 offset:3472
    ds_read_b128 v[92:95], v90 offset:5760
    ds_read_b128 v[96:99], v90 offset:5776
    s_waitcnt lgkmcnt(0)
    v_lshlrev_b32 v252, 16, v144
    ds_read_b64_tr_b16 v[8:9], v88 offset:36864
    ds_read_b64_tr_b16 v[10:11], v88 offset:37376
    v_mfma_f32_16x16x32_bf16 v[32:35], v[12:15], v[116:119], v[32:35]
    v_mfma_f32_16x16x32_bf16 v[36:39], v[12:15], v[188:191], v[36:39]
    v_and_b32 v253, 0xffff0000, v144
    v_fma_f32 v252, v252, v92, v244
    v_fma_f32 v253, v253, v93, v245
    v_cvt_pk_bf16_f32 v144, v252, v253
    v_lshlrev_b32 v252, 16, v145
    v_and_b32 v253, 0xffff0000, v145
    v_fma_f32 v252, v252, v94, v246
    ds_read_b64_tr_b16 v[12:13], v88 offset:37888
    ds_read_b64_tr_b16 v[14:15], v88 offset:38400
    v_mfma_f32_16x16x32_bf16 v[40:43], v[16:19], v[116:119], v[40:43]
    v_mfma_f32_16x16x32_bf16 v[44:47], v[16:19], v[188:191], v[44:47]
    v_fma_f32 v253, v253, v95, v247
    v_cvt_pk_bf16_f32 v145, v252, v253
    v_lshlrev_b32 v252, 16, v146
    v_and_b32 v253, 0xffff0000, v146
    v_fma_f32 v252, v252, v96, v248
    v_fma_f32 v253, v253, v97, v249
    v_cvt_pk_bf16_f32 v146, v252, v253
    ds_read_b64_tr_b16 v[16:17], v88 offset:38912
    ds_read_b64_tr_b16 v[18:19], v88 offset:39424
    v_mfma_f32_16x16x32_bf16 v[48:51], v[20:23], v[116:119], v[48:51]
    v_mfma_f32_16x16x32_bf16 v[52:55], v[20:23], v[188:191], v[52:55]
    v_lshlrev_b32 v252, 16, v147
    v_and_b32 v253, 0xffff0000, v147
    v_fma_f32 v252, v252, v98, v250
    v_fma_f32 v253, v253, v99, v251
    v_cvt_pk_bf16_f32 v147, v252, v253
    v_lshlrev_b32 v252, 16, v216
    v_and_b32 v253, 0xffff0000, v216
    ds_read_b64_tr_b16 v[20:21], v88 offset:39936
    ds_read_b64_tr_b16 v[22:23], v88 offset:40448
    s_waitcnt lgkmcnt(6)
    v_mfma_f32_16x16x32_bf16 v[56:59], v[8:11], v[116:119], v[56:59]
    v_mfma_f32_16x16x32_bf16 v[60:63], v[8:11], v[188:191], v[60:63]
    v_fma_f32 v252, v252, v92, v244
    v_fma_f32 v253, v253, v93, v245
    v_cvt_pk_bf16_f32 v216, v252, v253
    v_lshlrev_b32 v252, 16, v217
    v_and_b32 v253, 0xffff0000, v217
    v_fma_f32 v252, v252, v94, v246
    v_fma_f32 v253, v253, v95, v247
    ds_read_b64_tr_b16 v[8:9], v88 offset:40960
    ds_read_b64_tr_b16 v[10:11], v88 offset:41472
    s_waitcnt lgkmcnt(6)
    v_mfma_f32_16x16x32_bf16 v[64:67], v[12:15], v[116:119], v[64:67]
    v_mfma_f32_16x16x32_bf16 v[68:71], v[12:15], v[188:191], v[68:71]
    v_cvt_pk_bf16_f32 v217, v252, v253
    v_lshlrev_b32 v252, 16, v218
    v_and_b32 v253, 0xffff0000, v218
    v_fma_f32 v252, v252, v96, v248
    v_fma_f32 v253, v253, v97, v249
    v_cvt_pk_bf16_f32 v218, v252, v253
    v_lshlrev_b32 v252, 16, v219
    ds_read_b64_tr_b16 v[12:13], v88 offset:41984
    ds_read_b64_tr_b16 v[14:15], v88 offset:42496
    s_waitcnt lgkmcnt(6)
    v_mfma_f32_16x16x32_bf16 v[72:75], v[16:19], v[116:119], v[72:75]
    v_mfma_f32_16x16x32_bf16 v[76:79], v[16:19], v[188:191], v[76:79]
    v_and_b32 v253, 0xffff0000, v219
    v_fma_f32 v252, v252, v98, v250
    v_fma_f32 v253, v253, v99, v251
    v_cvt_pk_bf16_f32 v219, v252, v253
    ds_read_b64_tr_b16 v[16:17], v88 offset:43008
    ds_read_b64_tr_b16 v[18:19], v88 offset:43520
    s_waitcnt lgkmcnt(6)
    v_mfma_f32_16x16x32_bf16 v[80:83], v[20:23], v[116:119], v[80:83]
    v_mfma_f32_16x16x32_bf16 v[84:87], v[20:23], v[188:191], v[84:87]
    ds_read_b64_tr_b16 v[20:21], v88 offset:44032
    ds_read_b64_tr_b16 v[22:23], v88 offset:44544
    s_waitcnt lgkmcnt(6)
    v_mfma_f32_16x16x32_bf16 v[24:27], v[8:11], v[120:123], v[24:27]
    v_mfma_f32_16x16x32_bf16 v[28:31], v[8:11], v[192:195], v[28:31]
    ds_read_b64_tr_b16 v[8:9], v88 offset:45056
    ds_read_b64_tr_b16 v[10:11], v88 offset:45568
    s_waitcnt lgkmcnt(6)
    v_mfma_f32_16x16x32_bf16 v[32:35], v[12:15], v[120:123], v[32:35]
    v_mfma_f32_16x16x32_bf16 v[36:39], v[12:15], v[192:195], v[36:39]
    ds_read_b64_tr_b16 v[12:13], v88 offset:46080
    ds_read_b64_tr_b16 v[14:15], v88 offset:46592
    s_waitcnt lgkmcnt(6)
    v_mfma_f32_16x16x32_bf16 v[40:43], v[16:19], v[120:123], v[40:43]
    v_mfma_f32_16x16x32_bf16 v[44:47], v[16:19], v[192:195], v[44:47]
    ds_read_b64_tr_b16 v[16:17], v88 offset:47104
    ds_read_b64_tr_b16 v[18:19], v88 offset:47616
    s_waitcnt lgkmcnt(6)
    v_mfma_f32_16x16x32_bf16 v[48:51], v[20:23], v[120:123], v[48:51]
    v_mfma_f32_16x16x32_bf16 v[52:55], v[20:23], v[192:195], v[52:55]
    ds_read_b64_tr_b16 v[20:21], v88 offset:48128
    ds_read_b64_tr_b16 v[22:23], v88 offset:48640
    s_waitcnt lgkmcnt(6)
    v_mfma_f32_16x16x32_bf16 v[56:59], v[8:11], v[120:123], v[56:59]
    v_mfma_f32_16x16x32_bf16 v[60:63], v[8:11], v[192:195], v[60:63]
    s_waitcnt lgkmcnt(4)
    v_mfma_f32_16x16x32_bf16 v[64:67], v[12:15], v[120:123], v[64:67]
    v_mfma_f32_16x16x32_bf16 v[68:71], v[12:15], v[192:195], v[68:71]
    s_waitcnt lgkmcnt(2)
    v_mfma_f32_16x16x32_bf16 v[72:75], v[16:19], v[120:123], v[72:75]
    v_mfma_f32_16x16x32_bf16 v[76:79], v[16:19], v[192:195], v[76:79]
    s_waitcnt lgkmcnt(0)
    v_mfma_f32_16x16x32_bf16 v[80:83], v[20:23], v[120:123], v[80:83]
    v_mfma_f32_16x16x32_bf16 v[84:87], v[20:23], v[192:195], v[84:87]
    v_add_u32 v88, 49152, v88
    s_waitcnt vmcnt(24)
    s_barrier
    s_waitcnt vmcnt(12)
    ds_read_b64_tr_b16 v[8:9], v88 offset:0
    ds_read_b64_tr_b16 v[10:11], v88 offset:512
    ds_read_b64_tr_b16 v[12:13], v88 offset:1024
    ds_read_b64_tr_b16 v[14:15], v88 offset:1536
    ds_read_b64_tr_b16 v[16:17], v88 offset:2048
    ds_read_b64_tr_b16 v[18:19], v88 offset:2560
    ds_read_b64_tr_b16 v[20:21], v88 offset:3072
    ds_read_b64_tr_b16 v[22:23], v88 offset:3584
    s_waitcnt lgkmcnt(6)
    v_mfma_f32_16x16x32_bf16 v[24:27], v[8:11], v[124:127], v[24:27]
    v_mfma_f32_16x16x32_bf16 v[28:31], v[8:11], v[196:199], v[28:31]
    ds_read_b128 v[244:247], v90 offset:3584
    ds_read_b128 v[248:251], v90 offset:3600
    ds_read_b128 v[92:95], v90 offset:5888
    ds_read_b128 v[96:99], v90 offset:5904
    s_waitcnt lgkmcnt(0)
    v_lshlrev_b32 v252, 16, v148
    v_and_b32 v253, 0xffff0000, v148
    ds_read_b64_tr_b16 v[8:9], v88 offset:4096
    ds_read_b64_tr_b16 v[10:11], v88 offset:4608
    v_mfma_f32_16x16x32_bf16 v[32:35], v[12:15], v[124:127], v[32:35]
    v_mfma_f32_16x16x32_bf16 v[36:39], v[12:15], v[196:199], v[36:39]
    v_fma_f32 v252, v252, v92, v244
    v_fma_f32 v253, v253, v93, v245
    v_cvt_pk_bf16_f32 v148, v252, v253
    v_lshlrev_b32 v252, 16, v149
    v_and_b32 v253, 0xffff0000, v149
    v_fma_f32 v252, v252, v94, v246
    v_fma_f32 v253, v253, v95, v247
    ds_read_b64_tr_b16 v[12:13], v88 offset:5120
    ds_read_b64_tr_b16 v[14:15], v88 offset:5632
    v_mfma_f32_16x16x32_bf16 v[40:43], v[16:19], v[124:127], v[40:43]
    v_mfma_f32_16x16x32_bf16 v[44:47], v[16:19], v[196:199], v[44:47]
    v_cvt_pk_bf16_f32 v149, v252, v253
    v_lshlrev_b32 v252, 16, v150
    v_and_b32 v253, 0xffff0000, v150
    v_fma_f32 v252, v252, v96, v248
    v_fma_f32 v253, v253, v97, v249
    v_cvt_pk_bf16_f32 v150, v252, v253
    v_lshlrev_b32 v252, 16, v151
    ds_read_b64_tr_b16 v[16:17], v88 offset:6144
    ds_read_b64_tr_b16 v[18:19], v88 offset:6656
    v_mfma_f32_16x16x32_bf16 v[48:51], v[20:23], v[124:127], v[48:51]
    v_mfma_f32_16x16x32_bf16 v[52:55], v[20:23], v[196:199], v[52:55]
    v_and_b32 v253, 0xffff0000, v151
    v_fma_f32 v252, v252, v98, v250
    v_fma_f32 v253, v253, v99, v251
    v_cvt_pk_bf16_f32 v151, v252, v253
    v_lshlrev_b32 v252, 16, v220
    v_and_b32 v253, 0xffff0000, v220
    v_fma_f32 v252, v252, v92, v244
    ds_read_b64_tr_b16 v[20:21], v88 offset:7168
    ds_read_b64_tr_b16 v[22:23], v88 offset:7680
    s_waitcnt lgkmcnt(6)
    v_mfma_f32_16x16x32_bf16 v[56:59], v[8:11], v[124:127], v[56:59]
    v_mfma_f32_16x16x32_bf16 v[60:63], v[8:11], v[196:199], v[60:63]
    v_fma_f32 v253, v253, v93, v245
    v_cvt_pk_bf16_f32 v220, v252, v253
    v_lshlrev_b32 v252, 16, v221
    v_and_b32 v253, 0xffff0000, v221
    v_fma_f32 v252, v252, v94, v246
    v_fma_f32 v253, v253, v95, v247
    v_cvt_pk_bf16_f32 v221, v252, v253
    ds_read_b64_tr_b16 v[8:9], v88 offset:8192
    ds_read_b64_tr_b16 v[10:11], v88 offset:8704
    s_waitcnt lgkmcnt(6)
    v_mfma_f32_16x16x32_bf16 v[64:67], v[12:15], v[124:127], v[64:67]
    v_mfma_f32_16x16x32_bf16 v[68:71], v[12:15], v[196:199], v[68:71]
    v_lshlrev_b32 v252, 16, v222
    v_and_b32 v253, 0xffff0000, v222
    v_fma_f32 v252, v252, v96, v248
    v_fma_f32 v253, v253, v97, v249
    v_cvt_pk_bf16_f32 v222, v252, v253
    v_lshlrev_b32 v252, 16, v223
    v_and_b32 v253, 0xffff0000, v223
    ds_read_b64_tr_b16 v[12:13], v88 offset:9216
    ds_read_b64_tr_b16 v[14:15], v88 offset:9728
    s_waitcnt lgkmcnt(6)
    v_mfma_f32_16x16x32_bf16 v[72:75], v[16:19], v[124:127], v[72:75]
    v_mfma_f32_16x16x32_bf16 v[76:79], v[16:19], v[196:199], v[76:79]
    v_fma_f32 v252, v252, v98, v250
    v_fma_f32 v253, v253, v99, v251
    v_cvt_pk_bf16_f32 v223, v252, v253
    ds_read_b128 v[244:247], v90 offset:3712
    ds_read_b128 v[248:251], v90 offset:3728
    ds_read_b128 v[92:95], v90 offset:6016
    ds_read_b128 v[96:99], v90 offset:6032
    ds_read_b64_tr_b16 v[16:17], v88 offset:10240
    ds_read_b64_tr_b16 v[18:19], v88 offset:10752
    s_waitcnt lgkmcnt(10)
    v_mfma_f32_16x16x32_bf16 v[80:83], v[20:23], v[124:127], v[80:83]
    v_mfma_f32_16x16x32_bf16 v[84:87], v[20:23], v[196:199], v[84:87]
    s_waitcnt lgkmcnt(2)
    v_lshlrev_b32 v252, 16, v152
    v_and_b32 v253, 0xffff0000, v152
    v_fma_f32 v252, v252, v92, v244
    v_fma_f32 v253, v253, v93, v245
    v_cvt_pk_bf16_f32 v152, v252, v253
    v_lshlrev_b32 v252, 16, v153
    ds_read_b64_tr_b16 v[20:21], v88 offset:11264
    ds_read_b64_tr_b16 v[22:23], v88 offset:11776
    v_mfma_f32_16x16x32_bf16 v[24:27], v[8:11], v[128:131], v[24:27]
    v_mfma_f32_16x16x32_bf16 v[28:31], v[8:11], v[200:203], v[28:31]
    v_and_b32 v253, 0xffff0000, v153
    v_fma_f32 v252, v252, v94, v246
    v_fma_f32 v253, v253, v95, v247
    v_cvt_pk_bf16_f32 v153, v252, v253
    v_lshlrev_b32 v252, 16, v154
    v_and_b32 v253, 0xffff0000, v154
    v_fma_f32 v252, v252, v96, v248
    ds_read_b64_tr_b16 v[8:9], v88 offset:12288
    ds_read_b64_tr_b16 v[10:11], v88 offset:12800
    v_mfma_f32_16x16x32_bf16 v[32:35], v[12:15], v[128:131], v[32:35]
    v_mfma_f32_16x16x32_bf16 v[36:39], v[12:15], v[200:203], v[36:39]
    v_fma_f32 v253, v253, v97, v249
    v_cvt_pk_bf16_f32 v154, v252, v253
    v_lshlrev_b32 v252, 16, v155
    v_and_b32 v253, 0xffff0000, v155
    v_fma_f32 v252, v252, v98, v250
    v_fma_f32 v253, v253, v99, v251
    v_cvt_pk_bf16_f32 v155, v252, v253
    ds_read_b64_tr_b16 v[12:13], v88 offset:13312
    ds_read_b64_tr_b16 v[14:15], v88 offset:13824
    s_waitcnt lgkmcnt(6)
    v_mfma_f32_16x16x32_bf16 v[40:43], v[16:19], v[128:131], v[40:43]
    v_mfma_f32_16x16x32_bf16 v[44:47], v[16:19], v[200:203], v[44:47]
    v_lshlrev_b32 v252, 16, v224
    v_and_b32 v253, 0xffff0000, v224
    v_fma_f32 v252, v252, v92, v244
    v_fma_f32 v253, v253, v93, v245
    v_cvt_pk_bf16_f32 v224, v252, v253
    v_lshlrev_b32 v252, 16, v225
    v_and_b32 v253, 0xffff0000, v225
    ds_read_b64_tr_b16 v[16:17], v88 offset:14336
    ds_read_b64_tr_b16 v[18:19], v88 offset:14848
    s_waitcnt lgkmcnt(6)
    v_mfma_f32_16x16x32_bf16 v[48:51], v[20:23], v[128:131], v[48:51]
    v_mfma_f32_16x16x32_bf16 v[52:55], v[20:23], v[200:203], v[52:55]
    v_fma_f32 v252, v252, v94, v246
    v_fma_f32 v253, v253, v95, v247
    v_cvt_pk_bf16_f32 v225, v252, v253
    v_lshlrev_b32 v252, 16, v226
    v_and_b32 v253, 0xffff0000, v226
    v_fma_f32 v252, v252, v96, v248
    v_fma_f32 v253, v253, v97, v249
    ds_read_b64_tr_b16 v[20:21], v88 offset:15360
    ds_read_b64_tr_b16 v[22:23], v88 offset:15872
    s_waitcnt lgkmcnt(6)
    v_mfma_f32_16x16x32_bf16 v[56:59], v[8:11], v[128:131], v[56:59]
    v_mfma_f32_16x16x32_bf16 v[60:63], v[8:11], v[200:203], v[60:63]
    v_cvt_pk_bf16_f32 v226, v252, v253
    v_lshlrev_b32 v252, 16, v227
    v_and_b32 v253, 0xffff0000, v227
    v_fma_f32 v252, v252, v98, v250
    v_fma_f32 v253, v253, v99, v251
    v_cvt_pk_bf16_f32 v227, v252, v253
    ds_read_b128 v[244:247], v90 offset:3840
    ds_read_b64_tr_b16 v[8:9], v88 offset:16384
    ds_read_b64_tr_b16 v[10:11], v88 offset:16896
    s_waitcnt lgkmcnt(7)
    v_mfma_f32_16x16x32_bf16 v[64:67], v[12:15], v[128:131], v[64:67]
    v_mfma_f32_16x16x32_bf16 v[68:71], v[12:15], v[200:203], v[68:71]
    ds_read_b128 v[248:251], v90 offset:3856
    ds_read_b128 v[92:95], v90 offset:6144
    ds_read_b128 v[96:99], v90 offset:6160
    s_waitcnt lgkmcnt(0)
    v_lshlrev_b32 v252, 16, v156
    v_and_b32 v253, 0xffff0000, v156
    v_fma_f32 v252, v252, v92, v244
    ds_read_b64_tr_b16 v[12:13], v88 offset:17408
    ds_read_b64_tr_b16 v[14:15], v88 offset:17920
    v_mfma_f32_16x16x32_bf16 v[72:75], v[16:19], v[128:131], v[72:75]
    v_mfma_f32_16x16x32_bf16 v[76:79], v[16:19], v[200:203], v[76:79]
    v_fma_f32 v253, v253, v93, v245
    v_cvt_pk_bf16_f32 v156, v252, v253
    v_lshlrev_b32 v252, 16, v157
    v_and_b32 v253, 0xffff0000, v157
    v_fma_f32 v252, v252, v94, v246
    v_fma_f32 v253, v253, v95, v247
    v_cvt_pk_bf16_f32 v157, v252, v253
    ds_read_b64_tr_b16 v[16:17], v88 offset:18432
    ds_read_b64_tr_b16 v[18:19], v88 offset:18944
    v_mfma_f32_16x16x32_bf16 v[80:83], v[20:23], v[128:131], v[80:83]
    v_mfma_f32_16x16x32_bf16 v[84:87], v[20:23], v[200:203], v[84:87]
    v_lshlrev_b32 v252, 16, v158
    v_and_b32 v253, 0xffff0000, v158
    v_fma_f32 v252, v252, v96, v248
    v_fma_f32 v253, v253, v97, v249
    v_cvt_pk_bf16_f32 v158, v252, v253
    v_lshlrev_b32 v252, 16, v159
    v_and_b32 v253, 0xffff0000, v159
    ds_read_b64_tr_b16 v[20:21], v88 offset:19456
    ds_read_b64_tr_b16 v[22:23], v88 offset:19968
    v_mfma_f32_16x16x32_bf16 v[24:27], v[8:11], v[132:135], v[24:27]
    v_mfma_f32_16x16x32_bf16 v[28:31], v[8:11], v[204:207], v[28:31]
    v_fma_f32 v252, v252, v98, v250
    v_fma_f32 v253, v253, v99, v251
    v_cvt_pk_bf16_f32 v159, v252, v253
    v_lshlrev_b32 v252, 16, v228
    v_and_b32 v253, 0xffff0000, v228
    v_fma_f32 v252, v252, v92, v244
    v_fma_f32 v253, v253, v93, v245
    ds_read_b64_tr_b16 v[8:9], v88 offset:20480
    ds_read_b64_tr_b16 v[10:11], v88 offset:20992
    s_waitcnt lgkmcnt(6)
    v_mfma_f32_16x16x32_bf16 v[32:35], v[12:15], v[132:135], v[32:35]
    v_mfma_f32_16x16x32_bf16 v[36:39], v[12:15], v[204:207], v[36:39]
    v_cvt_pk_bf16_f32 v228, v252, v253
    v_lshlrev_b32 v252, 16, v229
    v_and_b32 v253, 0xffff0000, v229
    v_fma_f32 v252, v252, v94, v246
    v_fma_f32 v253, v253, v95, v247
    v_cvt_pk_bf16_f32 v229, v252, v253
    v_lshlrev_b32 v252, 16, v230
    ds_read_b64_tr_b16 v[12:13], v88 offset:21504
    ds_read_b64_tr_b16 v[14:15], v88 offset:22016
    s_waitcnt lgkmcnt(6)
    v_mfma_f32_16x16x32_bf16 v[40:43], v[16:19], v[132:135], v[40:43]
    v_mfma_f32_16x16x32_bf16 v[44:47], v[16:19], v[204:207], v[44:47]
    v_and_b32 v253, 0xffff0000, v230
    v_fma_f32 v252, v252, v96, v248
    v_fma_f32 v253, v253, v97, v249
    v_cvt_pk_bf16_f32 v230, v252, v253
    v_lshlrev_b32 v252, 16, v231
    v_and_b32 v253, 0xffff0000, v231
    v_fma_f32 v252, v252, v98, v250
    ds_read_b64_tr_b16 v[16:17], v88 offset:22528
    ds_read_b64_tr_b16 v[18:19], v88 offset:23040
    s_waitcnt lgkmcnt(6)
    v_mfma_f32_16x16x32_bf16 v[48:51], v[20:23], v[132:135], v[48:51]
    v_mfma_f32_16x16x32_bf16 v[52:55], v[20:23], v[204:207], v[52:55]
    v_fma_f32 v253, v253, v99, v251
    v_cvt_pk_bf16_f32 v231, v252, v253
    ds_read_b128 v[244:247], v90 offset:3968
    ds_read_b128 v[248:251], v90 offset:3984
    ds_read_b128 v[92:95], v90 offset:6272
    ds_read_b128 v[96:99], v90 offset:6288
    s_waitcnt lgkmcnt(0)
    ds_read_b64_tr_b16 v[20:21], v88 offset:23552
    ds_read_b64_tr_b16 v[22:23], v88 offset:24064
    v_mfma_f32_16x16x32_bf16 v[56:59], v[8:11], v[132:135], v[56:59]
    v_mfma_f32_16x16x32_bf16 v[60:63], v[8:11], v[204:207], v[60:63]
    v_lshlrev_b32 v252, 16, v160
    v_and_b32 v253, 0xffff0000, v160
    v_fma_f32 v252, v252, v92, v244
    v_fma_f32 v253, v253, v93, v245
    v_cvt_pk_bf16_f32 v160, v252, v253
    v_lshlrev_b32 v252, 16, v161
    v_and_b32 v253, 0xffff0000, v161
    ds_read_b64_tr_b16 v[8:9], v88 offset:24576
    ds_read_b64_tr_b16 v[10:11], v88 offset:25088
    v_mfma_f32_16x16x32_bf16 v[64:67], v[12:15], v[132:135], v[64:67]
    v_mfma_f32_16x16x32_bf16 v[68:71], v[12:15], v[204:207], v[68:71]
    v_fma_f32 v252, v252, v94, v246
    v_fma_f32 v253, v253, v95, v247
    v_cvt_pk_bf16_f32 v161, v252, v253
    v_lshlrev_b32 v252, 16, v162
    v_and_b32 v253, 0xffff0000, v162
    v_fma_f32 v252, v252, v96, v248
    v_fma_f32 v253, v253, v97, v249
    ds_read_b64_tr_b16 v[12:13], v88 offset:25600
    ds_read_b64_tr_b16 v[14:15], v88 offset:26112
    v_mfma_f32_16x16x32_bf16 v[72:75], v[16:19], v[132:135], v[72:75]
    v_mfma_f32_16x16x32_bf16 v[76:79], v[16:19], v[204:207], v[76:79]
    v_cvt_pk_bf16_f32 v162, v252, v253
    v_lshlrev_b32 v252, 16, v163
    v_and_b32 v253, 0xffff0000, v163
    v_fma_f32 v252, v252, v98, v250
    v_fma_f32 v253, v253, v99, v251
    v_cvt_pk_bf16_f32 v163, v252, v253
    v_lshlrev_b32 v252, 16, v232
    ds_read_b64_tr_b16 v[16:17], v88 offset:26624
    ds_read_b64_tr_b16 v[18:19], v88 offset:27136
    s_waitcnt lgkmcnt(6)
    v_mfma_f32_16x16x32_bf16 v[80:83], v[20:23], v[132:135], v[80:83]
    v_mfma_f32_16x16x32_bf16 v[84:87], v[20:23], v[204:207], v[84:87]
    v_and_b32 v253, 0xffff0000, v232
    v_fma_f32 v252, v252, v92, v244
    v_fma_f32 v253, v253, v93, v245
    v_cvt_pk_bf16_f32 v232, v252, v253
    v_lshlrev_b32 v252, 16, v233
    v_and_b32 v253, 0xffff0000, v233
    v_fma_f32 v252, v252, v94, v246
    ds_read_b64_tr_b16 v[20:21], v88 offset:27648
    ds_read_b64_tr_b16 v[22:23], v88 offset:28160
    s_waitcnt lgkmcnt(6)
    v_mfma_f32_16x16x32_bf16 v[24:27], v[8:11], v[136:139], v[24:27]
    v_mfma_f32_16x16x32_bf16 v[28:31], v[8:11], v[208:211], v[28:31]
    v_fma_f32 v253, v253, v95, v247
    v_cvt_pk_bf16_f32 v233, v252, v253
    v_lshlrev_b32 v252, 16, v234
    v_and_b32 v253, 0xffff0000, v234
    v_fma_f32 v252, v252, v96, v248
    v_fma_f32 v253, v253, v97, v249
    v_cvt_pk_bf16_f32 v234, v252, v253
    ds_read_b64_tr_b16 v[8:9], v88 offset:28672
    ds_read_b64_tr_b16 v[10:11], v88 offset:29184
    s_waitcnt lgkmcnt(6)
    v_mfma_f32_16x16x32_bf16 v[32:35], v[12:15], v[136:139], v[32:35]
    v_mfma_f32_16x16x32_bf16 v[36:39], v[12:15], v[208:211], v[36:39]
    v_lshlrev_b32 v252, 16, v235
    v_and_b32 v253, 0xffff0000, v235
    v_fma_f32 v252, v252, v98, v250
    v_fma_f32 v253, v253, v99, v251
    v_cvt_pk_bf16_f32 v235, v252, v253
    ds_read_b128 v[244:247], v90 offset:4096
    ds_read_b128 v[248:251], v90 offset:4112
    ds_read_b64_tr_b16 v[12:13], v88 offset:29696
    ds_read_b64_tr_b16 v[14:15], v88 offset:30208
    s_waitcnt lgkmcnt(8)
    v_mfma_f32_16x16x32_bf16 v[40:43], v[16:19], v[136:139], v[40:43]
    v_mfma_f32_16x16x32_bf16 v[44:47], v[16:19], v[208:211], v[44:47]
    ds_read_b128 v[92:95], v90 offset:6400
    ds_read_b128 v[96:99], v90 offset:6416
    s_waitcnt lgkmcnt(0)
    v_lshlrev_b32 v252, 16, v164
    v_and_b32 v253, 0xffff0000, v164
    v_fma_f32 v252, v252, v92, v244
    v_fma_f32 v253, v253, v93, v245
    ds_read_b64_tr_b16 v[16:17], v88 offset:30720
    ds_read_b64_tr_b16 v[18:19], v88 offset:31232
    v_mfma_f32_16x16x32_bf16 v[48:51], v[20:23], v[136:139], v[48:51]
    v_mfma_f32_16x16x32_bf16 v[52:55], v[20:23], v[208:211], v[52:55]
    v_cvt_pk_bf16_f32 v164, v252, v253
    v_lshlrev_b32 v252, 16, v165
    v_and_b32 v253, 0xffff0000, v165
    v_fma_f32 v252, v252, v94, v246
    v_fma_f32 v253, v253, v95, v247
    v_cvt_pk_bf16_f32 v165, v252, v253
    v_lshlrev_b32 v252, 16, v166
    ds_read_b64_tr_b16 v[20:21], v88 offset:31744
    ds_read_b64_tr_b16 v[22:23], v88 offset:32256
    v_mfma_f32_16x16x32_bf16 v[56:59], v[8:11], v[136:139], v[56:59]
    v_mfma_f32_16x16x32_bf16 v[60:63], v[8:11], v[208:211], v[60:63]
    v_and_b32 v253, 0xffff0000, v166
    v_fma_f32 v252, v252, v96, v248
    v_fma_f32 v253, v253, v97, v249
    v_cvt_pk_bf16_f32 v166, v252, v253
    v_lshlrev_b32 v252, 16, v167
    v_and_b32 v253, 0xffff0000, v167
    v_fma_f32 v252, v252, v98, v250
    ds_read_b64_tr_b16 v[8:9], v88 offset:32768
    ds_read_b64_tr_b16 v[10:11], v88 offset:33280
    v_mfma_f32_16x16x32_bf16 v[64:67], v[12:15], v[136:139], v[64:67]
    v_mfma_f32_16x16x32_bf16 v[68:71], v[12:15], v[208:211], v[68:71]
    v_fma_f32 v253, v253, v99, v251
    v_cvt_pk_bf16_f32 v167, v252, v253
    v_lshlrev_b32 v252, 16, v236
    v_and_b32 v253, 0xffff0000, v236
    v_fma_f32 v252, v252, v92, v244
    v_fma_f32 v253, v253, v93, v245
    v_cvt_pk_bf16_f32 v236, v252, v253
    ds_read_b64_tr_b16 v[12:13], v88 offset:33792
    ds_read_b64_tr_b16 v[14:15], v88 offset:34304
    s_waitcnt lgkmcnt(6)
    v_mfma_f32_16x16x32_bf16 v[72:75], v[16:19], v[136:139], v[72:75]
    v_mfma_f32_16x16x32_bf16 v[76:79], v[16:19], v[208:211], v[76:79]
    v_lshlrev_b32 v252, 16, v237
    v_and_b32 v253, 0xffff0000, v237
    v_fma_f32 v252, v252, v94, v246
    v_fma_f32 v253, v253, v95, v247
    v_cvt_pk_bf16_f32 v237, v252, v253
    v_lshlrev_b32 v252, 16, v238
    v_and_b32 v253, 0xffff0000, v238
    ds_read_b64_tr_b16 v[16:17], v88 offset:34816
    ds_read_b64_tr_b16 v[18:19], v88 offset:35328
    s_waitcnt lgkmcnt(6)
    v_mfma_f32_16x16x32_bf16 v[80:83], v[20:23], v[136:139], v[80:83]
    v_mfma_f32_16x16x32_bf16 v[84:87], v[20:23], v[208:211], v[84:87]
    v_fma_f32 v252, v252, v96, v248
    v_fma_f32 v253, v253, v97, v249
    v_cvt_pk_bf16_f32 v238, v252, v253
    v_lshlrev_b32 v252, 16, v239
    v_and_b32 v253, 0xffff0000, v239
    v_fma_f32 v252, v252, v98, v250
    v_fma_f32 v253, v253, v99, v251
    ds_read_b64_tr_b16 v[20:21], v88 offset:35840
    ds_read_b64_tr_b16 v[22:23], v88 offset:36352
    s_waitcnt lgkmcnt(6)
    v_mfma_f32_16x16x32_bf16 v[24:27], v[8:11], v[140:143], v[24:27]
    v_mfma_f32_16x16x32_bf16 v[28:31], v[8:11], v[212:215], v[28:31]
    v_cvt_pk_bf16_f32 v239, v252, v253
    ds_read_b128 v[244:247], v90 offset:4224
    ds_read_b128 v[248:251], v90 offset:4240
    ds_read_b128 v[92:95], v90 offset:6528
    ds_read_b128 v[96:99], v90 offset:6544
    s_waitcnt lgkmcnt(0)
    v_lshlrev_b32 v252, 16, v168
    ds_read_b64_tr_b16 v[8:9], v88 offset:36864
    ds_read_b64_tr_b16 v[10:11], v88 offset:37376
    v_mfma_f32_16x16x32_bf16 v[32:35], v[12:15], v[140:143], v[32:35]
    v_mfma_f32_16x16x32_bf16 v[36:39], v[12:15], v[212:215], v[36:39]
    v_and_b32 v253, 0xffff0000, v168
    v_fma_f32 v252, v252, v92, v244
    v_fma_f32 v253, v253, v93, v245
    v_cvt_pk_bf16_f32 v168, v252, v253
    v_lshlrev_b32 v252, 16, v169
    v_and_b32 v253, 0xffff0000, v169
    v_fma_f32 v252, v252, v94, v246
    ds_read_b64_tr_b16 v[12:13], v88 offset:37888
    ds_read_b64_tr_b16 v[14:15], v88 offset:38400
    v_mfma_f32_16x16x32_bf16 v[40:43], v[16:19], v[140:143], v[40:43]
    v_mfma_f32_16x16x32_bf16 v[44:47], v[16:19], v[212:215], v[44:47]
    v_fma_f32 v253, v253, v95, v247
    v_cvt_pk_bf16_f32 v169, v252, v253
    v_lshlrev_b32 v252, 16, v170
    v_and_b32 v253, 0xffff0000, v170
    v_fma_f32 v252, v252, v96, v248
    v_fma_f32 v253, v253, v97, v249
    v_cvt_pk_bf16_f32 v170, v252, v253
    ds_read_b64_tr_b16 v[16:17], v88 offset:38912
    ds_read_b64_tr_b16 v[18:19], v88 offset:39424
    v_mfma_f32_16x16x32_bf16 v[48:51], v[20:23], v[140:143], v[48:51]
    v_mfma_f32_16x16x32_bf16 v[52:55], v[20:23], v[212:215], v[52:55]
    v_lshlrev_b32 v252, 16, v171
    v_and_b32 v253, 0xffff0000, v171
    v_fma_f32 v252, v252, v98, v250
    v_fma_f32 v253, v253, v99, v251
    v_cvt_pk_bf16_f32 v171, v252, v253
    v_lshlrev_b32 v252, 16, v240
    v_and_b32 v253, 0xffff0000, v240
    ds_read_b64_tr_b16 v[20:21], v88 offset:39936
    ds_read_b64_tr_b16 v[22:23], v88 offset:40448
    s_waitcnt lgkmcnt(6)
    v_mfma_f32_16x16x32_bf16 v[56:59], v[8:11], v[140:143], v[56:59]
    v_mfma_f32_16x16x32_bf16 v[60:63], v[8:11], v[212:215], v[60:63]
    v_fma_f32 v252, v252, v92, v244
    v_fma_f32 v253, v253, v93, v245
    v_cvt_pk_bf16_f32 v240, v252, v253
    v_lshlrev_b32 v252, 16, v241
    v_and_b32 v253, 0xffff0000, v241
    v_fma_f32 v252, v252, v94, v246
    v_fma_f32 v253, v253, v95, v247
    ds_read_b64_tr_b16 v[8:9], v88 offset:40960
    ds_read_b64_tr_b16 v[10:11], v88 offset:41472
    s_waitcnt lgkmcnt(6)
    v_mfma_f32_16x16x32_bf16 v[64:67], v[12:15], v[140:143], v[64:67]
    v_mfma_f32_16x16x32_bf16 v[68:71], v[12:15], v[212:215], v[68:71]
    v_cvt_pk_bf16_f32 v241, v252, v253
    v_lshlrev_b32 v252, 16, v242
    v_and_b32 v253, 0xffff0000, v242
    v_fma_f32 v252, v252, v96, v248
    v_fma_f32 v253, v253, v97, v249
    v_cvt_pk_bf16_f32 v242, v252, v253
    v_lshlrev_b32 v252, 16, v243
    ds_read_b64_tr_b16 v[12:13], v88 offset:41984
    ds_read_b64_tr_b16 v[14:15], v88 offset:42496
    s_waitcnt lgkmcnt(6)
    v_mfma_f32_16x16x32_bf16 v[72:75], v[16:19], v[140:143], v[72:75]
    v_mfma_f32_16x16x32_bf16 v[76:79], v[16:19], v[212:215], v[76:79]
    v_and_b32 v253, 0xffff0000, v243
    v_fma_f32 v252, v252, v98, v250
    v_fma_f32 v253, v253, v99, v251
    v_cvt_pk_bf16_f32 v243, v252, v253
    ds_read_b64_tr_b16 v[16:17], v88 offset:43008
    ds_read_b64_tr_b16 v[18:19], v88 offset:43520
    s_waitcnt lgkmcnt(6)
    v_mfma_f32_16x16x32_bf16 v[80:83], v[20:23], v[140:143], v[80:83]
    v_mfma_f32_16x16x32_bf16 v[84:87], v[20:23], v[212:215], v[84:87]
    ds_read_b64_tr_b16 v[20:21], v88 offset:44032
    ds_read_b64_tr_b16 v[22:23], v88 offset:44544
    s_waitcnt lgkmcnt(6)
    v_mfma_f32_16x16x32_bf16 v[24:27], v[8:11], v[144:147], v[24:27]
    v_mfma_f32_16x16x32_bf16 v[28:31], v[8:11], v[216:219], v[28:31]
    ds_read_b64_tr_b16 v[8:9], v88 offset:45056
    ds_read_b64_tr_b16 v[10:11], v88 offset:45568
    s_waitcnt lgkmcnt(6)
    v_mfma_f32_16x16x32_bf16 v[32:35], v[12:15], v[144:147], v[32:35]
    v_mfma_f32_16x16x32_bf16 v[36:39], v[12:15], v[216:219], v[36:39]
    ds_read_b64_tr_b16 v[12:13], v88 offset:46080
    ds_read_b64_tr_b16 v[14:15], v88 offset:46592
    s_waitcnt lgkmcnt(6)
    v_mfma_f32_16x16x32_bf16 v[40:43], v[16:19], v[144:147], v[40:43]
    v_mfma_f32_16x16x32_bf16 v[44:47], v[16:19], v[216:219], v[44:47]
    ds_read_b64_tr_b16 v[16:17], v88 offset:47104
    ds_read_b64_tr_b16 v[18:19], v88 offset:47616
    s_waitcnt lgkmcnt(6)
    v_mfma_f32_16x16x32_bf16 v[48:51], v[20:23], v[144:147], v[48:51]
    v_mfma_f32_16x16x32_bf16 v[52:55], v[20:23], v[216:219], v[52:55]
    ds_read_b64_tr_b16 v[20:21], v88 offset:48128
    ds_read_b64_tr_b16 v[22:23], v88 offset:48640
    s_waitcnt lgkmcnt(6)
    v_mfma_f32_16x16x32_bf16 v[56:59], v[8:11], v[144:147], v[56:59]
    v_mfma_f32_16x16x32_bf16 v[60:63], v[8:11], v[216:219], v[60:63]
    s_waitcnt lgkmcnt(4)
    v_mfma_f32_16x16x32_bf16 v[64:67], v[12:15], v[144:147], v[64:67]
    v_mfma_f32_16x16x32_bf16 v[68:71], v[12:15], v[216:219], v[68:71]
    s_waitcnt lgkmcnt(2)
    v_mfma_f32_16x16x32_bf16 v[72:75], v[16:19], v[144:147], v[72:75]
    v_mfma_f32_16x16x32_bf16 v[76:79], v[16:19], v[216:219], v[76:79]
    s_waitcnt lgkmcnt(0)
    v_mfma_f32_16x16x32_bf16 v[80:83], v[20:23], v[144:147], v[80:83]
    v_mfma_f32_16x16x32_bf16 v[84:87], v[20:23], v[216:219], v[84:87]
    v_add_u32 v88, 49152, v88
    s_waitcnt vmcnt(0)
    s_barrier
    ds_read_b64_tr_b16 v[8:9], v88 offset:0
    ds_read_b64_tr_b16 v[10:11], v88 offset:512
    ds_read_b64_tr_b16 v[12:13], v88 offset:1024
    ds_read_b64_tr_b16 v[14:15], v88 offset:1536
    ds_read_b64_tr_b16 v[16:17], v88 offset:2048
    ds_read_b64_tr_b16 v[18:19], v88 offset:2560
    ds_read_b64_tr_b16 v[20:21], v88 offset:3072
    ds_read_b64_tr_b16 v[22:23], v88 offset:3584
    s_waitcnt lgkmcnt(6)
    v_mfma_f32_16x16x32_bf16 v[24:27], v[8:11], v[148:151], v[24:27]
    v_mfma_f32_16x16x32_bf16 v[28:31], v[8:11], v[220:223], v[28:31]
    ds_read_b64_tr_b16 v[8:9], v88 offset:4096
    ds_read_b64_tr_b16 v[10:11], v88 offset:4608
    s_waitcnt lgkmcnt(6)
    v_mfma_f32_16x16x32_bf16 v[32:35], v[12:15], v[148:151], v[32:35]
    v_mfma_f32_16x16x32_bf16 v[36:39], v[12:15], v[220:223], v[36:39]
    ds_read_b64_tr_b16 v[12:13], v88 offset:5120
    ds_read_b64_tr_b16 v[14:15], v88 offset:5632
    s_waitcnt lgkmcnt(6)
    v_mfma_f32_16x16x32_bf16 v[40:43], v[16:19], v[148:151], v[40:43]
    v_mfma_f32_16x16x32_bf16 v[44:47], v[16:19], v[220:223], v[44:47]
    ds_read_b64_tr_b16 v[16:17], v88 offset:6144
    ds_read_b64_tr_b16 v[18:19], v88 offset:6656
    s_waitcnt lgkmcnt(6)
    v_mfma_f32_16x16x32_bf16 v[48:51], v[20:23], v[148:151], v[48:51]
    v_mfma_f32_16x16x32_bf16 v[52:55], v[20:23], v[220:223], v[52:55]
    ds_read_b64_tr_b16 v[20:21], v88 offset:7168
    ds_read_b64_tr_b16 v[22:23], v88 offset:7680
    s_waitcnt lgkmcnt(6)
    v_mfma_f32_16x16x32_bf16 v[56:59], v[8:11], v[148:151], v[56:59]
    v_mfma_f32_16x16x32_bf16 v[60:63], v[8:11], v[220:223], v[60:63]
    ds_read_b64_tr_b16 v[8:9], v88 offset:8192
    ds_read_b64_tr_b16 v[10:11], v88 offset:8704
    s_waitcnt lgkmcnt(6)
    v_mfma_f32_16x16x32_bf16 v[64:67], v[12:15], v[148:151], v[64:67]
    v_mfma_f32_16x16x32_bf16 v[68:71], v[12:15], v[220:223], v[68:71]
    ds_read_b64_tr_b16 v[12:13], v88 offset:9216
    ds_read_b64_tr_b16 v[14:15], v88 offset:9728
    s_waitcnt lgkmcnt(6)
    v_mfma_f32_16x16x32_bf16 v[72:75], v[16:19], v[148:151], v[72:75]
    v_mfma_f32_16x16x32_bf16 v[76:79], v[16:19], v[220:223], v[76:79]
    ds_read_b64_tr_b16 v[16:17], v88 offset:10240
    ds_read_b64_tr_b16 v[18:19], v88 offset:10752
    s_waitcnt lgkmcnt(6)
    v_mfma_f32_16x16x32_bf16 v[80:83], v[20:23], v[148:151], v[80:83]
    v_mfma_f32_16x16x32_bf16 v[84:87], v[20:23], v[220:223], v[84:87]
    ds_read_b64_tr_b16 v[20:21], v88 offset:11264
    ds_read_b64_tr_b16 v[22:23], v88 offset:11776
    s_waitcnt lgkmcnt(6)
    v_mfma_f32_16x16x32_bf16 v[24:27], v[8:11], v[152:155], v[24:27]
    v_mfma_f32_16x16x32_bf16 v[28:31], v[8:11], v[224:227], v[28:31]
    ds_read_b64_tr_b16 v[8:9], v88 offset:12288
    ds_read_b64_tr_b16 v[10:11], v88 offset:12800
    s_waitcnt lgkmcnt(6)
    v_mfma_f32_16x16x32_bf16 v[32:35], v[12:15], v[152:155], v[32:35]
    v_mfma_f32_16x16x32_bf16 v[36:39], v[12:15], v[224:227], v[36:39]
    ds_read_b64_tr_b16 v[12:13], v88 offset:13312
    ds_read_b64_tr_b16 v[14:15], v88 offset:13824
    s_waitcnt lgkmcnt(6)
    v_mfma_f32_16x16x32_bf16 v[40:43], v[16:19], v[152:155], v[40:43]
    v_mfma_f32_16x16x32_bf16 v[44:47], v[16:19], v[224:227], v[44:47]
    ds_read_b64_tr_b16 v[16:17], v88 offset:14336
    ds_read_b64_tr_b16 v[18:19], v88 offset:14848
    s_waitcnt lgkmcnt(6)
    v_mfma_f32_16x16x32_bf16 v[48:51], v[20:23], v[152:155], v[48:51]
    v_mfma_f32_16x16x32_bf16 v[52:55], v[20:23], v[224:227], v[52:55]
    ds_read_b64_tr_b16 v[20:21], v88 offset:15360
    ds_read_b64_tr_b16 v[22:23], v88 offset:15872
    s_waitcnt lgkmcnt(6)
    v_mfma_f32_16x16x32_bf16 v[56:59], v[8:11], v[152:155], v[56:59]
    v_mfma_f32_16x16x32_bf16 v[60:63], v[8:11], v[224:227], v[60:63]
    ds_read_b64_tr_b16 v[8:9], v88 offset:16384
    ds_read_b64_tr_b16 v[10:11], v88 offset:16896
    s_waitcnt lgkmcnt(6)
    v_mfma_f32_16x16x32_bf16 v[64:67], v[12:15], v[152:155], v[64:67]
    v_mfma_f32_16x16x32_bf16 v[68:71], v[12:15], v[224:227], v[68:71]
    ds_read_b64_tr_b16 v[12:13], v88 offset:17408
    ds_read_b64_tr_b16 v[14:15], v88 offset:17920
    s_waitcnt lgkmcnt(6)
    v_mfma_f32_16x16x32_bf16 v[72:75], v[16:19], v[152:155], v[72:75]
    v_mfma_f32_16x16x32_bf16 v[76:79], v[16:19], v[224:227], v[76:79]
    ds_read_b64_tr_b16 v[16:17], v88 offset:18432
    ds_read_b64_tr_b16 v[18:19], v88 offset:18944
    s_waitcnt lgkmcnt(6)
    v_mfma_f32_16x16x32_bf16 v[80:83], v[20:23], v[152:155], v[80:83]
    v_mfma_f32_16x16x32_bf16 v[84:87], v[20:23], v[224:227], v[84:87]
    ds_read_b64_tr_b16 v[20:21], v88 offset:19456
    ds_read_b64_tr_b16 v[22:23], v88 offset:19968
    s_waitcnt lgkmcnt(6)
    v_mfma_f32_16x16x32_bf16 v[24:27], v[8:11], v[156:159], v[24:27]
    v_mfma_f32_16x16x32_bf16 v[28:31], v[8:11], v[228:231], v[28:31]
    ds_read_b64_tr_b16 v[8:9], v88 offset:20480
    ds_read_b64_tr_b16 v[10:11], v88 offset:20992
    s_waitcnt lgkmcnt(6)
    v_mfma_f32_16x16x32_bf16 v[32:35], v[12:15], v[156:159], v[32:35]
    v_mfma_f32_16x16x32_bf16 v[36:39], v[12:15], v[228:231], v[36:39]
    ds_read_b64_tr_b16 v[12:13], v88 offset:21504
    ds_read_b64_tr_b16 v[14:15], v88 offset:22016
    s_waitcnt lgkmcnt(6)
    v_mfma_f32_16x16x32_bf16 v[40:43], v[16:19], v[156:159], v[40:43]
    v_mfma_f32_16x16x32_bf16 v[44:47], v[16:19], v[228:231], v[44:47]
    ds_read_b64_tr_b16 v[16:17], v88 offset:22528
    ds_read_b64_tr_b16 v[18:19], v88 offset:23040
    s_waitcnt lgkmcnt(6)
    v_mfma_f32_16x16x32_bf16 v[48:51], v[20:23], v[156:159], v[48:51]
    v_mfma_f32_16x16x32_bf16 v[52:55], v[20:23], v[228:231], v[52:55]
    ds_read_b64_tr_b16 v[20:21], v88 offset:23552
    ds_read_b64_tr_b16 v[22:23], v88 offset:24064
    s_waitcnt lgkmcnt(6)
    v_mfma_f32_16x16x32_bf16 v[56:59], v[8:11], v[156:159], v[56:59]
    v_mfma_f32_16x16x32_bf16 v[60:63], v[8:11], v[228:231], v[60:63]
    ds_read_b64_tr_b16 v[8:9], v88 offset:24576
    ds_read_b64_tr_b16 v[10:11], v88 offset:25088
    s_waitcnt lgkmcnt(6)
    v_mfma_f32_16x16x32_bf16 v[64:67], v[12:15], v[156:159], v[64:67]
    v_mfma_f32_16x16x32_bf16 v[68:71], v[12:15], v[228:231], v[68:71]
    ds_read_b64_tr_b16 v[12:13], v88 offset:25600
    ds_read_b64_tr_b16 v[14:15], v88 offset:26112
    s_waitcnt lgkmcnt(6)
    v_mfma_f32_16x16x32_bf16 v[72:75], v[16:19], v[156:159], v[72:75]
    v_mfma_f32_16x16x32_bf16 v[76:79], v[16:19], v[228:231], v[76:79]
    ds_read_b64_tr_b16 v[16:17], v88 offset:26624
    ds_read_b64_tr_b16 v[18:19], v88 offset:27136
    s_waitcnt lgkmcnt(6)
    v_mfma_f32_16x16x32_bf16 v[80:83], v[20:23], v[156:159], v[80:83]
    v_mfma_f32_16x16x32_bf16 v[84:87], v[20:23], v[228:231], v[84:87]
    ds_read_b64_tr_b16 v[20:21], v88 offset:27648
    ds_read_b64_tr_b16 v[22:23], v88 offset:28160
    s_waitcnt lgkmcnt(6)
    v_mfma_f32_16x16x32_bf16 v[24:27], v[8:11], v[160:163], v[24:27]
    v_mfma_f32_16x16x32_bf16 v[28:31], v[8:11], v[232:235], v[28:31]
    ds_read_b64_tr_b16 v[8:9], v88 offset:28672
    ds_read_b64_tr_b16 v[10:11], v88 offset:29184
    s_waitcnt lgkmcnt(6)
    v_mfma_f32_16x16x32_bf16 v[32:35], v[12:15], v[160:163], v[32:35]
    v_mfma_f32_16x16x32_bf16 v[36:39], v[12:15], v[232:235], v[36:39]
    ds_read_b64_tr_b16 v[12:13], v88 offset:29696
    ds_read_b64_tr_b16 v[14:15], v88 offset:30208
    s_waitcnt lgkmcnt(6)
    v_mfma_f32_16x16x32_bf16 v[40:43], v[16:19], v[160:163], v[40:43]
    v_mfma_f32_16x16x32_bf16 v[44:47], v[16:19], v[232:235], v[44:47]
    ds_read_b64_tr_b16 v[16:17], v88 offset:30720
    ds_read_b64_tr_b16 v[18:19], v88 offset:31232
    s_waitcnt lgkmcnt(6)
    v_mfma_f32_16x16x32_bf16 v[48:51], v[20:23], v[160:163], v[48:51]
    v_mfma_f32_16x16x32_bf16 v[52:55], v[20:23], v[232:235], v[52:55]
    ds_read_b64_tr_b16 v[20:21], v88 offset:31744
    ds_read_b64_tr_b16 v[22:23], v88 offset:32256
    s_waitcnt lgkmcnt(6)
    v_mfma_f32_16x16x32_bf16 v[56:59], v[8:11], v[160:163], v[56:59]
    v_mfma_f32_16x16x32_bf16 v[60:63], v[8:11], v[232:235], v[60:63]
    ds_read_b64_tr_b16 v[8:9], v88 offset:32768
    ds_read_b64_tr_b16 v[10:11], v88 offset:33280
    s_waitcnt lgkmcnt(6)
    v_mfma_f32_16x16x32_bf16 v[64:67], v[12:15], v[160:163], v[64:67]
    v_mfma_f32_16x16x32_bf16 v[68:71], v[12:15], v[232:235], v[68:71]
    ds_read_b64_tr_b16 v[12:13], v88 offset:33792
    ds_read_b64_tr_b16 v[14:15], v88 offset:34304
    s_waitcnt lgkmcnt(6)
    v_mfma_f32_16x16x32_bf16 v[72:75], v[16:19], v[160:163], v[72:75]
    v_mfma_f32_16x16x32_bf16 v[76:79], v[16:19], v[232:235], v[76:79]
    ds_read_b64_tr_b16 v[16:17], v88 offset:34816
    ds_read_b64_tr_b16 v[18:19], v88 offset:35328
    s_waitcnt lgkmcnt(6)
    v_mfma_f32_16x16x32_bf16 v[80:83], v[20:23], v[160:163], v[80:83]
    v_mfma_f32_16x16x32_bf16 v[84:87], v[20:23], v[232:235], v[84:87]
    ds_read_b64_tr_b16 v[20:21], v88 offset:35840
    ds_read_b64_tr_b16 v[22:23], v88 offset:36352
    s_waitcnt lgkmcnt(6)
    v_mfma_f32_16x16x32_bf16 v[24:27], v[8:11], v[164:167], v[24:27]
    v_mfma_f32_16x16x32_bf16 v[28:31], v[8:11], v[236:239], v[28:31]
    ds_read_b64_tr_b16 v[8:9], v88 offset:36864
    ds_read_b64_tr_b16 v[10:11], v88 offset:37376
    s_waitcnt lgkmcnt(6)
    v_mfma_f32_16x16x32_bf16 v[32:35], v[12:15], v[164:167], v[32:35]
    v_mfma_f32_16x16x32_bf16 v[36:39], v[12:15], v[236:239], v[36:39]
    ds_read_b64_tr_b16 v[12:13], v88 offset:37888
    ds_read_b64_tr_b16 v[14:15], v88 offset:38400
    s_waitcnt lgkmcnt(6)
    v_mfma_f32_16x16x32_bf16 v[40:43], v[16:19], v[164:167], v[40:43]
    v_mfma_f32_16x16x32_bf16 v[44:47], v[16:19], v[236:239], v[44:47]
    ds_read_b64_tr_b16 v[16:17], v88 offset:38912
    ds_read_b64_tr_b16 v[18:19], v88 offset:39424
    s_waitcnt lgkmcnt(6)
    v_mfma_f32_16x16x32_bf16 v[48:51], v[20:23], v[164:167], v[48:51]
    v_mfma_f32_16x16x32_bf16 v[52:55], v[20:23], v[236:239], v[52:55]
    ds_read_b64_tr_b16 v[20:21], v88 offset:39936
    ds_read_b64_tr_b16 v[22:23], v88 offset:40448
    s_waitcnt lgkmcnt(6)
    v_mfma_f32_16x16x32_bf16 v[56:59], v[8:11], v[164:167], v[56:59]
    v_mfma_f32_16x16x32_bf16 v[60:63], v[8:11], v[236:239], v[60:63]
    ds_read_b64_tr_b16 v[8:9], v88 offset:40960
    ds_read_b64_tr_b16 v[10:11], v88 offset:41472
    s_waitcnt lgkmcnt(6)
    v_mfma_f32_16x16x32_bf16 v[64:67], v[12:15], v[164:167], v[64:67]
    v_mfma_f32_16x16x32_bf16 v[68:71], v[12:15], v[236:239], v[68:71]
    ds_read_b64_tr_b16 v[12:13], v88 offset:41984
    ds_read_b64_tr_b16 v[14:15], v88 offset:42496
    s_waitcnt lgkmcnt(6)
    v_mfma_f32_16x16x32_bf16 v[72:75], v[16:19], v[164:167], v[72:75]
    v_mfma_f32_16x16x32_bf16 v[76:79], v[16:19], v[236:239], v[76:79]
    ds_read_b64_tr_b16 v[16:17], v88 offset:43008
    ds_read_b64_tr_b16 v[18:19], v88 offset:43520
    s_waitcnt lgkmcnt(6)
    v_mfma_f32_16x16x32_bf16 v[80:83], v[20:23], v[164:167], v[80:83]
    v_mfma_f32_16x16x32_bf16 v[84:87], v[20:23], v[236:239], v[84:87]
    ds_read_b64_tr_b16 v[20:21], v88 offset:44032
    ds_read_b64_tr_b16 v[22:23], v88 offset:44544
    s_waitcnt lgkmcnt(6)
    v_mfma_f32_16x16x32_bf16 v[24:27], v[8:11], v[168:171], v[24:27]
    v_mfma_f32_16x16x32_bf16 v[28:31], v[8:11], v[240:243], v[28:31]
    ds_read_b64_tr_b16 v[8:9], v88 offset:45056
    ds_read_b64_tr_b16 v[10:11], v88 offset:45568
    s_waitcnt lgkmcnt(6)
    v_mfma_f32_16x16x32_bf16 v[32:35], v[12:15], v[168:171], v[32:35]
    v_mfma_f32_16x16x32_bf16 v[36:39], v[12:15], v[240:243], v[36:39]
    ds_read_b64_tr_b16 v[12:13], v88 offset:46080
    ds_read_b64_tr_b16 v[14:15], v88 offset:46592
    s_waitcnt lgkmcnt(6)
    v_mfma_f32_16x16x32_bf16 v[40:43], v[16:19], v[168:171], v[40:43]
    v_mfma_f32_16x16x32_bf16 v[44:47], v[16:19], v[240:243], v[44:47]
    ds_read_b64_tr_b16 v[16:17], v88 offset:47104
    ds_read_b64_tr_b16 v[18:19], v88 offset:47616
    s_waitcnt lgkmcnt(6)
    v_mfma_f32_16x16x32_bf16 v[48:51], v[20:23], v[168:171], v[48:51]
    v_mfma_f32_16x16x32_bf16 v[52:55], v[20:23], v[240:243], v[52:55]
    ds_read_b64_tr_b16 v[20:21], v88 offset:48128
    ds_read_b64_tr_b16 v[22:23], v88 offset:48640
    s_waitcnt lgkmcnt(6)
    v_mfma_f32_16x16x32_bf16 v[56:59], v[8:11], v[168:171], v[56:59]
    v_mfma_f32_16x16x32_bf16 v[60:63], v[8:11], v[240:243], v[60:63]
    s_waitcnt lgkmcnt(4)
    v_mfma_f32_16x16x32_bf16 v[64:67], v[12:15], v[168:171], v[64:67]
    v_mfma_f32_16x16x32_bf16 v[68:71], v[12:15], v[240:243], v[68:71]
    s_waitcnt lgkmcnt(2)
    v_mfma_f32_16x16x32_bf16 v[72:75], v[16:19], v[168:171], v[72:75]
    v_mfma_f32_16x16x32_bf16 v[76:79], v[16:19], v[240:243], v[76:79]
    s_waitcnt lgkmcnt(0)
    v_mfma_f32_16x16x32_bf16 v[80:83], v[20:23], v[168:171], v[80:83]
    v_mfma_f32_16x16x32_bf16 v[84:87], v[20:23], v[240:243], v[84:87]
    s_nop 9
    s_barrier
    s_lshl_b32 s43, s3, 5
    v_add_u32 v8, s43, v3
    v_mul_u32_u24 v9, 104, v8
    v_lshl_add_u32 v9, v4, 3, v9
    v_cvt_pk_bf16_f32 v10, v64, v65
    v_cvt_pk_bf16_f32 v11, v66, v67
    ds_write_b64 v9, v[10:11] offset:32256
    v_cvt_pk_bf16_f32 v10, v72, v73
    v_cvt_pk_bf16_f32 v11, v74, v75
    ds_write_b64 v9, v[10:11] offset:32288
    v_cvt_pk_bf16_f32 v10, v80, v81
    v_cvt_pk_bf16_f32 v11, v82, v83
    ds_write_b64 v9, v[10:11] offset:32320
    v_cvt_pk_bf16_f32 v10, v68, v69
    v_cvt_pk_bf16_f32 v11, v70, v71
    ds_write_b64 v9, v[10:11] offset:33920
    v_cvt_pk_bf16_f32 v10, v76, v77
    v_cvt_pk_bf16_f32 v11, v78, v79
    ds_write_b64 v9, v[10:11] offset:33952
    v_cvt_pk_bf16_f32 v10, v84, v85
    v_cvt_pk_bf16_f32 v11, v86, v87
    ds_write_b64 v9, v[10:11] offset:33984
    v_lshrrev_b32 v9, 2, v3
    v_and_b32 v10, 3, v1
    v_and_b32 v11, 1, v9
    v_mul_u32_u24 v11, 960, v11
    v_mul_u32_u24 v12, 48, v10
    v_add_u32 v11, v11, v12
    v_cmp_eq_u32 s[48:49], v9, v4
    ds_read_b128 v[100:103], v11 offset:0
    ds_read_b128 v[104:107], v11 offset:16
    ds_read_b128 v[108:111], v11 offset:32
    ds_read_b128 v[112:115], v11 offset:192
    ds_read_b128 v[116:119], v11 offset:208
    ds_read_b128 v[120:123], v11 offset:224
    ds_read_b128 v[124:127], v11 offset:384
    ds_read_b128 v[128:131], v11 offset:400
    ds_read_b128 v[132:135], v11 offset:416
    ds_read_b128 v[136:139], v11 offset:576
    ds_read_b128 v[140:143], v11 offset:592
    ds_read_b128 v[144:147], v11 offset:608
    ds_read_b128 v[148:151], v11 offset:768
    ds_read_b128 v[152:155], v11 offset:784
    ds_read_b128 v[156:159], v11 offset:800
    s_waitcnt lgkmcnt(0)
    v_cndmask_b32 v100, 0, v100, s[48:49]
    v_cndmask_b32 v101, 0, v101, s[48:49]
    v_cndmask_b32 v102, 0, v102, s[48:49]
    v_cndmask_b32 v103, 0, v103, s[48:49]
    v_cndmask_b32 v104, 0, v104, s[48:49]
    v_cndmask_b32 v105, 0, v105, s[48:49]
    v_cndmask_b32 v106, 0, v106, s[48:49]
    v_cndmask_b32 v107, 0, v107, s[48:49]
    v_cndmask_b32 v108, 0, v108, s[48:49]
    v_cndmask_b32 v109, 0, v109, s[48:49]
    v_cndmask_b32 v110, 0, v110, s[48:49]
    v_cndmask_b32 v111, 0, v111, s[48:49]
    v_cndmask_b32 v112, 0, v112, s[48:49]
    v_cndmask_b32 v113, 0, v113, s[48:49]
    v_cndmask_b32 v114, 0, v114, s[48:49]
    v_cndmask_b32 v115, 0, v115, s[48:49]
    v_cndmask_b32 v116, 0, v116, s[48:49]
    v_cndmask_b32 v117, 0, v117, s[48:49]
    v_cndmask_b32 v118, 0, v118, s[48:49]
    v_cndmask_b32 v119, 0, v119, s[48:49]
    v_cndmask_b32 v120, 0, v120, s[48:49]
    v_cndmask_b32 v121, 0, v121, s[48:49]
    v_cndmask_b32 v122, 0, v122, s[48:49]
    v_cndmask_b32 v123, 0, v123, s[48:49]
    v_cndmask_b32 v124, 0, v124, s[48:49]
    v_cndmask_b32 v125, 0, v125, s[48:49]
    v_cndmask_b32 v126, 0, v126, s[48:49]
    v_cndmask_b32 v127, 0, v127, s[48:49]
    v_cndmask_b32 v128, 0, v128, s[48:49]
    v_cndmask_b32 v129, 0, v129, s[48:49]
    v_cndmask_b32 v130, 0, v130, s[48:49]
    v_cndmask_b32 v131, 0, v131, s[48:49]
    v_cndmask_b32 v132, 0, v132, s[48:49]
    v_cndmask_b32 v133, 0, v133, s[48:49]
    v_cndmask_b32 v134, 0, v134, s[48:49]
    v_cndmask_b32 v135, 0, v135, s[48:49]
    v_cndmask_b32 v136, 0, v136, s[48:49]
    v_cndmask_b32 v137, 0, v137, s[48:49]
    v_cndmask_b32 v138, 0, v138, s[48:49]
    v_cndmask_b32 v139, 0, v139, s[48:49]
    v_cndmask_b32 v140, 0, v140, s[48:49]
    v_cndmask_b32 v141, 0, v141, s[48:49]
    v_cndmask_b32 v142, 0, v142, s[48:49]
    v_cndmask_b32 v143, 0, v143, s[48:49]
    v_cndmask_b32 v144, 0, v144, s[48:49]
    v_cndmask_b32 v145, 0, v145, s[48:49]
    v_cndmask_b32 v146, 0, v146, s[48:49]
    v_cndmask_b32 v147, 0, v147, s[48:49]
    v_cndmask_b32 v148, 0, v148, s[48:49]
    v_cndmask_b32 v149, 0, v149, s[48:49]
    v_cndmask_b32 v150, 0, v150, s[48:49]
    v_cndmask_b32 v151, 0, v151, s[48:49]
    v_cndmask_b32 v152, 0, v152, s[48:49]
    v_cndmask_b32 v153, 0, v153, s[48:49]
    v_cndmask_b32 v154, 0, v154, s[48:49]
    v_cndmask_b32 v155, 0, v155, s[48:49]
    v_cndmask_b32 v156, 0, v156, s[48:49]
    v_cndmask_b32 v157, 0, v157, s[48:49]
    v_cndmask_b32 v158, 0, v158, s[48:49]
    v_cndmask_b32 v159, 0, v159, s[48:49]
    s_mov_b32 s44, 1069066811
    v_mov_b32 v170, 0
    v_mov_b32 v171, 0
    s_lshr_b32 s45, s42, 4
    s_lshl_b32 s45, s45, 3
    s_lshr_b32 s46, s41, 1
    s_add_u32 s45, s45, s46
    s_mul_i32 s45, s45, 5120
    s_and_b32 s46, s41, 1
    s_lshl_b32 s46, s46, 9
    s_add_u32 s45, s45, s46
    v_lshlrev_b32 v90, 4, v1
    v_add_u32 v90, s45, v90
    v_mov_b32 v246, 0
    v_mov_b32 v247, 0
    v_mul_u32_u24 v91, 200, v8
    v_and_b32 v92, 1, v4
    v_mul_u32_u24 v92, 96, v92
    v_add_u32 v91, v91, v92
    v_cvt_pk_bf16_f32 v160, v24, v25
    v_cvt_pk_bf16_f32 v161, v26, v27
    v_cvt_pk_bf16_f32 v162, v32, v33
    v_cvt_pk_bf16_f32 v163, v34, v35
    v_cvt_pk_bf16_f32 v164, v40, v41
    v_cvt_pk_bf16_f32 v165, v42, v43
    v_cvt_pk_bf16_f32 v166, v48, v49
    v_cvt_pk_bf16_f32 v167, v50, v51
    v_cvt_pk_bf16_f32 v168, v56, v57
    v_cvt_pk_bf16_f32 v169, v58, v59
    s_nop 1
    v_mfma_f32_16x16x32_bf16 v[172:175], v[100:103], v[160:163], 0
    v_mfma_f32_16x16x32_bf16 v[172:175], v[104:107], v[164:167], v[172:175]
    v_mfma_f32_16x16x32_bf16 v[172:175], v[108:111], v[168:171], v[172:175]
    v_mfma_f32_16x16x32_bf16 v[176:179], v[112:115], v[160:163], 0
    v_mfma_f32_16x16x32_bf16 v[176:179], v[116:119], v[164:167], v[176:179]
    v_mfma_f32_16x16x32_bf16 v[176:179], v[120:123], v[168:171], v[176:179]
    v_mfma_f32_16x16x32_bf16 v[180:183], v[124:127], v[160:163], 0
    v_mfma_f32_16x16x32_bf16 v[180:183], v[128:131], v[164:167], v[180:183]
    v_mfma_f32_16x16x32_bf16 v[180:183], v[132:135], v[168:171], v[180:183]
    v_mfma_f32_16x16x32_bf16 v[184:187], v[136:139], v[160:163], 0
    v_mfma_f32_16x16x32_bf16 v[184:187], v[140:143], v[164:167], v[184:187]
    v_mfma_f32_16x16x32_bf16 v[184:187], v[144:147], v[168:171], v[184:187]
    v_mfma_f32_16x16x32_bf16 v[188:191], v[148:151], v[160:163], 0
    v_mfma_f32_16x16x32_bf16 v[188:191], v[152:155], v[164:167], v[188:191]
    v_mfma_f32_16x16x32_bf16 v[188:191], v[156:159], v[168:171], v[188:191]
    s_nop 9
    v_cvt_pk_bf16_f32 v93, v172, v173
    v_lshlrev_b32 v172, 16, v93
    v_and_b32 v173, 0xffff0000, v93
    v_cvt_pk_bf16_f32 v93, v174, v175
    v_lshlrev_b32 v174, 16, v93
    v_and_b32 v175, 0xffff0000, v93
    v_cvt_pk_bf16_f32 v93, v176, v177
    v_lshlrev_b32 v176, 16, v93
    v_and_b32 v177, 0xffff0000, v93
    v_cvt_pk_bf16_f32 v93, v178, v179
    v_lshlrev_b32 v178, 16, v93
    v_and_b32 v179, 0xffff0000, v93
    v_cvt_pk_bf16_f32 v93, v180, v181
    v_lshlrev_b32 v180, 16, v93
    v_and_b32 v181, 0xffff0000, v93
    v_cvt_pk_bf16_f32 v93, v182, v183
    v_lshlrev_b32 v182, 16, v93
    v_and_b32 v183, 0xffff0000, v93
    v_cvt_pk_bf16_f32 v93, v184, v185
    v_lshlrev_b32 v184, 16, v93
    v_and_b32 v185, 0xffff0000, v93
    v_cvt_pk_bf16_f32 v93, v186, v187
    v_lshlrev_b32 v186, 16, v93
    v_and_b32 v187, 0xffff0000, v93
    v_cvt_pk_bf16_f32 v93, v188, v189
    v_lshlrev_b32 v188, 16, v93
    v_and_b32 v189, 0xffff0000, v93
    v_max3_f32 v93, v172, v173, v174
    v_min3_f32 v94, v172, v173, v174
    v_max3_f32 v93, v93, v175, v176
    v_min3_f32 v94, v94, v175, v176
    v_max3_f32 v93, v93, v177, v178
    v_min3_f32 v94, v94, v177, v178
    v_max3_f32 v93, v93, v179, v180
    v_min3_f32 v94, v94, v179, v180
    v_max3_f32 v93, v93, v181, v182
    v_min3_f32 v94, v94, v181, v182
    v_max3_f32 v93, v93, v183, v184
    v_min3_f32 v94, v94, v183, v184
    v_max3_f32 v93, v93, v185, v186
    v_min3_f32 v94, v94, v185, v186
    v_max3_f32 v93, v93, v187, v188
    v_min3_f32 v94, v94, v187, v188
    v_max_f32 v93, v93, v189
    v_min_f32 v94, v94, v189
    v_mul_f32 v93, s44, v93
    v_mul_f32 v94, s44, v94
    v_fma_f32 v192, v172, s44, -v93
    v_fma_f32 v210, -v172, s44, v94
    v_fma_f32 v193, v173, s44, -v93
    v_fma_f32 v211, -v173, s44, v94
    v_fma_f32 v194, v174, s44, -v93
    v_fma_f32 v212, -v174, s44, v94
    v_fma_f32 v195, v175, s44, -v93
    v_fma_f32 v213, -v175, s44, v94
    v_fma_f32 v196, v176, s44, -v93
    v_fma_f32 v214, -v176, s44, v94
    v_fma_f32 v197, v177, s44, -v93
    v_fma_f32 v215, -v177, s44, v94
    v_fma_f32 v198, v178, s44, -v93
    v_fma_f32 v216, -v178, s44, v94
    v_fma_f32 v199, v179, s44, -v93
    v_fma_f32 v217, -v179, s44, v94
    v_fma_f32 v200, v180, s44, -v93
    v_fma_f32 v218, -v180, s44, v94
    v_fma_f32 v201, v181, s44, -v93
    v_fma_f32 v219, -v181, s44, v94
    v_fma_f32 v202, v182, s44, -v93
    v_fma_f32 v220, -v182, s44, v94
    v_fma_f32 v203, v183, s44, -v93
    v_fma_f32 v221, -v183, s44, v94
    v_fma_f32 v204, v184, s44, -v93
    v_fma_f32 v222, -v184, s44, v94
    v_fma_f32 v205, v185, s44, -v93
    v_fma_f32 v223, -v185, s44, v94
    v_fma_f32 v206, v186, s44, -v93
    v_fma_f32 v224, -v186, s44, v94
    v_fma_f32 v207, v187, s44, -v93
    v_fma_f32 v225, -v187, s44, v94
    v_fma_f32 v208, v188, s44, -v93
    v_fma_f32 v226, -v188, s44, v94
    v_fma_f32 v209, v189, s44, -v93
    v_fma_f32 v227, -v189, s44, v94
    v_exp_f32 v192, v192
    v_exp_f32 v210, v210
    v_exp_f32 v193, v193
    v_exp_f32 v211, v211
    v_exp_f32 v194, v194
    v_exp_f32 v212, v212
    v_exp_f32 v195, v195
    v_exp_f32 v213, v213
    v_exp_f32 v196, v196
    v_exp_f32 v214, v214
    v_exp_f32 v197, v197
    v_exp_f32 v215, v215
    v_exp_f32 v198, v198
    v_exp_f32 v216, v216
    v_exp_f32 v199, v199
    v_exp_f32 v217, v217
    v_exp_f32 v200, v200
    v_exp_f32 v218, v218
    v_exp_f32 v201, v201
    v_exp_f32 v219, v219
    v_exp_f32 v202, v202
    v_exp_f32 v220, v220
    v_exp_f32 v203, v203
    v_exp_f32 v221, v221
    v_exp_f32 v204, v204
    v_exp_f32 v222, v222
    v_exp_f32 v205, v205
    v_exp_f32 v223, v223
    v_exp_f32 v206, v206
    v_exp_f32 v224, v224
    v_exp_f32 v207, v207
    v_exp_f32 v225, v225
    v_exp_f32 v208, v208
    v_exp_f32 v226, v226
    v_exp_f32 v209, v209
    v_exp_f32 v227, v227
    s_nop 0
    v_add_f32 v93, v192, v193
    v_add_f32 v94, v210, v211
    v_add_f32 v93, v93, v194
    v_add_f32 v94, v94, v212
    v_add_f32 v93, v93, v195
    v_add_f32 v94, v94, v213
    v_add_f32 v93, v93, v196
    v_add_f32 v94, v94, v214
    v_add_f32 v93, v93, v197
    v_add_f32 v94, v94, v215
    v_add_f32 v93, v93, v198
    v_add_f32 v94, v94, v216
    v_add_f32 v93, v93, v199
    v_add_f32 v94, v94, v217
    v_add_f32 v93, v93, v200
    v_add_f32 v94, v94, v218
    v_add_f32 v93, v93, v201
    v_add_f32 v94, v94, v219
    v_add_f32 v93, v93, v202
    v_add_f32 v94, v94, v220
    v_add_f32 v93, v93, v203
    v_add_f32 v94, v94, v221
    v_add_f32 v93, v93, v204
    v_add_f32 v94, v94, v222
    v_add_f32 v93, v93, v205
    v_add_f32 v94, v94, v223
    v_add_f32 v93, v93, v206
    v_add_f32 v94, v94, v224
    v_add_f32 v93, v93, v207
    v_add_f32 v94, v94, v225
    v_add_f32 v93, v93, v208
    v_add_f32 v94, v94, v226
    v_add_f32 v93, v93, v209
    v_add_f32 v94, v94, v227
    v_rcp_f32 v93, v93
    v_rcp_f32 v94, v94
    s_nop 0
    v_mul_f32 v192, v192, v93
    v_mul_f32 v210, v210, v94
    v_mul_f32 v193, v193, v93
    v_mul_f32 v211, v211, v94
    v_mul_f32 v194, v194, v93
    v_mul_f32 v212, v212, v94
    v_mul_f32 v195, v195, v93
    v_mul_f32 v213, v213, v94
    v_mul_f32 v196, v196, v93
    v_mul_f32 v214, v214, v94
    v_mul_f32 v197, v197, v93
    v_mul_f32 v215, v215, v94
    v_mul_f32 v198, v198, v93
    v_mul_f32 v216, v216, v94
    v_mul_f32 v199, v199, v93
    v_mul_f32 v217, v217, v94
    v_mul_f32 v200, v200, v93
    v_mul_f32 v218, v218, v94
    v_mul_f32 v201, v201, v93
    v_mul_f32 v219, v219, v94
    v_mul_f32 v202, v202, v93
    v_mul_f32 v220, v220, v94
    v_mul_f32 v203, v203, v93
    v_mul_f32 v221, v221, v94
    v_mul_f32 v204, v204, v93
    v_mul_f32 v222, v222, v94
    v_mul_f32 v205, v205, v93
    v_mul_f32 v223, v223, v94
    v_mul_f32 v206, v206, v93
    v_mul_f32 v224, v224, v94
    v_mul_f32 v207, v207, v93
    v_mul_f32 v225, v225, v94
    v_mul_f32 v208, v208, v93
    v_mul_f32 v226, v226, v94
    v_mul_f32 v209, v209, v93
    v_mul_f32 v227, v227, v94
    v_cvt_pk_bf16_f32 v228, v192, v193
    v_cvt_pk_bf16_f32 v237, v210, v211
    v_cvt_pk_bf16_f32 v229, v194, v195
    v_cvt_pk_bf16_f32 v238, v212, v213
    v_cvt_pk_bf16_f32 v230, v196, v197
    v_cvt_pk_bf16_f32 v239, v214, v215
    v_cvt_pk_bf16_f32 v231, v198, v199
    v_cvt_pk_bf16_f32 v240, v216, v217
    v_cvt_pk_bf16_f32 v232, v200, v201
    v_cvt_pk_bf16_f32 v241, v218, v219
    v_cvt_pk_bf16_f32 v233, v202, v203
    v_cvt_pk_bf16_f32 v242, v220, v221
    v_cvt_pk_bf16_f32 v234, v204, v205
    v_cvt_pk_bf16_f32 v243, v222, v223
    v_cvt_pk_bf16_f32 v235, v206, v207
    v_cvt_pk_bf16_f32 v244, v224, v225
    v_cvt_pk_bf16_f32 v236, v208, v209
    v_cvt_pk_bf16_f32 v245, v226, v227
    s_mov_b64 exec, 0xffffffff
    v_add_u32 v95, 0, v90
    buffer_store_dwordx4 v[228:231], v95, s[28:31], 0 offen offset:0
    buffer_store_dwordx4 v[232:235], v95, s[28:31], 0 offen offset:1024
    buffer_store_dwordx4 v[236:239], v95, s[28:31], 0 offen offset:2048
    buffer_store_dwordx4 v[240:243], v95, s[28:31], 0 offen offset:3072
    s_mov_b32 s46, 4096
    buffer_store_dwordx4 v[244:247], v95, s[28:31], s46 offen
    s_mov_b32 exec_lo, 0
    s_mov_b32 exec_hi, -1
    ds_write_b64 v91, v[228:229] offset:6656
    ds_write_b64 v91, v[230:231] offset:6664
    ds_write_b64 v91, v[232:233] offset:6672
    ds_write_b64 v91, v[234:235] offset:6680
    ds_write_b64 v91, v[236:237] offset:6688
    ds_write_b64 v91, v[238:239] offset:6696
    ds_write_b64 v91, v[240:241] offset:6704
    ds_write_b64 v91, v[242:243] offset:6712
    ds_write_b64 v91, v[244:245] offset:6720
    s_mov_b64 exec, -1
    s_nop 1
    v_cvt_pk_bf16_f32 v160, v28, v29
    v_cvt_pk_bf16_f32 v161, v30, v31
    v_cvt_pk_bf16_f32 v162, v36, v37
    v_cvt_pk_bf16_f32 v163, v38, v39
    v_cvt_pk_bf16_f32 v164, v44, v45
    v_cvt_pk_bf16_f32 v165, v46, v47
    v_cvt_pk_bf16_f32 v166, v52, v53
    v_cvt_pk_bf16_f32 v167, v54, v55
    v_cvt_pk_bf16_f32 v168, v60, v61
    v_cvt_pk_bf16_f32 v169, v62, v63
    s_nop 1
    v_mfma_f32_16x16x32_bf16 v[172:175], v[100:103], v[160:163], 0
    v_mfma_f32_16x16x32_bf16 v[172:175], v[104:107], v[164:167], v[172:175]
    v_mfma_f32_16x16x32_bf16 v[172:175], v[108:111], v[168:171], v[172:175]
    v_mfma_f32_16x16x32_bf16 v[176:179], v[112:115], v[160:163], 0
    v_mfma_f32_16x16x32_bf16 v[176:179], v[116:119], v[164:167], v[176:179]
    v_mfma_f32_16x16x32_bf16 v[176:179], v[120:123], v[168:171], v[176:179]
    v_mfma_f32_16x16x32_bf16 v[180:183], v[124:127], v[160:163], 0
    v_mfma_f32_16x16x32_bf16 v[180:183], v[128:131], v[164:167], v[180:183]
    v_mfma_f32_16x16x32_bf16 v[180:183], v[132:135], v[168:171], v[180:183]
    v_mfma_f32_16x16x32_bf16 v[184:187], v[136:139], v[160:163], 0
    v_mfma_f32_16x16x32_bf16 v[184:187], v[140:143], v[164:167], v[184:187]
    v_mfma_f32_16x16x32_bf16 v[184:187], v[144:147], v[168:171], v[184:187]
    v_mfma_f32_16x16x32_bf16 v[188:191], v[148:151], v[160:163], 0
    v_mfma_f32_16x16x32_bf16 v[188:191], v[152:155], v[164:167], v[188:191]
    v_mfma_f32_16x16x32_bf16 v[188:191], v[156:159], v[168:171], v[188:191]
    s_nop 9
    v_cvt_pk_bf16_f32 v93, v172, v173
    v_lshlrev_b32 v172, 16, v93
    v_and_b32 v173, 0xffff0000, v93
    v_cvt_pk_bf16_f32 v93, v174, v175
    v_lshlrev_b32 v174, 16, v93
    v_and_b32 v175, 0xffff0000, v93
    v_cvt_pk_bf16_f32 v93, v176, v177
    v_lshlrev_b32 v176, 16, v93
    v_and_b32 v177, 0xffff0000, v93
    v_cvt_pk_bf16_f32 v93, v178, v179
    v_lshlrev_b32 v178, 16, v93
    v_and_b32 v179, 0xffff0000, v93
    v_cvt_pk_bf16_f32 v93, v180, v181
    v_lshlrev_b32 v180, 16, v93
    v_and_b32 v181, 0xffff0000, v93
    v_cvt_pk_bf16_f32 v93, v182, v183
    v_lshlrev_b32 v182, 16, v93
    v_and_b32 v183, 0xffff0000, v93
    v_cvt_pk_bf16_f32 v93, v184, v185
    v_lshlrev_b32 v184, 16, v93
    v_and_b32 v185, 0xffff0000, v93
    v_cvt_pk_bf16_f32 v93, v186, v187
    v_lshlrev_b32 v186, 16, v93
    v_and_b32 v187, 0xffff0000, v93
    v_cvt_pk_bf16_f32 v93, v188, v189
    v_lshlrev_b32 v188, 16, v93
    v_and_b32 v189, 0xffff0000, v93
    v_max3_f32 v93, v172, v173, v174
    v_min3_f32 v94, v172, v173, v174
    v_max3_f32 v93, v93, v175, v176
    v_min3_f32 v94, v94, v175, v176
    v_max3_f32 v93, v93, v177, v178
    v_min3_f32 v94, v94, v177, v178
    v_max3_f32 v93, v93, v179, v180
    v_min3_f32 v94, v94, v179, v180
    v_max3_f32 v93, v93, v181, v182
    v_min3_f32 v94, v94, v181, v182
    v_max3_f32 v93, v93, v183, v184
    v_min3_f32 v94, v94, v183, v184
    v_max3_f32 v93, v93, v185, v186
    v_min3_f32 v94, v94, v185, v186
    v_max3_f32 v93, v93, v187, v188
    v_min3_f32 v94, v94, v187, v188
    v_max_f32 v93, v93, v189
    v_min_f32 v94, v94, v189
    v_mul_f32 v93, s44, v93
    v_mul_f32 v94, s44, v94
    v_fma_f32 v192, v172, s44, -v93
    v_fma_f32 v210, -v172, s44, v94
    v_fma_f32 v193, v173, s44, -v93
    v_fma_f32 v211, -v173, s44, v94
    v_fma_f32 v194, v174, s44, -v93
    v_fma_f32 v212, -v174, s44, v94
    v_fma_f32 v195, v175, s44, -v93
    v_fma_f32 v213, -v175, s44, v94
    v_fma_f32 v196, v176, s44, -v93
    v_fma_f32 v214, -v176, s44, v94
    v_fma_f32 v197, v177, s44, -v93
    v_fma_f32 v215, -v177, s44, v94
    v_fma_f32 v198, v178, s44, -v93
    v_fma_f32 v216, -v178, s44, v94
    v_fma_f32 v199, v179, s44, -v93
    v_fma_f32 v217, -v179, s44, v94
    v_fma_f32 v200, v180, s44, -v93
    v_fma_f32 v218, -v180, s44, v94
    v_fma_f32 v201, v181, s44, -v93
    v_fma_f32 v219, -v181, s44, v94
    v_fma_f32 v202, v182, s44, -v93
    v_fma_f32 v220, -v182, s44, v94
    v_fma_f32 v203, v183, s44, -v93
    v_fma_f32 v221, -v183, s44, v94
    v_fma_f32 v204, v184, s44, -v93
    v_fma_f32 v222, -v184, s44, v94
    v_fma_f32 v205, v185, s44, -v93
    v_fma_f32 v223, -v185, s44, v94
    v_fma_f32 v206, v186, s44, -v93
    v_fma_f32 v224, -v186, s44, v94
    v_fma_f32 v207, v187, s44, -v93
    v_fma_f32 v225, -v187, s44, v94
    v_fma_f32 v208, v188, s44, -v93
    v_fma_f32 v226, -v188, s44, v94
    v_fma_f32 v209, v189, s44, -v93
    v_fma_f32 v227, -v189, s44, v94
    v_exp_f32 v192, v192
    v_exp_f32 v210, v210
    v_exp_f32 v193, v193
    v_exp_f32 v211, v211
    v_exp_f32 v194, v194
    v_exp_f32 v212, v212
    v_exp_f32 v195, v195
    v_exp_f32 v213, v213
    v_exp_f32 v196, v196
    v_exp_f32 v214, v214
    v_exp_f32 v197, v197
    v_exp_f32 v215, v215
    v_exp_f32 v198, v198
    v_exp_f32 v216, v216
    v_exp_f32 v199, v199
    v_exp_f32 v217, v217
    v_exp_f32 v200, v200
    v_exp_f32 v218, v218
    v_exp_f32 v201, v201
    v_exp_f32 v219, v219
    v_exp_f32 v202, v202
    v_exp_f32 v220, v220
    v_exp_f32 v203, v203
    v_exp_f32 v221, v221
    v_exp_f32 v204, v204
    v_exp_f32 v222, v222
    v_exp_f32 v205, v205
    v_exp_f32 v223, v223
    v_exp_f32 v206, v206
    v_exp_f32 v224, v224
    v_exp_f32 v207, v207
    v_exp_f32 v225, v225
    v_exp_f32 v208, v208
    v_exp_f32 v226, v226
    v_exp_f32 v209, v209
    v_exp_f32 v227, v227
    s_nop 0
    v_add_f32 v93, v192, v193
    v_add_f32 v94, v210, v211
    v_add_f32 v93, v93, v194
    v_add_f32 v94, v94, v212
    v_add_f32 v93, v93, v195
    v_add_f32 v94, v94, v213
    v_add_f32 v93, v93, v196
    v_add_f32 v94, v94, v214
    v_add_f32 v93, v93, v197
    v_add_f32 v94, v94, v215
    v_add_f32 v93, v93, v198
    v_add_f32 v94, v94, v216
    v_add_f32 v93, v93, v199
    v_add_f32 v94, v94, v217
    v_add_f32 v93, v93, v200
    v_add_f32 v94, v94, v218
    v_add_f32 v93, v93, v201
    v_add_f32 v94, v94, v219
    v_add_f32 v93, v93, v202
    v_add_f32 v94, v94, v220
    v_add_f32 v93, v93, v203
    v_add_f32 v94, v94, v221
    v_add_f32 v93, v93, v204
    v_add_f32 v94, v94, v222
    v_add_f32 v93, v93, v205
    v_add_f32 v94, v94, v223
    v_add_f32 v93, v93, v206
    v_add_f32 v94, v94, v224
    v_add_f32 v93, v93, v207
    v_add_f32 v94, v94, v225
    v_add_f32 v93, v93, v208
    v_add_f32 v94, v94, v226
    v_add_f32 v93, v93, v209
    v_add_f32 v94, v94, v227
    v_rcp_f32 v93, v93
    v_rcp_f32 v94, v94
    s_nop 0
    v_mul_f32 v192, v192, v93
    v_mul_f32 v210, v210, v94
    v_mul_f32 v193, v193, v93
    v_mul_f32 v211, v211, v94
    v_mul_f32 v194, v194, v93
    v_mul_f32 v212, v212, v94
    v_mul_f32 v195, v195, v93
    v_mul_f32 v213, v213, v94
    v_mul_f32 v196, v196, v93
    v_mul_f32 v214, v214, v94
    v_mul_f32 v197, v197, v93
    v_mul_f32 v215, v215, v94
    v_mul_f32 v198, v198, v93
    v_mul_f32 v216, v216, v94
    v_mul_f32 v199, v199, v93
    v_mul_f32 v217, v217, v94
    v_mul_f32 v200, v200, v93
    v_mul_f32 v218, v218, v94
    v_mul_f32 v201, v201, v93
    v_mul_f32 v219, v219, v94
    v_mul_f32 v202, v202, v93
    v_mul_f32 v220, v220, v94
    v_mul_f32 v203, v203, v93
    v_mul_f32 v221, v221, v94
    v_mul_f32 v204, v204, v93
    v_mul_f32 v222, v222, v94
    v_mul_f32 v205, v205, v93
    v_mul_f32 v223, v223, v94
    v_mul_f32 v206, v206, v93
    v_mul_f32 v224, v224, v94
    v_mul_f32 v207, v207, v93
    v_mul_f32 v225, v225, v94
    v_mul_f32 v208, v208, v93
    v_mul_f32 v226, v226, v94
    v_mul_f32 v209, v209, v93
    v_mul_f32 v227, v227, v94
    v_cvt_pk_bf16_f32 v228, v192, v193
    v_cvt_pk_bf16_f32 v237, v210, v211
    v_cvt_pk_bf16_f32 v229, v194, v195
    v_cvt_pk_bf16_f32 v238, v212, v213
    v_cvt_pk_bf16_f32 v230, v196, v197
    v_cvt_pk_bf16_f32 v239, v214, v215
    v_cvt_pk_bf16_f32 v231, v198, v199
    v_cvt_pk_bf16_f32 v240, v216, v217
    v_cvt_pk_bf16_f32 v232, v200, v201
    v_cvt_pk_bf16_f32 v241, v218, v219
    v_cvt_pk_bf16_f32 v233, v202, v203
    v_cvt_pk_bf16_f32 v242, v220, v221
    v_cvt_pk_bf16_f32 v234, v204, v205
    v_cvt_pk_bf16_f32 v243, v222, v223
    v_cvt_pk_bf16_f32 v235, v206, v207
    v_cvt_pk_bf16_f32 v244, v224, v225
    v_cvt_pk_bf16_f32 v236, v208, v209
    v_cvt_pk_bf16_f32 v245, v226, v227
    s_mov_b64 exec, 0xffffffff
    v_add_u32 v95, 40960, v90
    buffer_store_dwordx4 v[228:231], v95, s[28:31], 0 offen offset:0
    buffer_store_dwordx4 v[232:235], v95, s[28:31], 0 offen offset:1024
    buffer_store_dwordx4 v[236:239], v95, s[28:31], 0 offen offset:2048
    buffer_store_dwordx4 v[240:243], v95, s[28:31], 0 offen offset:3072
    s_mov_b32 s46, 4096
    buffer_store_dwordx4 v[244:247], v95, s[28:31], s46 offen
    s_mov_b32 exec_lo, 0
    s_mov_b32 exec_hi, -1
    ds_write_b64 v91, v[228:229] offset:9856
    ds_write_b64 v91, v[230:231] offset:9864
    ds_write_b64 v91, v[232:233] offset:9872
    ds_write_b64 v91, v[234:235] offset:9880
    ds_write_b64 v91, v[236:237] offset:9888
    ds_write_b64 v91, v[238:239] offset:9896
    ds_write_b64 v91, v[240:241] offset:9904
    ds_write_b64 v91, v[242:243] offset:9912
    ds_write_b64 v91, v[244:245] offset:9920
    s_mov_b64 exec, -1
    s_nop 1
    s_waitcnt lgkmcnt(0)
    s_barrier
    s_and_b32 s45, s3, 1
    s_lshr_b32 s46, s3, 1
    v_lshrrev_b32 v9, 2, v3
    v_and_b32 v10, 3, v1
    v_lshl_add_u32 v9, v4, 3, v9
    v_mul_u32_u24 v11, 200, v9
    v_lshl_add_u32 v11, v10, 3, v11
    s_mul_i32 s47, s45, 96
    s_add_u32 s47, s47, 6656
    v_add_u32 v11, s47, v11
    v_mul_u32_u24 v12, 104, v9
    v_lshl_add_u32 v12, v10, 3, v12
    s_lshl_b32 s47, s45, 5
    s_lshl_b32 s50, s46, 5
    s_add_u32 s47, s47, s50
    s_add_u32 s47, s47, 32256
    v_add_u32 v12, s47, v12
    v_mov_b32 v96, 0x3f803f80
    v_mov_b32 v97, 0x3f803f80
    v_mov_b32 v98, 0x3f803f80
    v_mov_b32 v99, 0x3f803f80
    ds_read_b64_tr_b16 v[100:101], v12 offset:0
    ds_read_b64_tr_b16 v[102:103], v12 offset:416
    ds_read_b64_tr_b16 v[116:117], v11 offset:0
    ds_read_b64_tr_b16 v[118:119], v11 offset:800
    ds_read_b64_tr_b16 v[132:133], v11 offset:32
    ds_read_b64_tr_b16 v[134:135], v11 offset:832
    ds_read_b64_tr_b16 v[148:149], v11 offset:64
    ds_read_b64_tr_b16 v[150:151], v11 offset:864
    ds_read_b64_tr_b16 v[104:105], v12 offset:3328
    ds_read_b64_tr_b16 v[106:107], v12 offset:3744
    ds_read_b64_tr_b16 v[120:121], v11 offset:6400
    ds_read_b64_tr_b16 v[122:123], v11 offset:7200
    ds_read_b64_tr_b16 v[136:137], v11 offset:6432
    ds_read_b64_tr_b16 v[138:139], v11 offset:7232
    ds_read_b64_tr_b16 v[152:153], v11 offset:6464
    ds_read_b64_tr_b16 v[154:155], v11 offset:7264
    ds_read_b64_tr_b16 v[108:109], v12 offset:6656
    ds_read_b64_tr_b16 v[110:111], v12 offset:7072
    ds_read_b64_tr_b16 v[124:125], v11 offset:12800
    ds_read_b64_tr_b16 v[126:127], v11 offset:13600
    ds_read_b64_tr_b16 v[140:141], v11 offset:12832
    ds_read_b64_tr_b16 v[142:143], v11 offset:13632
    ds_read_b64_tr_b16 v[156:157], v11 offset:12864
    ds_read_b64_tr_b16 v[158:159], v11 offset:13664
    ds_read_b64_tr_b16 v[112:113], v12 offset:9984
    ds_read_b64_tr_b16 v[114:115], v12 offset:10400
    ds_read_b64_tr_b16 v[128:129], v11 offset:19200
    ds_read_b64_tr_b16 v[130:131], v11 offset:20000
    ds_read_b64_tr_b16 v[144:145], v11 offset:19232
    ds_read_b64_tr_b16 v[146:147], v11 offset:20032
    ds_read_b64_tr_b16 v[160:161], v11 offset:19264
    ds_read_b64_tr_b16 v[162:163], v11 offset:20064
    s_waitcnt lgkmcnt(0)
    v_mfma_f32_16x16x32_bf16 v[24:27], v[100:103], v[116:119], 0
    v_mfma_f32_16x16x32_bf16 v[24:27], v[104:107], v[120:123], v[24:27]
    v_mfma_f32_16x16x32_bf16 v[24:27], v[108:111], v[124:127], v[24:27]
    v_mfma_f32_16x16x32_bf16 v[24:27], v[112:115], v[128:131], v[24:27]
    v_mfma_f32_16x16x32_bf16 v[28:31], v[100:103], v[132:135], 0
    v_mfma_f32_16x16x32_bf16 v[28:31], v[104:107], v[136:139], v[28:31]
    v_mfma_f32_16x16x32_bf16 v[28:31], v[108:111], v[140:143], v[28:31]
    v_mfma_f32_16x16x32_bf16 v[28:31], v[112:115], v[144:147], v[28:31]
    v_mfma_f32_16x16x32_bf16 v[32:35], v[100:103], v[148:151], 0
    v_mfma_f32_16x16x32_bf16 v[32:35], v[104:107], v[152:155], v[32:35]
    v_mfma_f32_16x16x32_bf16 v[32:35], v[108:111], v[156:159], v[32:35]
    v_mfma_f32_16x16x32_bf16 v[32:35], v[112:115], v[160:163], v[32:35]
    s_cmp_eq_u32 s46, 0
    s_cbranch_scc0 K1_NOZ
    v_mfma_f32_16x16x32_bf16 v[40:43], v[96:99], v[116:119], 0
    v_mfma_f32_16x16x32_bf16 v[40:43], v[96:99], v[120:123], v[40:43]
    v_mfma_f32_16x16x32_bf16 v[40:43], v[96:99], v[124:127], v[40:43]
    v_mfma_f32_16x16x32_bf16 v[40:43], v[96:99], v[128:131], v[40:43]
    v_mfma_f32_16x16x32_bf16 v[44:47], v[96:99], v[132:135], 0
    v_mfma_f32_16x16x32_bf16 v[44:47], v[96:99], v[136:139], v[44:47]
    v_mfma_f32_16x16x32_bf16 v[44:47], v[96:99], v[140:143], v[44:47]
    v_mfma_f32_16x16x32_bf16 v[44:47], v[96:99], v[144:147], v[44:47]
    v_mfma_f32_16x16x32_bf16 v[48:51], v[96:99], v[148:151], 0
    v_mfma_f32_16x16x32_bf16 v[48:51], v[96:99], v[152:155], v[48:51]
    v_mfma_f32_16x16x32_bf16 v[48:51], v[96:99], v[156:159], v[48:51]
    v_mfma_f32_16x16x32_bf16 v[48:51], v[96:99], v[160:163], v[48:51]
K1_NOZ:
    s_lshl_b32 s47, s41, 1
    s_add_u32 s47, s47, s45
    s_mul_i32 s47, s47, 3200
    s_lshl_b32 s50, s46, 4
    s_lshl_b32 s51, s45, 1
    s_sub_u32 s50, s50, s51
    v_lshl_add_u32 v9, v4, 2, s50
    v_lshlrev_b32 v10, 2, v3
    v_add_u32 v10, s47, v10
    v_cmp_gt_u32 s[52:53], 4, v3
    s_nop 7
    v_add_u32 v11, 0, v9
    v_cmp_gt_u32 s[54:55], 18, v11
    v_mul_u32_u24 v12, 160, v11
    v_add_u32 v12, v12, v10
    s_nop 1
    s_mov_b64 exec, s[54:55]
    buffer_atomic_add_f32 v24, v12, s[32:35], 0 offen
    buffer_atomic_add_f32 v28, v12, s[32:35], 0 offen offset:64
    s_and_b64 exec, s[54:55], s[52:53]
    buffer_atomic_add_f32 v32, v12, s[32:35], 0 offen offset:128
    s_mov_b64 exec, -1
    v_add_u32 v11, 1, v9
    v_cmp_gt_u32 s[54:55], 18, v11
    v_mul_u32_u24 v12, 160, v11
    v_add_u32 v12, v12, v10
    s_nop 1
    s_mov_b64 exec, s[54:55]
    buffer_atomic_add_f32 v25, v12, s[32:35], 0 offen
    buffer_atomic_add_f32 v29, v12, s[32:35], 0 offen offset:64
    s_and_b64 exec, s[54:55], s[52:53]
    buffer_atomic_add_f32 v33, v12, s[32:35], 0 offen offset:128
    s_mov_b64 exec, -1
    v_add_u32 v11, 2, v9
    v_cmp_gt_u32 s[54:55], 18, v11
    v_mul_u32_u24 v12, 160, v11
    v_add_u32 v12, v12, v10
    s_nop 1
    s_mov_b64 exec, s[54:55]
    buffer_atomic_add_f32 v26, v12, s[32:35], 0 offen
    buffer_atomic_add_f32 v30, v12, s[32:35], 0 offen offset:64
    s_and_b64 exec, s[54:55], s[52:53]
    buffer_atomic_add_f32 v34, v12, s[32:35], 0 offen offset:128
    s_mov_b64 exec, -1
    v_add_u32 v11, 3, v9
    v_cmp_gt_u32 s[54:55], 18, v11
    v_mul_u32_u24 v12, 160, v11
    v_add_u32 v12, v12, v10
    s_nop 1
    s_mov_b64 exec, s[54:55]
    buffer_atomic_add_f32 v27, v12, s[32:35], 0 offen
    buffer_atomic_add_f32 v31, v12, s[32:35], 0 offen offset:64
    s_and_b64 exec, s[54:55], s[52:53]
    buffer_atomic_add_f32 v35, v12, s[32:35], 0 offen offset:128
    s_mov_b64 exec, -1
    s_cmp_eq_u32 s46, 0
    s_cbranch_scc0 K1_END2
    s_mov_b64 exec, 0xffff
    buffer_atomic_add_f32 v40, v10, s[32:35], 0 offen offset:2880
    buffer_atomic_add_f32 v44, v10, s[32:35], 0 offen offset:2944
    s_mov_b64 exec, 0xf
    buffer_atomic_add_f32 v48, v10, s[32:35], 0 offen offset:3008
K1_END2:
K1_END:
    s_endpgm
.globl k2_kernel
.p2align 8
.type k2_kernel,@function
k2_kernel:
    s_cmp_ge_u32 s2, 256
    s_cbranch_scc1 K2_END
    s_cmp_ge_u32 s2, 128
    s_cbranch_scc1 K2_COPY
    s_load_dwordx2 s[4:5], s[0:1], 96
    s_load_dwordx2 s[8:9], s[0:1], 0
    v_lshrrev_b32 v2, 6, v0
    v_and_b32 v1, 63, v0
    s_nop 0
    v_readfirstlane_b32 s3, v2
    s_lshl_b32 s40, s2, 4
    s_waitcnt lgkmcnt(0)
    s_add_u32 s12, s4, 68485120
    s_addc_u32 s13, s5, 0
    s_and_b32 s13, s13, 0xffff
    s_mov_b32 s14, 663552
    s_mov_b32 s15, 0x00020000
    s_mov_b32 s16, s8
    s_and_b32 s17, s9, 0xffff
    s_mov_b32 s18, 2359296
    s_mov_b32 s19, 0x00020000
    s_add_u32 s20, s4, 0
    s_addc_u32 s21, s5, 0
    s_and_b32 s21, s21, 0xffff
    s_mov_b32 s22, 13824
    s_mov_b32 s23, 0x00020000
    s_add_u32 s24, s4, 16384
    s_addc_u32 s25, s5, 0
    s_and_b32 s25, s25, 0xffff
    s_mov_b32 s26, 102400
    s_mov_b32 s27, 0x00020000
    s_add_u32 s28, s4, 2490368
    s_addc_u32 s29, s5, 0
    s_and_b32 s29, s29, 0xffff
    s_mov_b32 s30, 5242880
    s_mov_b32 s31, 0x00020000
    s_add_u32 s32, s4, 7733248
    s_addc_u32 s33, s5, 0
    s_and_b32 s33, s33, 0xffff
    s_mov_b32 s34, 2359296
    s_mov_b32 s35, 0x00020000
    s_add_u32 s36, s4, 10092544
    s_addc_u32 s37, s5, 0
    s_and_b32 s37, s37, 0xffff
    s_mov_b32 s38, 2359296
    s_mov_b32 s39, 0x00020000
    v_and_b32 v3, 15, v1
    v_lshrrev_b32 v4, 4, v1
    s_mul_i32 s47, s3, 9216
    v_lshlrev_b32 v230, 4, v1
    v_add_u32 v230, s47, v230
    v_lshlrev_b32 v8, 4, v1
    s_lshl_b32 s48, s3, 11
    s_add_u32 s48, s48, 0
    s_add_u32 m0, s48, 73728
    s_add_u32 s48, s48, 4608
    buffer_load_dwordx4 v8, s[20:23], s48 offen lds
    s_lshl_b32 s48, s3, 11
    s_add_u32 s48, s48, 1024
    s_add_u32 m0, s48, 73728
    s_add_u32 s48, s48, 4608
    buffer_load_dwordx4 v8, s[20:23], s48 offen lds
    s_lshl_b32 s48, s2, 3
    s_lshl_b32 s49, s3, 1
    s_add_u32 s48, s48, s49
    s_mul_i32 s48, s48, 5120
    v_lshlrev_b32 v8, 4, v1
    v_add_u32 v8, s48, v8
    s_mov_b32 s48, 0
    buffer_load_dwordx4 v[100:103], v8, s[28:31], s48 offen offset:0
    buffer_load_dwordx4 v[104:107], v8, s[28:31], s48 offen offset:1024
    buffer_load_dwordx4 v[108:111], v8, s[28:31], s48 offen offset:2048
    buffer_load_dwordx4 v[112:115], v8, s[28:31], s48 offen offset:3072
    s_mov_b32 s48, 4096
    buffer_load_dwordx4 v[116:119], v8, s[28:31], s48 offen
    s_mov_b32 s48, 5120
    buffer_load_dwordx4 v[120:123], v8, s[28:31], s48 offen offset:0
    buffer_load_dwordx4 v[124:127], v8, s[28:31], s48 offen offset:1024
    buffer_load_dwordx4 v[128:131], v8, s[28:31], s48 offen offset:2048
    buffer_load_dwordx4 v[132:135], v8, s[28:31], s48 offen offset:3072
    s_mov_b32 s48, 9216
    buffer_load_dwordx4 v[136:139], v8, s[28:31], s48 offen
    v_lshlrev_b32 v8, 4, v0
    v_lshlrev_b32 v9, 3, v0
    s_mov_b32 s48, 0
    buffer_load_dwordx4 v[24:27], v8, s[24:27], s48 offen
    s_mov_b32 s48, 4096
    buffer_load_dwordx4 v[28:31], v8, s[24:27], s48 offen
    s_mov_b32 s48, 8192
    buffer_load_dwordx4 v[32:35], v8, s[24:27], s48 offen
    s_mov_b32 s48, 12288
    buffer_load_dwordx4 v[36:39], v8, s[24:27], s48 offen
    s_mov_b32 s48, 16384
    buffer_load_dwordx4 v[40:43], v8, s[24:27], s48 offen
    s_mov_b32 s48, 20480
    buffer_load_dwordx4 v[44:47], v8, s[24:27], s48 offen
    s_mov_b32 s48, 24576
    buffer_load_dwordx4 v[48:51], v8, s[24:27], s48 offen
    s_mov_b32 s48, 28672
    buffer_load_dwordx4 v[52:55], v8, s[24:27], s48 offen
    s_mov_b32 s48, 32768
    buffer_load_dwordx4 v[56:59], v8, s[24:27], s48 offen
    s_mov_b32 s48, 36864
    buffer_load_dwordx4 v[60:63], v8, s[24:27], s48 offen
    s_mov_b32 s48, 40960
    buffer_load_dwordx4 v[64:67], v8, s[24:27], s48 offen
    s_mov_b32 s48, 45056
    buffer_load_dwordx4 v[68:71], v8, s[24:27], s48 offen
    s_mov_b32 s48, 49152
    buffer_load_dwordx4 v[72:75], v8, s[24:27], s48 offen
    s_mov_b32 s48, 0
    s_add_u32 m0, s47, 90112
    s_nop 0
    buffer_load_dwordx4 v230, s[12:15], s48 offen lds
    s_mov_b32 s48, 1024
    s_add_u32 m0, s47, 91136
    s_nop 0
    buffer_load_dwordx4 v230, s[12:15], s48 offen lds
    s_mov_b32 s48, 2048
    s_add_u32 m0, s47, 92160
    s_nop 0
    buffer_load_dwordx4 v230, s[12:15], s48 offen lds
    s_mov_b32 s48, 3072
    s_add_u32 m0, s47, 93184
    s_nop 0
    buffer_load_dwordx4 v230, s[12:15], s48 offen lds
    s_mov_b32 s48, 4096
    s_add_u32 m0, s47, 94208
    s_nop 0
    buffer_load_dwordx4 v230, s[12:15], s48 offen lds
    s_mov_b32 s48, 5120
    s_add_u32 m0, s47, 95232
    s_nop 0
    buffer_load_dwordx4 v230, s[12:15], s48 offen lds
    s_mov_b32 s48, 6144
    s_add_u32 m0, s47, 96256
    s_nop 0
    buffer_load_dwordx4 v230, s[12:15], s48 offen lds
    s_mov_b32 s48, 7168
    s_add_u32 m0, s47, 97280
    s_nop 0
    buffer_load_dwordx4 v230, s[12:15], s48 offen lds
    s_mov_b32 s48, 8192
    s_add_u32 m0, s47, 98304
    s_nop 0
    buffer_load_dwordx4 v230, s[12:15], s48 offen lds
    s_waitcnt vmcnt(9)
    v_cvt_pk_bf16_f32 v24, v24, v25
    v_cvt_pk_bf16_f32 v25, v26, v27
    ds_write_b64 v9, v[24:25] offset:0
    v_cvt_pk_bf16_f32 v28, v28, v29
    v_cvt_pk_bf16_f32 v29, v30, v31
    ds_write_b64 v9, v[28:29] offset:2048
    v_cvt_pk_bf16_f32 v32, v32, v33
    v_cvt_pk_bf16_f32 v33, v34, v35
    ds_write_b64 v9, v[32:33] offset:4096
    v_cvt_pk_bf16_f32 v36, v36, v37
    v_cvt_pk_bf16_f32 v37, v38, v39
    ds_write_b64 v9, v[36:37] offset:6144
    v_cvt_pk_bf16_f32 v40, v40, v41
    v_cvt_pk_bf16_f32 v41, v42, v43
    ds_write_b64 v9, v[40:41] offset:8192
    v_cvt_pk_bf16_f32 v44, v44, v45
    v_cvt_pk_bf16_f32 v45, v46, v47
    ds_write_b64 v9, v[44:45] offset:10240
    v_cvt_pk_bf16_f32 v48, v48, v49
    v_cvt_pk_bf16_f32 v49, v50, v51
    ds_write_b64 v9, v[48:49] offset:12288
    v_cvt_pk_bf16_f32 v52, v52, v53
    v_cvt_pk_bf16_f32 v53, v54, v55
    ds_write_b64 v9, v[52:53] offset:14336
    v_cvt_pk_bf16_f32 v56, v56, v57
    v_cvt_pk_bf16_f32 v57, v58, v59
    ds_write_b64 v9, v[56:57] offset:16384
    v_cvt_pk_bf16_f32 v60, v60, v61
    v_cvt_pk_bf16_f32 v61, v62, v63
    ds_write_b64 v9, v[60:61] offset:18432
    v_cvt_pk_bf16_f32 v64, v64, v65
    v_cvt_pk_bf16_f32 v65, v66, v67
    ds_write_b64 v9, v[64:65] offset:20480
    v_cvt_pk_bf16_f32 v68, v68, v69
    v_cvt_pk_bf16_f32 v69, v70, v71
    ds_write_b64 v9, v[68:69] offset:22528
    v_cvt_pk_bf16_f32 v72, v72, v73
    v_cvt_pk_bf16_f32 v73, v74, v75
    ds_write_b64 v9, v[72:73] offset:24576
    s_mov_b32 s48, 53248
    buffer_load_dwordx4 v[24:27], v8, s[24:27], s48 offen
    s_mov_b32 s48, 57344
    buffer_load_dwordx4 v[28:31], v8, s[24:27], s48 offen
    s_mov_b32 s48, 61440
    buffer_load_dwordx4 v[32:35], v8, s[24:27], s48 offen
    s_mov_b32 s48, 65536
    buffer_load_dwordx4 v[36:39], v8, s[24:27], s48 offen
    s_mov_b32 s48, 69632
    buffer_load_dwordx4 v[40:43], v8, s[24:27], s48 offen
    s_mov_b32 s48, 73728
    buffer_load_dwordx4 v[44:47], v8, s[24:27], s48 offen
    s_mov_b32 s48, 77824
    buffer_load_dwordx4 v[48:51], v8, s[24:27], s48 offen
    s_mov_b32 s48, 81920
    buffer_load_dwordx4 v[52:55], v8, s[24:27], s48 offen
    s_mov_b32 s48, 86016
    buffer_load_dwordx4 v[56:59], v8, s[24:27], s48 offen
    s_mov_b32 s48, 90112
    buffer_load_dwordx4 v[60:63], v8, s[24:27], s48 offen
    s_mov_b32 s48, 94208
    buffer_load_dwordx4 v[64:67], v8, s[24:27], s48 offen
    s_mov_b32 s48, 98304
    buffer_load_dwordx4 v[68:71], v8, s[24:27], s48 offen
    s_mov_b32 s48, 36864
    s_add_u32 m0, s47, 126976
    s_nop 0
    buffer_load_dwordx4 v230, s[12:15], s48 offen lds
    s_mov_b32 s48, 37888
    s_add_u32 m0, s47, 128000
    s_nop 0
    buffer_load_dwordx4 v230, s[12:15], s48 offen lds
    s_mov_b32 s48, 38912
    s_add_u32 m0, s47, 129024
    s_nop 0
    buffer_load_dwordx4 v230, s[12:15], s48 offen lds
    s_mov_b32 s48, 39936
    s_add_u32 m0, s47, 130048
    s_nop 0
    buffer_load_dwordx4 v230, s[12:15], s48 offen lds
    s_mov_b32 s48, 40960
    s_add_u32 m0, s47, 131072
    s_nop 0
    buffer_load_dwordx4 v230, s[12:15], s48 offen lds
    s_mov_b32 s48, 41984
    s_add_u32 m0, s47, 132096
    s_nop 0
    buffer_load_dwordx4 v230, s[12:15], s48 offen lds
    s_mov_b32 s48, 43008
    s_add_u32 m0, s47, 133120
    s_nop 0
    buffer_load_dwordx4 v230, s[12:15], s48 offen lds
    s_mov_b32 s48, 44032
    s_add_u32 m0, s47, 134144
    s_nop 0
    buffer_load_dwordx4 v230, s[12:15], s48 offen lds
    s_mov_b32 s48, 45056
    s_add_u32 m0, s47, 135168
    s_nop 0
    buffer_load_dwordx4 v230, s[12:15], s48 offen lds
    s_waitcnt vmcnt(9)
    v_cvt_pk_bf16_f32 v24, v24, v25
    v_cvt_pk_bf16_f32 v25, v26, v27
    ds_write_b64 v9, v[24:25] offset:26624
    v_cvt_pk_bf16_f32 v28, v28, v29
    v_cvt_pk_bf16_f32 v29, v30, v31
    ds_write_b64 v9, v[28:29] offset:28672
    v_cvt_pk_bf16_f32 v32, v32, v33
    v_cvt_pk_bf16_f32 v33, v34, v35
    ds_write_b64 v9, v[32:33] offset:30720
    v_cvt_pk_bf16_f32 v36, v36, v37
    v_cvt_pk_bf16_f32 v37, v38, v39
    ds_write_b64 v9, v[36:37] offset:32768
    v_cvt_pk_bf16_f32 v40, v40, v41
    v_cvt_pk_bf16_f32 v41, v42, v43
    ds_write_b64 v9, v[40:41] offset:34816
    v_cvt_pk_bf16_f32 v44, v44, v45
    v_cvt_pk_bf16_f32 v45, v46, v47
    ds_write_b64 v9, v[44:45] offset:36864
    v_cvt_pk_bf16_f32 v48, v48, v49
    v_cvt_pk_bf16_f32 v49, v50, v51
    ds_write_b64 v9, v[48:49] offset:38912
    v_cvt_pk_bf16_f32 v52, v52, v53
    v_cvt_pk_bf16_f32 v53, v54, v55
    ds_write_b64 v9, v[52:53] offset:40960
    v_cvt_pk_bf16_f32 v56, v56, v57
    v_cvt_pk_bf16_f32 v57, v58, v59
    ds_write_b64 v9, v[56:57] offset:43008
    v_cvt_pk_bf16_f32 v60, v60, v61
    v_cvt_pk_bf16_f32 v61, v62, v63
    ds_write_b64 v9, v[60:61] offset:45056
    v_cvt_pk_bf16_f32 v64, v64, v65
    v_cvt_pk_bf16_f32 v65, v66, v67
    ds_write_b64 v9, v[64:65] offset:47104
    v_cvt_pk_bf16_f32 v68, v68, v69
    v_cvt_pk_bf16_f32 v69, v70, v71
    ds_write_b64 v9, v[68:69] offset:49152
    s_waitcnt lgkmcnt(0)
    s_barrier
    v_lshrrev_b32 v9, 2, v3
    v_and_b32 v10, 3, v1
    v_cmp_eq_u32 s[50:51], v9, v4
    v_mul_u32_u24 v11, 1600, v9
    v_mul_u32_u24 v12, 80, v10
    s_mul_i32 s48, s3, 12800
    v_add3_u32 v11, v11, v12, s48
    v_mul_u32_u24 v12, 1168, v3
    v_mul_u32_u24 v13, 36, v4
    s_mul_i32 s48, s3, 288
    v_add3_u32 v12, v12, v13, s48
    v_add_u32 v12, 51200, v12
    s_mov_b32 s49, 0x358637bd
    ds_read_b128 v[24:27], v11 offset:0
    ds_read_b128 v[28:31], v11 offset:16
    ds_read_b128 v[32:35], v11 offset:32
    ds_read_b128 v[36:39], v11 offset:48
    ds_read_b128 v[40:43], v11 offset:64
    ds_read_b128 v[44:47], v11 offset:320
    ds_read_b128 v[48:51], v11 offset:336
    ds_read_b128 v[52:55], v11 offset:352
    ds_read_b128 v[56:59], v11 offset:368
    ds_read_b128 v[60:63], v11 offset:384
    ds_read_b128 v[64:67], v11 offset:640
    ds_read_b128 v[68:71], v11 offset:656
    ds_read_b128 v[72:75], v11 offset:672
    ds_read_b128 v[76:79], v11 offset:688
    ds_read_b128 v[80:83], v11 offset:704
    ds_read_b128 v[140:143], v11 offset:960
    ds_read_b128 v[144:147], v11 offset:976
    ds_read_b128 v[148:151], v11 offset:992
    ds_read_b128 v[152:155], v11 offset:1008
    ds_read_b128 v[156:159], v11 offset:1024
    ds_read_b128 v[160:163], v11 offset:1280
    ds_read_b128 v[164:167], v11 offset:1296
    ds_read_b128 v[168:171], v11 offset:1312
    ds_read_b128 v[172:175], v11 offset:1328
    ds_read_b128 v[176:179], v11 offset:1344
    s_waitcnt lgkmcnt(0)
    v_cndmask_b32 v24, 0, v24, s[50:51]
    v_cndmask_b32 v25, 0, v25, s[50:51]
    v_cndmask_b32 v26, 0, v26, s[50:51]
    v_cndmask_b32 v27, 0, v27, s[50:51]
    v_cndmask_b32 v28, 0, v28, s[50:51]
    v_cndmask_b32 v29, 0, v29, s[50:51]
    v_cndmask_b32 v30, 0, v30, s[50:51]
    v_cndmask_b32 v31, 0, v31, s[50:51]
    v_cndmask_b32 v32, 0, v32, s[50:51]
    v_cndmask_b32 v33, 0, v33, s[50:51]
    v_cndmask_b32 v34, 0, v34, s[50:51]
    v_cndmask_b32 v35, 0, v35, s[50:51]
    v_cndmask_b32 v36, 0, v36, s[50:51]
    v_cndmask_b32 v37, 0, v37, s[50:51]
    v_cndmask_b32 v38, 0, v38, s[50:51]
    v_cndmask_b32 v39, 0, v39, s[50:51]
    v_cndmask_b32 v40, 0, v40, s[50:51]
    v_cndmask_b32 v41, 0, v41, s[50:51]
    v_cndmask_b32 v42, 0, v42, s[50:51]
    v_cndmask_b32 v43, 0, v43, s[50:51]
    v_cndmask_b32 v44, 0, v44, s[50:51]
    v_cndmask_b32 v45, 0, v45, s[50:51]
    v_cndmask_b32 v46, 0, v46, s[50:51]
    v_cndmask_b32 v47, 0, v47, s[50:51]
    v_cndmask_b32 v48, 0, v48, s[50:51]
    v_cndmask_b32 v49, 0, v49, s[50:51]
    v_cndmask_b32 v50, 0, v50, s[50:51]
    v_cndmask_b32 v51, 0, v51, s[50:51]
    v_cndmask_b32 v52, 0, v52, s[50:51]
    v_cndmask_b32 v53, 0, v53, s[50:51]
    v_cndmask_b32 v54, 0, v54, s[50:51]
    v_cndmask_b32 v55, 0, v55, s[50:51]
    v_cndmask_b32 v56, 0, v56, s[50:51]
    v_cndmask_b32 v57, 0, v57, s[50:51]
    v_cndmask_b32 v58, 0, v58, s[50:51]
    v_cndmask_b32 v59, 0, v59, s[50:51]
    v_cndmask_b32 v60, 0, v60, s[50:51]
    v_cndmask_b32 v61, 0, v61, s[50:51]
    v_cndmask_b32 v62, 0, v62, s[50:51]
    v_cndmask_b32 v63, 0, v63, s[50:51]
    v_cndmask_b32 v64, 0, v64, s[50:51]
    v_cndmask_b32 v65, 0, v65, s[50:51]
    v_cndmask_b32 v66, 0, v66, s[50:51]
    v_cndmask_b32 v67, 0, v67, s[50:51]
    v_cndmask_b32 v68, 0, v68, s[50:51]
    v_cndmask_b32 v69, 0, v69, s[50:51]
    v_cndmask_b32 v70, 0, v70, s[50:51]
    v_cndmask_b32 v71, 0, v71, s[50:51]
    v_cndmask_b32 v72, 0, v72, s[50:51]
    v_cndmask_b32 v73, 0, v73, s[50:51]
    v_cndmask_b32 v74, 0, v74, s[50:51]
    v_cndmask_b32 v75, 0, v75, s[50:51]
    v_cndmask_b32 v76, 0, v76, s[50:51]
    v_cndmask_b32 v77, 0, v77, s[50:51]
    v_cndmask_b32 v78, 0, v78, s[50:51]
    v_cndmask_b32 v79, 0, v79, s[50:51]
    v_cndmask_b32 v80, 0, v80, s[50:51]
    v_cndmask_b32 v81, 0, v81, s[50:51]
    v_cndmask_b32 v82, 0, v82, s[50:51]
    v_cndmask_b32 v83, 0, v83, s[50:51]
    v_cndmask_b32 v140, 0, v140, s[50:51]
    v_cndmask_b32 v141, 0, v141, s[50:51]
    v_cndmask_b32 v142, 0, v142, s[50:51]
    v_cndmask_b32 v143, 0, v143, s[50:51]
    v_cndmask_b32 v144, 0, v144, s[50:51]
    v_cndmask_b32 v145, 0, v145, s[50:51]
    v_cndmask_b32 v146, 0, v146, s[50:51]
    v_cndmask_b32 v147, 0, v147, s[50:51]
    v_cndmask_b32 v148, 0, v148, s[50:51]
    v_cndmask_b32 v149, 0, v149, s[50:51]
    v_cndmask_b32 v150, 0, v150, s[50:51]
    v_cndmask_b32 v151, 0, v151, s[50:51]
    v_cndmask_b32 v152, 0, v152, s[50:51]
    v_cndmask_b32 v153, 0, v153, s[50:51]
    v_cndmask_b32 v154, 0, v154, s[50:51]
    v_cndmask_b32 v155, 0, v155, s[50:51]
    v_cndmask_b32 v156, 0, v156, s[50:51]
    v_cndmask_b32 v157, 0, v157, s[50:51]
    v_cndmask_b32 v158, 0, v158, s[50:51]
    v_cndmask_b32 v159, 0, v159, s[50:51]
    v_cndmask_b32 v160, 0, v160, s[50:51]
    v_cndmask_b32 v161, 0, v161, s[50:51]
    v_cndmask_b32 v162, 0, v162, s[50:51]
    v_cndmask_b32 v163, 0, v163, s[50:51]
    v_cndmask_b32 v164, 0, v164, s[50:51]
    v_cndmask_b32 v165, 0, v165, s[50:51]
    v_cndmask_b32 v166, 0, v166, s[50:51]
    v_cndmask_b32 v167, 0, v167, s[50:51]
    v_cndmask_b32 v168, 0, v168, s[50:51]
    v_cndmask_b32 v169, 0, v169, s[50:51]
    v_cndmask_b32 v170, 0, v170, s[50:51]
    v_cndmask_b32 v171, 0, v171, s[50:51]
    v_cndmask_b32 v172, 0, v172, s[50:51]
    v_cndmask_b32 v173, 0, v173, s[50:51]
    v_cndmask_b32 v174, 0, v174, s[50:51]
    v_cndmask_b32 v175, 0, v175, s[50:51]
    v_cndmask_b32 v176, 0, v176, s[50:51]
    v_cndmask_b32 v177, 0, v177, s[50:51]
    v_cndmask_b32 v178, 0, v178, s[50:51]
    v_cndmask_b32 v179, 0, v179, s[50:51]
    s_nop 1
    v_mfma_f32_16x16x32_bf16 v[180:183], v[24:27], v[100:103], 0
    v_mfma_f32_16x16x32_bf16 v[180:183], v[28:31], v[104:107], v[180:183]
    v_mfma_f32_16x16x32_bf16 v[180:183], v[32:35], v[108:111], v[180:183]
    v_mfma_f32_16x16x32_bf16 v[180:183], v[36:39], v[112:115], v[180:183]
    v_mfma_f32_16x16x32_bf16 v[180:183], v[40:43], v[116:119], v[180:183]
    v_mfma_f32_16x16x32_bf16 v[184:187], v[44:47], v[100:103], 0
    v_mfma_f32_16x16x32_bf16 v[184:187], v[48:51], v[104:107], v[184:187]
    v_mfma_f32_16x16x32_bf16 v[184:187], v[52:55], v[108:111], v[184:187]
    v_mfma_f32_16x16x32_bf16 v[184:187], v[56:59], v[112:115], v[184:187]
    v_mfma_f32_16x16x32_bf16 v[184:187], v[60:63], v[116:119], v[184:187]
    v_mfma_f32_16x16x32_bf16 v[188:191], v[64:67], v[100:103], 0
    v_mfma_f32_16x16x32_bf16 v[188:191], v[68:71], v[104:107], v[188:191]
    v_mfma_f32_16x16x32_bf16 v[188:191], v[72:75], v[108:111], v[188:191]
    v_mfma_f32_16x16x32_bf16 v[188:191], v[76:79], v[112:115], v[188:191]
    v_mfma_f32_16x16x32_bf16 v[188:191], v[80:83], v[116:119], v[188:191]
    v_mfma_f32_16x16x32_bf16 v[192:195], v[140:143], v[100:103], 0
    v_mfma_f32_16x16x32_bf16 v[192:195], v[144:147], v[104:107], v[192:195]
    v_mfma_f32_16x16x32_bf16 v[192:195], v[148:151], v[108:111], v[192:195]
    v_mfma_f32_16x16x32_bf16 v[192:195], v[152:155], v[112:115], v[192:195]
    v_mfma_f32_16x16x32_bf16 v[192:195], v[156:159], v[116:119], v[192:195]
    v_mfma_f32_16x16x32_bf16 v[196:199], v[160:163], v[100:103], 0
    v_mfma_f32_16x16x32_bf16 v[196:199], v[164:167], v[104:107], v[196:199]
    v_mfma_f32_16x16x32_bf16 v[196:199], v[168:171], v[108:111], v[196:199]
    v_mfma_f32_16x16x32_bf16 v[196:199], v[172:175], v[112:115], v[196:199]
    v_mfma_f32_16x16x32_bf16 v[196:199], v[176:179], v[116:119], v[196:199]
    s_nop 9
    v_cvt_pk_bf16_f32 v198, v198, v198
    v_and_b32 v198, 0xffff0000, v198
    v_add_f32 v198, s49, v198
    v_cvt_pk_bf16_f32 v198, v198, v198
    v_and_b32 v198, 0xffff0000, v198
    v_rcp_f32 v198, v198
    v_cvt_pk_bf16_f32 v14, v180, v181
    v_lshlrev_b32 v15, 16, v14
    v_and_b32 v14, 0xffff0000, v14
    v_mul_f32 v15, v15, v198
    v_mul_f32 v14, v14, v198
    v_cvt_pk_bf16_f32 v14, v15, v14
    ds_write_b32 v12, v14 offset:0
    v_cvt_pk_bf16_f32 v14, v182, v183
    v_lshlrev_b32 v15, 16, v14
    v_and_b32 v14, 0xffff0000, v14
    v_mul_f32 v15, v15, v198
    v_mul_f32 v14, v14, v198
    v_cvt_pk_bf16_f32 v14, v15, v14
    ds_write_b32 v12, v14 offset:4
    v_cvt_pk_bf16_f32 v14, v184, v185
    v_lshlrev_b32 v15, 16, v14
    v_and_b32 v14, 0xffff0000, v14
    v_mul_f32 v15, v15, v198
    v_mul_f32 v14, v14, v198
    v_cvt_pk_bf16_f32 v14, v15, v14
    ds_write_b32 v12, v14 offset:8
    v_cvt_pk_bf16_f32 v14, v186, v187
    v_lshlrev_b32 v15, 16, v14
    v_and_b32 v14, 0xffff0000, v14
    v_mul_f32 v15, v15, v198
    v_mul_f32 v14, v14, v198
    v_cvt_pk_bf16_f32 v14, v15, v14
    ds_write_b32 v12, v14 offset:12
    v_cvt_pk_bf16_f32 v14, v188, v189
    v_lshlrev_b32 v15, 16, v14
    v_and_b32 v14, 0xffff0000, v14
    v_mul_f32 v15, v15, v198
    v_mul_f32 v14, v14, v198
    v_cvt_pk_bf16_f32 v14, v15, v14
    ds_write_b32 v12, v14 offset:16
    v_cvt_pk_bf16_f32 v14, v190, v191
    v_lshlrev_b32 v15, 16, v14
    v_and_b32 v14, 0xffff0000, v14
    v_mul_f32 v15, v15, v198
    v_mul_f32 v14, v14, v198
    v_cvt_pk_bf16_f32 v14, v15, v14
    ds_write_b32 v12, v14 offset:20
    v_cvt_pk_bf16_f32 v14, v192, v193
    v_lshlrev_b32 v15, 16, v14
    v_and_b32 v14, 0xffff0000, v14
    v_mul_f32 v15, v15, v198
    v_mul_f32 v14, v14, v198
    v_cvt_pk_bf16_f32 v14, v15, v14
    ds_write_b32 v12, v14 offset:24
    v_cvt_pk_bf16_f32 v14, v194, v195
    v_lshlrev_b32 v15, 16, v14
    v_and_b32 v14, 0xffff0000, v14
    v_mul_f32 v15, v15, v198
    v_mul_f32 v14, v14, v198
    v_cvt_pk_bf16_f32 v14, v15, v14
    ds_write_b32 v12, v14 offset:28
    v_cvt_pk_bf16_f32 v14, v196, v197
    v_lshlrev_b32 v15, 16, v14
    v_and_b32 v14, 0xffff0000, v14
    v_mul_f32 v15, v15, v198
    v_mul_f32 v14, v14, v198
    v_cvt_pk_bf16_f32 v14, v15, v14
    ds_write_b32 v12, v14 offset:32
    ds_read_b128 v[24:27], v11 offset:6400
    ds_read_b128 v[28:31], v11 offset:6416
    ds_read_b128 v[32:35], v11 offset:6432
    ds_read_b128 v[36:39], v11 offset:6448
    ds_read_b128 v[40:43], v11 offset:6464
    ds_read_b128 v[44:47], v11 offset:6720
    ds_read_b128 v[48:51], v11 offset:6736
    ds_read_b128 v[52:55], v11 offset:6752
    ds_read_b128 v[56:59], v11 offset:6768
    ds_read_b128 v[60:63], v11 offset:6784
    ds_read_b128 v[64:67], v11 offset:7040
    ds_read_b128 v[68:71], v11 offset:7056
    ds_read_b128 v[72:75], v11 offset:7072
    ds_read_b128 v[76:79], v11 offset:7088
    ds_read_b128 v[80:83], v11 offset:7104
    ds_read_b128 v[140:143], v11 offset:7360
    ds_read_b128 v[144:147], v11 offset:7376
    ds_read_b128 v[148:151], v11 offset:7392
    ds_read_b128 v[152:155], v11 offset:7408
    ds_read_b128 v[156:159], v11 offset:7424
    ds_read_b128 v[160:163], v11 offset:7680
    ds_read_b128 v[164:167], v11 offset:7696
    ds_read_b128 v[168:171], v11 offset:7712
    ds_read_b128 v[172:175], v11 offset:7728
    ds_read_b128 v[176:179], v11 offset:7744
    s_waitcnt lgkmcnt(0)
    v_cndmask_b32 v24, 0, v24, s[50:51]
    v_cndmask_b32 v25, 0, v25, s[50:51]
    v_cndmask_b32 v26, 0, v26, s[50:51]
    v_cndmask_b32 v27, 0, v27, s[50:51]
    v_cndmask_b32 v28, 0, v28, s[50:51]
    v_cndmask_b32 v29, 0, v29, s[50:51]
    v_cndmask_b32 v30, 0, v30, s[50:51]
    v_cndmask_b32 v31, 0, v31, s[50:51]
    v_cndmask_b32 v32, 0, v32, s[50:51]
    v_cndmask_b32 v33, 0, v33, s[50:51]
    v_cndmask_b32 v34, 0, v34, s[50:51]
    v_cndmask_b32 v35, 0, v35, s[50:51]
    v_cndmask_b32 v36, 0, v36, s[50:51]
    v_cndmask_b32 v37, 0, v37, s[50:51]
    v_cndmask_b32 v38, 0, v38, s[50:51]
    v_cndmask_b32 v39, 0, v39, s[50:51]
    v_cndmask_b32 v40, 0, v40, s[50:51]
    v_cndmask_b32 v41, 0, v41, s[50:51]
    v_cndmask_b32 v42, 0, v42, s[50:51]
    v_cndmask_b32 v43, 0, v43, s[50:51]
    v_cndmask_b32 v44, 0, v44, s[50:51]
    v_cndmask_b32 v45, 0, v45, s[50:51]
    v_cndmask_b32 v46, 0, v46, s[50:51]
    v_cndmask_b32 v47, 0, v47, s[50:51]
    v_cndmask_b32 v48, 0, v48, s[50:51]
    v_cndmask_b32 v49, 0, v49, s[50:51]
    v_cndmask_b32 v50, 0, v50, s[50:51]
    v_cndmask_b32 v51, 0, v51, s[50:51]
    v_cndmask_b32 v52, 0, v52, s[50:51]
    v_cndmask_b32 v53, 0, v53, s[50:51]
    v_cndmask_b32 v54, 0, v54, s[50:51]
    v_cndmask_b32 v55, 0, v55, s[50:51]
    v_cndmask_b32 v56, 0, v56, s[50:51]
    v_cndmask_b32 v57, 0, v57, s[50:51]
    v_cndmask_b32 v58, 0, v58, s[50:51]
    v_cndmask_b32 v59, 0, v59, s[50:51]
    v_cndmask_b32 v60, 0, v60, s[50:51]
    v_cndmask_b32 v61, 0, v61, s[50:51]
    v_cndmask_b32 v62, 0, v62, s[50:51]
    v_cndmask_b32 v63, 0, v63, s[50:51]
    v_cndmask_b32 v64, 0, v64, s[50:51]
    v_cndmask_b32 v65, 0, v65, s[50:51]
    v_cndmask_b32 v66, 0, v66, s[50:51]
    v_cndmask_b32 v67, 0, v67, s[50:51]
    v_cndmask_b32 v68, 0, v68, s[50:51]
    v_cndmask_b32 v69, 0, v69, s[50:51]
    v_cndmask_b32 v70, 0, v70, s[50:51]
    v_cndmask_b32 v71, 0, v71, s[50:51]
    v_cndmask_b32 v72, 0, v72, s[50:51]
    v_cndmask_b32 v73, 0, v73, s[50:51]
    v_cndmask_b32 v74, 0, v74, s[50:51]
    v_cndmask_b32 v75, 0, v75, s[50:51]
    v_cndmask_b32 v76, 0, v76, s[50:51]
    v_cndmask_b32 v77, 0, v77, s[50:51]
    v_cndmask_b32 v78, 0, v78, s[50:51]
    v_cndmask_b32 v79, 0, v79, s[50:51]
    v_cndmask_b32 v80, 0, v80, s[50:51]
    v_cndmask_b32 v81, 0, v81, s[50:51]
    v_cndmask_b32 v82, 0, v82, s[50:51]
    v_cndmask_b32 v83, 0, v83, s[50:51]
    v_cndmask_b32 v140, 0, v140, s[50:51]
    v_cndmask_b32 v141, 0, v141, s[50:51]
    v_cndmask_b32 v142, 0, v142, s[50:51]
    v_cndmask_b32 v143, 0, v143, s[50:51]
    v_cndmask_b32 v144, 0, v144, s[50:51]
    v_cndmask_b32 v145, 0, v145, s[50:51]
    v_cndmask_b32 v146, 0, v146, s[50:51]
    v_cndmask_b32 v147, 0, v147, s[50:51]
    v_cndmask_b32 v148, 0, v148, s[50:51]
    v_cndmask_b32 v149, 0, v149, s[50:51]
    v_cndmask_b32 v150, 0, v150, s[50:51]
    v_cndmask_b32 v151, 0, v151, s[50:51]
    v_cndmask_b32 v152, 0, v152, s[50:51]
    v_cndmask_b32 v153, 0, v153, s[50:51]
    v_cndmask_b32 v154, 0, v154, s[50:51]
    v_cndmask_b32 v155, 0, v155, s[50:51]
    v_cndmask_b32 v156, 0, v156, s[50:51]
    v_cndmask_b32 v157, 0, v157, s[50:51]
    v_cndmask_b32 v158, 0, v158, s[50:51]
    v_cndmask_b32 v159, 0, v159, s[50:51]
    v_cndmask_b32 v160, 0, v160, s[50:51]
    v_cndmask_b32 v161, 0, v161, s[50:51]
    v_cndmask_b32 v162, 0, v162, s[50:51]
    v_cndmask_b32 v163, 0, v163, s[50:51]
    v_cndmask_b32 v164, 0, v164, s[50:51]
    v_cndmask_b32 v165, 0, v165, s[50:51]
    v_cndmask_b32 v166, 0, v166, s[50:51]
    v_cndmask_b32 v167, 0, v167, s[50:51]
    v_cndmask_b32 v168, 0, v168, s[50:51]
    v_cndmask_b32 v169, 0, v169, s[50:51]
    v_cndmask_b32 v170, 0, v170, s[50:51]
    v_cndmask_b32 v171, 0, v171, s[50:51]
    v_cndmask_b32 v172, 0, v172, s[50:51]
    v_cndmask_b32 v173, 0, v173, s[50:51]
    v_cndmask_b32 v174, 0, v174, s[50:51]
    v_cndmask_b32 v175, 0, v175, s[50:51]
    v_cndmask_b32 v176, 0, v176, s[50:51]
    v_cndmask_b32 v177, 0, v177, s[50:51]
    v_cndmask_b32 v178, 0, v178, s[50:51]
    v_cndmask_b32 v179, 0, v179, s[50:51]
    s_nop 1
    v_mfma_f32_16x16x32_bf16 v[180:183], v[24:27], v[120:123], 0
    v_mfma_f32_16x16x32_bf16 v[180:183], v[28:31], v[124:127], v[180:183]
    v_mfma_f32_16x16x32_bf16 v[180:183], v[32:35], v[128:131], v[180:183]
    v_mfma_f32_16x16x32_bf16 v[180:183], v[36:39], v[132:135], v[180:183]
    v_mfma_f32_16x16x32_bf16 v[180:183], v[40:43], v[136:139], v[180:183]
    v_mfma_f32_16x16x32_bf16 v[184:187], v[44:47], v[120:123], 0
    v_mfma_f32_16x16x32_bf16 v[184:187], v[48:51], v[124:127], v[184:187]
    v_mfma_f32_16x16x32_bf16 v[184:187], v[52:55], v[128:131], v[184:187]
    v_mfma_f32_16x16x32_bf16 v[184:187], v[56:59], v[132:135], v[184:187]
    v_mfma_f32_16x16x32_bf16 v[184:187], v[60:63], v[136:139], v[184:187]
    v_mfma_f32_16x16x32_bf16 v[188:191], v[64:67], v[120:123], 0
    v_mfma_f32_16x16x32_bf16 v[188:191], v[68:71], v[124:127], v[188:191]
    v_mfma_f32_16x16x32_bf16 v[188:191], v[72:75], v[128:131], v[188:191]
    v_mfma_f32_16x16x32_bf16 v[188:191], v[76:79], v[132:135], v[188:191]
    v_mfma_f32_16x16x32_bf16 v[188:191], v[80:83], v[136:139], v[188:191]
    v_mfma_f32_16x16x32_bf16 v[192:195], v[140:143], v[120:123], 0
    v_mfma_f32_16x16x32_bf16 v[192:195], v[144:147], v[124:127], v[192:195]
    v_mfma_f32_16x16x32_bf16 v[192:195], v[148:151], v[128:131], v[192:195]
    v_mfma_f32_16x16x32_bf16 v[192:195], v[152:155], v[132:135], v[192:195]
    v_mfma_f32_16x16x32_bf16 v[192:195], v[156:159], v[136:139], v[192:195]
    v_mfma_f32_16x16x32_bf16 v[196:199], v[160:163], v[120:123], 0
    v_mfma_f32_16x16x32_bf16 v[196:199], v[164:167], v[124:127], v[196:199]
    v_mfma_f32_16x16x32_bf16 v[196:199], v[168:171], v[128:131], v[196:199]
    v_mfma_f32_16x16x32_bf16 v[196:199], v[172:175], v[132:135], v[196:199]
    v_mfma_f32_16x16x32_bf16 v[196:199], v[176:179], v[136:139], v[196:199]
    s_nop 9
    v_cvt_pk_bf16_f32 v198, v198, v198
    v_and_b32 v198, 0xffff0000, v198
    v_add_f32 v198, s49, v198
    v_cvt_pk_bf16_f32 v198, v198, v198
    v_and_b32 v198, 0xffff0000, v198
    v_rcp_f32 v198, v198
    v_cvt_pk_bf16_f32 v14, v180, v181
    v_lshlrev_b32 v15, 16, v14
    v_and_b32 v14, 0xffff0000, v14
    v_mul_f32 v15, v15, v198
    v_mul_f32 v14, v14, v198
    v_cvt_pk_bf16_f32 v14, v15, v14
    ds_write_b32 v12, v14 offset:144
    v_cvt_pk_bf16_f32 v14, v182, v183
    v_lshlrev_b32 v15, 16, v14
    v_and_b32 v14, 0xffff0000, v14
    v_mul_f32 v15, v15, v198
    v_mul_f32 v14, v14, v198
    v_cvt_pk_bf16_f32 v14, v15, v14
    ds_write_b32 v12, v14 offset:148
    v_cvt_pk_bf16_f32 v14, v184, v185
    v_lshlrev_b32 v15, 16, v14
    v_and_b32 v14, 0xffff0000, v14
    v_mul_f32 v15, v15, v198
    v_mul_f32 v14, v14, v198
    v_cvt_pk_bf16_f32 v14, v15, v14
    ds_write_b32 v12, v14 offset:152
    v_cvt_pk_bf16_f32 v14, v186, v187
    v_lshlrev_b32 v15, 16, v14
    v_and_b32 v14, 0xffff0000, v14
    v_mul_f32 v15, v15, v198
    v_mul_f32 v14, v14, v198
    v_cvt_pk_bf16_f32 v14, v15, v14
    ds_write_b32 v12, v14 offset:156
    v_cvt_pk_bf16_f32 v14, v188, v189
    v_lshlrev_b32 v15, 16, v14
    v_and_b32 v14, 0xffff0000, v14
    v_mul_f32 v15, v15, v198
    v_mul_f32 v14, v14, v198
    v_cvt_pk_bf16_f32 v14, v15, v14
    ds_write_b32 v12, v14 offset:160
    v_cvt_pk_bf16_f32 v14, v190, v191
    v_lshlrev_b32 v15, 16, v14
    v_and_b32 v14, 0xffff0000, v14
    v_mul_f32 v15, v15, v198
    v_mul_f32 v14, v14, v198
    v_cvt_pk_bf16_f32 v14, v15, v14
    ds_write_b32 v12, v14 offset:164
    v_cvt_pk_bf16_f32 v14, v192, v193
    v_lshlrev_b32 v15, 16, v14
    v_and_b32 v14, 0xffff0000, v14
    v_mul_f32 v15, v15, v198
    v_mul_f32 v14, v14, v198
    v_cvt_pk_bf16_f32 v14, v15, v14
    ds_write_b32 v12, v14 offset:168
    v_cvt_pk_bf16_f32 v14, v194, v195
    v_lshlrev_b32 v15, 16, v14
    v_and_b32 v14, 0xffff0000, v14
    v_mul_f32 v15, v15, v198
    v_mul_f32 v14, v14, v198
    v_cvt_pk_bf16_f32 v14, v15, v14
    ds_write_b32 v12, v14 offset:172
    v_cvt_pk_bf16_f32 v14, v196, v197
    v_lshlrev_b32 v15, 16, v14
    v_and_b32 v14, 0xffff0000, v14
    v_mul_f32 v15, v15, v198
    v_mul_f32 v14, v14, v198
    v_cvt_pk_bf16_f32 v14, v15, v14
    ds_write_b32 v12, v14 offset:176
    s_waitcnt lgkmcnt(0)
    s_barrier
    v_mul_u32_u24 v8, 1168, v3
    v_lshl_add_u32 v8, v4, 4, v8
    ds_read_b128 v[150:153], v8 offset:51200
    ds_read_b128 v[154:157], v8 offset:51264
    ds_read_b128 v[158:161], v8 offset:51328
    ds_read_b128 v[162:165], v8 offset:51392
    ds_read_b128 v[166:169], v8 offset:51456
    ds_read_b128 v[170:173], v8 offset:51520
    ds_read_b128 v[174:177], v8 offset:51584
    ds_read_b128 v[178:181], v8 offset:51648
    ds_read_b128 v[182:185], v8 offset:51712
    ds_read_b128 v[186:189], v8 offset:51776
    ds_read_b128 v[190:193], v8 offset:51840
    ds_read_b128 v[194:197], v8 offset:51904
    ds_read_b128 v[198:201], v8 offset:51968
    ds_read_b128 v[202:205], v8 offset:52032
    ds_read_b128 v[206:209], v8 offset:52096
    ds_read_b128 v[210:213], v8 offset:52160
    ds_read_b128 v[214:217], v8 offset:52224
    ds_read_b128 v[218:221], v8 offset:52288
    s_waitcnt lgkmcnt(0)
    s_barrier
    s_mov_b32 s48, 73728
    s_add_u32 m0, s47, 0
    s_nop 0
    buffer_load_dwordx4 v230, s[12:15], s48 offen lds
    s_mov_b32 s48, 74752
    s_add_u32 m0, s47, 1024
    s_nop 0
    buffer_load_dwordx4 v230, s[12:15], s48 offen lds
    s_mov_b32 s48, 75776
    s_add_u32 m0, s47, 2048
    s_nop 0
    buffer_load_dwordx4 v230, s[12:15], s48 offen lds
    s_mov_b32 s48, 76800
    s_add_u32 m0, s47, 3072
    s_nop 0
    buffer_load_dwordx4 v230, s[12:15], s48 offen lds
    s_mov_b32 s48, 77824
    s_add_u32 m0, s47, 4096
    s_nop 0
    buffer_load_dwordx4 v230, s[12:15], s48 offen lds
    s_mov_b32 s48, 78848
    s_add_u32 m0, s47, 5120
    s_nop 0
    buffer_load_dwordx4 v230, s[12:15], s48 offen lds
    s_mov_b32 s48, 79872
    s_add_u32 m0, s47, 6144
    s_nop 0
    buffer_load_dwordx4 v230, s[12:15], s48 offen lds
    s_mov_b32 s48, 80896
    s_add_u32 m0, s47, 7168
    s_nop 0
    buffer_load_dwordx4 v230, s[12:15], s48 offen lds
    s_mov_b32 s48, 81920
    s_add_u32 m0, s47, 8192
    s_nop 0
    buffer_load_dwordx4 v230, s[12:15], s48 offen lds
    s_mov_b32 s48, 110592
    s_add_u32 m0, s47, 36864
    s_nop 0
    buffer_load_dwordx4 v230, s[12:15], s48 offen lds
    s_mov_b32 s48, 111616
    s_add_u32 m0, s47, 37888
    s_nop 0
    buffer_load_dwordx4 v230, s[12:15], s48 offen lds
    s_mov_b32 s48, 112640
    s_add_u32 m0, s47, 38912
    s_nop 0
    buffer_load_dwordx4 v230, s[12:15], s48 offen lds
    s_mov_b32 s48, 113664
    s_add_u32 m0, s47, 39936
    s_nop 0
    buffer_load_dwordx4 v230, s[12:15], s48 offen lds
    s_mov_b32 s48, 114688
    s_add_u32 m0, s47, 40960
    s_nop 0
    buffer_load_dwordx4 v230, s[12:15], s48 offen lds
    s_mov_b32 s48, 115712
    s_add_u32 m0, s47, 41984
    s_nop 0
    buffer_load_dwordx4 v230, s[12:15], s48 offen lds
    s_mov_b32 s48, 116736
    s_add_u32 m0, s47, 43008
    s_nop 0
    buffer_load_dwordx4 v230, s[12:15], s48 offen lds
    s_mov_b32 s48, 117760
    s_add_u32 m0, s47, 44032
    s_nop 0
    buffer_load_dwordx4 v230, s[12:15], s48 offen lds
    s_mov_b32 s48, 118784
    s_add_u32 m0, s47, 45056
    s_nop 0
    buffer_load_dwordx4 v230, s[12:15], s48 offen lds
    v_add_u32 v5, s40, v3
    v_mul_u32_u24 v5, 1152, v5
    s_mul_i32 s48, s3, 288
    v_lshl_add_u32 v5, v4, 3, v5
    v_add_u32 v5, s48, v5
    buffer_load_dwordx2 v[60:61], v5, s[16:19], 0 offen offset:0
    buffer_load_dwordx2 v[62:63], v5, s[16:19], 0 offen offset:32
    buffer_load_dwordx2 v[64:65], v5, s[16:19], 0 offen offset:64
    buffer_load_dwordx2 v[66:67], v5, s[16:19], 0 offen offset:96
    buffer_load_dwordx2 v[68:69], v5, s[16:19], 0 offen offset:128
    buffer_load_dwordx2 v[70:71], v5, s[16:19], 0 offen offset:160
    buffer_load_dwordx2 v[72:73], v5, s[16:19], 0 offen offset:192
    buffer_load_dwordx2 v[74:75], v5, s[16:19], 0 offen offset:224
    buffer_load_dwordx2 v[76:77], v5, s[16:19], 0 offen offset:256
    s_mul_i32 s48, s3, 576
    v_lshlrev_b32 v6, 4, v4
    v_add_u32 v6, s48, v6
    v_add_u32 v6, 73728, v6
    v_lshlrev_b32 v11, 3, v1
    v_add_u32 v11, s47, v11
    v_add_u32 v224, 90112, v11
    v_add_u32 v225, 126976, v11
    v_add_u32 v226, 0, v11
    v_add_u32 v227, 36864, v11
    s_barrier
    ds_read_b64_tr_b16 v[8:9], v224 offset:0
    ds_read_b64_tr_b16 v[10:11], v224 offset:512
    ds_read_b64_tr_b16 v[12:13], v224 offset:1024
    ds_read_b64_tr_b16 v[14:15], v224 offset:1536
    ds_read_b64_tr_b16 v[16:17], v224 offset:2048
    ds_read_b64_tr_b16 v[18:19], v224 offset:2560
    ds_read_b64_tr_b16 v[20:21], v224 offset:3072
    ds_read_b64_tr_b16 v[22:23], v224 offset:3584
    s_waitcnt lgkmcnt(6)
    v_mfma_f32_16x16x32_bf16 v[24:27], v[8:11], v[150:153], 0
    ds_read_b64_tr_b16 v[8:9], v224 offset:4096
    ds_read_b64_tr_b16 v[10:11], v224 offset:4608
    s_waitcnt lgkmcnt(6)
    v_mfma_f32_16x16x32_bf16 v[28:31], v[12:15], v[150:153], 0
    ds_read_b64_tr_b16 v[12:13], v224 offset:5120
    ds_read_b64_tr_b16 v[14:15], v224 offset:5632
    s_waitcnt lgkmcnt(6)
    v_mfma_f32_16x16x32_bf16 v[32:35], v[16:19], v[150:153], 0
    ds_read_b64_tr_b16 v[16:17], v224 offset:6144
    ds_read_b64_tr_b16 v[18:19], v224 offset:6656
    s_waitcnt lgkmcnt(6)
    v_mfma_f32_16x16x32_bf16 v[36:39], v[20:23], v[150:153], 0
    ds_read_b64_tr_b16 v[20:21], v224 offset:7168
    ds_read_b64_tr_b16 v[22:23], v224 offset:7680
    s_waitcnt lgkmcnt(6)
    v_mfma_f32_16x16x32_bf16 v[40:43], v[8:11], v[150:153], 0
    ds_read_b64_tr_b16 v[8:9], v224 offset:8192
    ds_read_b64_tr_b16 v[10:11], v224 offset:8704
    s_waitcnt lgkmcnt(6)
    v_mfma_f32_16x16x32_bf16 v[44:47], v[12:15], v[150:153], 0
    s_waitcnt lgkmcnt(4)
    v_mfma_f32_16x16x32_bf16 v[48:51], v[16:19], v[150:153], 0
    s_waitcnt lgkmcnt(2)
    v_mfma_f32_16x16x32_bf16 v[52:55], v[20:23], v[150:153], 0
    s_waitcnt lgkmcnt(0)
    v_mfma_f32_16x16x32_bf16 v[56:59], v[8:11], v[150:153], 0
    s_waitcnt vmcnt(27)
    s_barrier
    s_mov_b32 s48, 147456
    s_add_u32 m0, s47, 90112
    s_nop 0
    buffer_load_dwordx4 v230, s[12:15], s48 offen lds
    s_mov_b32 s48, 148480
    s_add_u32 m0, s47, 91136
    s_nop 0
    buffer_load_dwordx4 v230, s[12:15], s48 offen lds
    s_mov_b32 s48, 149504
    s_add_u32 m0, s47, 92160
    s_nop 0
    buffer_load_dwordx4 v230, s[12:15], s48 offen lds
    s_mov_b32 s48, 150528
    s_add_u32 m0, s47, 93184
    s_nop 0
    buffer_load_dwordx4 v230, s[12:15], s48 offen lds
    s_mov_b32 s48, 151552
    s_add_u32 m0, s47, 94208
    s_nop 0
    buffer_load_dwordx4 v230, s[12:15], s48 offen lds
    s_mov_b32 s48, 152576
    s_add_u32 m0, s47, 95232
    s_nop 0
    buffer_load_dwordx4 v230, s[12:15], s48 offen lds
    s_mov_b32 s48, 153600
    s_add_u32 m0, s47, 96256
    s_nop 0
    buffer_load_dwordx4 v230, s[12:15], s48 offen lds
    s_mov_b32 s48, 154624
    s_add_u32 m0, s47, 97280
    s_nop 0
    buffer_load_dwordx4 v230, s[12:15], s48 offen lds
    s_mov_b32 s48, 155648
    s_add_u32 m0, s47, 98304
    s_nop 0
    buffer_load_dwordx4 v230, s[12:15], s48 offen lds
    ds_read_b64_tr_b16 v[12:13], v225 offset:0
    ds_read_b64_tr_b16 v[14:15], v225 offset:512
    ds_read_b64_tr_b16 v[16:17], v225 offset:1024
    ds_read_b64_tr_b16 v[18:19], v225 offset:1536
    ds_read_b64_tr_b16 v[20:21], v225 offset:2048
    ds_read_b64_tr_b16 v[22:23], v225 offset:2560
    ds_read_b64_tr_b16 v[8:9], v225 offset:3072
    ds_read_b64_tr_b16 v[10:11], v225 offset:3584
    s_waitcnt lgkmcnt(6)
    v_mfma_f32_16x16x32_bf16 v[24:27], v[12:15], v[154:157], v[24:27]
    ds_read_b64_tr_b16 v[12:13], v225 offset:4096
    ds_read_b64_tr_b16 v[14:15], v225 offset:4608
    s_waitcnt lgkmcnt(6)
    v_mfma_f32_16x16x32_bf16 v[28:31], v[16:19], v[154:157], v[28:31]
    ds_read_b64_tr_b16 v[16:17], v225 offset:5120
    ds_read_b64_tr_b16 v[18:19], v225 offset:5632
    s_waitcnt lgkmcnt(6)
    v_mfma_f32_16x16x32_bf16 v[32:35], v[20:23], v[154:157], v[32:35]
    ds_read_b64_tr_b16 v[20:21], v225 offset:6144
    ds_read_b64_tr_b16 v[22:23], v225 offset:6656
    s_waitcnt lgkmcnt(6)
    v_mfma_f32_16x16x32_bf16 v[36:39], v[8:11], v[154:157], v[36:39]
    ds_read_b64_tr_b16 v[8:9], v225 offset:7168
    ds_read_b64_tr_b16 v[10:11], v225 offset:7680
    s_waitcnt lgkmcnt(6)
    v_mfma_f32_16x16x32_bf16 v[40:43], v[12:15], v[154:157], v[40:43]
    ds_read_b64_tr_b16 v[12:13], v225 offset:8192
    ds_read_b64_tr_b16 v[14:15], v225 offset:8704
    s_waitcnt lgkmcnt(6)
    v_mfma_f32_16x16x32_bf16 v[44:47], v[16:19], v[154:157], v[44:47]
    s_waitcnt lgkmcnt(4)
    v_mfma_f32_16x16x32_bf16 v[48:51], v[20:23], v[154:157], v[48:51]
    s_waitcnt lgkmcnt(2)
    v_mfma_f32_16x16x32_bf16 v[52:55], v[8:11], v[154:157], v[52:55]
    s_waitcnt lgkmcnt(0)
    v_mfma_f32_16x16x32_bf16 v[56:59], v[12:15], v[154:157], v[56:59]
    s_waitcnt vmcnt(27)
    s_barrier
    s_mov_b32 s48, 184320
    s_add_u32 m0, s47, 126976
    s_nop 0
    buffer_load_dwordx4 v230, s[12:15], s48 offen lds
    s_mov_b32 s48, 185344
    s_add_u32 m0, s47, 128000
    s_nop 0
    buffer_load_dwordx4 v230, s[12:15], s48 offen lds
    s_mov_b32 s48, 186368
    s_add_u32 m0, s47, 129024
    s_nop 0
    buffer_load_dwordx4 v230, s[12:15], s48 offen lds
    s_mov_b32 s48, 187392
    s_add_u32 m0, s47, 130048
    s_nop 0
    buffer_load_dwordx4 v230, s[12:15], s48 offen lds
    s_mov_b32 s48, 188416
    s_add_u32 m0, s47, 131072
    s_nop 0
    buffer_load_dwordx4 v230, s[12:15], s48 offen lds
    s_mov_b32 s48, 189440
    s_add_u32 m0, s47, 132096
    s_nop 0
    buffer_load_dwordx4 v230, s[12:15], s48 offen lds
    s_mov_b32 s48, 190464
    s_add_u32 m0, s47, 133120
    s_nop 0
    buffer_load_dwordx4 v230, s[12:15], s48 offen lds
    s_mov_b32 s48, 191488
    s_add_u32 m0, s47, 134144
    s_nop 0
    buffer_load_dwordx4 v230, s[12:15], s48 offen lds
    s_mov_b32 s48, 192512
    s_add_u32 m0, s47, 135168
    s_nop 0
    buffer_load_dwordx4 v230, s[12:15], s48 offen lds
    ds_read_b64_tr_b16 v[16:17], v226 offset:0
    ds_read_b64_tr_b16 v[18:19], v226 offset:512
    ds_read_b64_tr_b16 v[20:21], v226 offset:1024
    ds_read_b64_tr_b16 v[22:23], v226 offset:1536
    ds_read_b64_tr_b16 v[8:9], v226 offset:2048
    ds_read_b64_tr_b16 v[10:11], v226 offset:2560
    ds_read_b64_tr_b16 v[12:13], v226 offset:3072
    ds_read_b64_tr_b16 v[14:15], v226 offset:3584
    s_waitcnt lgkmcnt(6)
    v_mfma_f32_16x16x32_bf16 v[24:27], v[16:19], v[158:161], v[24:27]
    ds_read_b64_tr_b16 v[16:17], v226 offset:4096
    ds_read_b64_tr_b16 v[18:19], v226 offset:4608
    s_waitcnt lgkmcnt(6)
    v_mfma_f32_16x16x32_bf16 v[28:31], v[20:23], v[158:161], v[28:31]
    ds_read_b64_tr_b16 v[20:21], v226 offset:5120
    ds_read_b64_tr_b16 v[22:23], v226 offset:5632
    s_waitcnt lgkmcnt(6)
    v_mfma_f32_16x16x32_bf16 v[32:35], v[8:11], v[158:161], v[32:35]
    ds_read_b64_tr_b16 v[8:9], v226 offset:6144
    ds_read_b64_tr_b16 v[10:11], v226 offset:6656
    s_waitcnt lgkmcnt(6)
    v_mfma_f32_16x16x32_bf16 v[36:39], v[12:15], v[158:161], v[36:39]
    ds_read_b64_tr_b16 v[12:13], v226 offset:7168
    ds_read_b64_tr_b16 v[14:15], v226 offset:7680
    s_waitcnt lgkmcnt(6)
    v_mfma_f32_16x16x32_bf16 v[40:43], v[16:19], v[158:161], v[40:43]
    ds_read_b64_tr_b16 v[16:17], v226 offset:8192
    ds_read_b64_tr_b16 v[18:19], v226 offset:8704
    s_waitcnt lgkmcnt(6)
    v_mfma_f32_16x16x32_bf16 v[44:47], v[20:23], v[158:161], v[44:47]
    s_waitcnt lgkmcnt(4)
    v_mfma_f32_16x16x32_bf16 v[48:51], v[8:11], v[158:161], v[48:51]
    s_waitcnt lgkmcnt(2)
    v_mfma_f32_16x16x32_bf16 v[52:55], v[12:15], v[158:161], v[52:55]
    s_waitcnt lgkmcnt(0)
    v_mfma_f32_16x16x32_bf16 v[56:59], v[16:19], v[158:161], v[56:59]
    s_waitcnt vmcnt(27)
    s_barrier
    s_mov_b32 s48, 221184
    s_add_u32 m0, s47, 0
    s_nop 0
    buffer_load_dwordx4 v230, s[12:15], s48 offen lds
    s_mov_b32 s48, 222208
    s_add_u32 m0, s47, 1024
    s_nop 0
    buffer_load_dwordx4 v230, s[12:15], s48 offen lds
    s_mov_b32 s48, 223232
    s_add_u32 m0, s47, 2048
    s_nop 0
    buffer_load_dwordx4 v230, s[12:15], s48 offen lds
    s_mov_b32 s48, 224256
    s_add_u32 m0, s47, 3072
    s_nop 0
    buffer_load_dwordx4 v230, s[12:15], s48 offen lds
    s_mov_b32 s48, 225280
    s_add_u32 m0, s47, 4096
    s_nop 0
    buffer_load_dwordx4 v230, s[12:15], s48 offen lds
    s_mov_b32 s48, 226304
    s_add_u32 m0, s47, 5120
    s_nop 0
    buffer_load_dwordx4 v230, s[12:15], s48 offen lds
    s_mov_b32 s48, 227328
    s_add_u32 m0, s47, 6144
    s_nop 0
    buffer_load_dwordx4 v230, s[12:15], s48 offen lds
    s_mov_b32 s48, 228352
    s_add_u32 m0, s47, 7168
    s_nop 0
    buffer_load_dwordx4 v230, s[12:15], s48 offen lds
    s_mov_b32 s48, 229376
    s_add_u32 m0, s47, 8192
    s_nop 0
    buffer_load_dwordx4 v230, s[12:15], s48 offen lds
    ds_read_b64_tr_b16 v[20:21], v227 offset:0
    ds_read_b64_tr_b16 v[22:23], v227 offset:512
    ds_read_b64_tr_b16 v[8:9], v227 offset:1024
    ds_read_b64_tr_b16 v[10:11], v227 offset:1536
    ds_read_b64_tr_b16 v[12:13], v227 offset:2048
    ds_read_b64_tr_b16 v[14:15], v227 offset:2560
    ds_read_b64_tr_b16 v[16:17], v227 offset:3072
    ds_read_b64_tr_b16 v[18:19], v227 offset:3584
    s_waitcnt lgkmcnt(6)
    v_mfma_f32_16x16x32_bf16 v[24:27], v[20:23], v[162:165], v[24:27]
    ds_read_b64_tr_b16 v[20:21], v227 offset:4096
    ds_read_b64_tr_b16 v[22:23], v227 offset:4608
    s_waitcnt lgkmcnt(6)
    v_mfma_f32_16x16x32_bf16 v[28:31], v[8:11], v[162:165], v[28:31]
    ds_read_b64_tr_b16 v[8:9], v227 offset:5120
    ds_read_b64_tr_b16 v[10:11], v227 offset:5632
    s_waitcnt lgkmcnt(6)
    v_mfma_f32_16x16x32_bf16 v[32:35], v[12:15], v[162:165], v[32:35]
    ds_read_b64_tr_b16 v[12:13], v227 offset:6144
    ds_read_b64_tr_b16 v[14:15], v227 offset:6656
    s_waitcnt lgkmcnt(6)
    v_mfma_f32_16x16x32_bf16 v[36:39], v[16:19], v[162:165], v[36:39]
    ds_read_b64_tr_b16 v[16:17], v227 offset:7168
    ds_read_b64_tr_b16 v[18:19], v227 offset:7680
    s_waitcnt lgkmcnt(6)
    v_mfma_f32_16x16x32_bf16 v[40:43], v[20:23], v[162:165], v[40:43]
    ds_read_b64_tr_b16 v[20:21], v227 offset:8192
    ds_read_b64_tr_b16 v[22:23], v227 offset:8704
    s_waitcnt lgkmcnt(6)
    v_mfma_f32_16x16x32_bf16 v[44:47], v[8:11], v[162:165], v[44:47]
    s_waitcnt lgkmcnt(4)
    v_mfma_f32_16x16x32_bf16 v[48:51], v[12:15], v[162:165], v[48:51]
    s_waitcnt lgkmcnt(2)
    v_mfma_f32_16x16x32_bf16 v[52:55], v[16:19], v[162:165], v[52:55]
    s_waitcnt lgkmcnt(0)
    v_mfma_f32_16x16x32_bf16 v[56:59], v[20:23], v[162:165], v[56:59]
    s_waitcnt vmcnt(18)
    s_barrier
    s_mov_b32 s48, 258048
    s_add_u32 m0, s47, 36864
    s_nop 0
    buffer_load_dwordx4 v230, s[12:15], s48 offen lds
    s_mov_b32 s48, 259072
    s_add_u32 m0, s47, 37888
    s_nop 0
    buffer_load_dwordx4 v230, s[12:15], s48 offen lds
    s_mov_b32 s48, 260096
    s_add_u32 m0, s47, 38912
    s_nop 0
    buffer_load_dwordx4 v230, s[12:15], s48 offen lds
    s_mov_b32 s48, 261120
    s_add_u32 m0, s47, 39936
    s_nop 0
    buffer_load_dwordx4 v230, s[12:15], s48 offen lds
    s_mov_b32 s48, 262144
    s_add_u32 m0, s47, 40960
    s_nop 0
    buffer_load_dwordx4 v230, s[12:15], s48 offen lds
    s_mov_b32 s48, 263168
    s_add_u32 m0, s47, 41984
    s_nop 0
    buffer_load_dwordx4 v230, s[12:15], s48 offen lds
    s_mov_b32 s48, 264192
    s_add_u32 m0, s47, 43008
    s_nop 0
    buffer_load_dwordx4 v230, s[12:15], s48 offen lds
    s_mov_b32 s48, 265216
    s_add_u32 m0, s47, 44032
    s_nop 0
    buffer_load_dwordx4 v230, s[12:15], s48 offen lds
    s_mov_b32 s48, 266240
    s_add_u32 m0, s47, 45056
    s_nop 0
    buffer_load_dwordx4 v230, s[12:15], s48 offen lds
    ds_read_b64_tr_b16 v[8:9], v224 offset:0
    ds_read_b64_tr_b16 v[10:11], v224 offset:512
    ds_read_b64_tr_b16 v[12:13], v224 offset:1024
    ds_read_b64_tr_b16 v[14:15], v224 offset:1536
    ds_read_b64_tr_b16 v[16:17], v224 offset:2048
    ds_read_b64_tr_b16 v[18:19], v224 offset:2560
    ds_read_b64_tr_b16 v[20:21], v224 offset:3072
    ds_read_b64_tr_b16 v[22:23], v224 offset:3584
    s_waitcnt lgkmcnt(6)
    v_mfma_f32_16x16x32_bf16 v[24:27], v[8:11], v[166:169], v[24:27]
    ds_read_b64_tr_b16 v[8:9], v224 offset:4096
    ds_read_b64_tr_b16 v[10:11], v224 offset:4608
    s_waitcnt lgkmcnt(6)
    v_mfma_f32_16x16x32_bf16 v[28:31], v[12:15], v[166:169], v[28:31]
    ds_read_b64_tr_b16 v[12:13], v224 offset:5120
    ds_read_b64_tr_b16 v[14:15], v224 offset:5632
    s_waitcnt lgkmcnt(6)
    v_mfma_f32_16x16x32_bf16 v[32:35], v[16:19], v[166:169], v[32:35]
    ds_read_b64_tr_b16 v[16:17], v224 offset:6144
    ds_read_b64_tr_b16 v[18:19], v224 offset:6656
    s_waitcnt lgkmcnt(6)
    v_mfma_f32_16x16x32_bf16 v[36:39], v[20:23], v[166:169], v[36:39]
    ds_read_b64_tr_b16 v[20:21], v224 offset:7168
    ds_read_b64_tr_b16 v[22:23], v224 offset:7680
    s_waitcnt lgkmcnt(6)
    v_mfma_f32_16x16x32_bf16 v[40:43], v[8:11], v[166:169], v[40:43]
    ds_read_b64_tr_b16 v[8:9], v224 offset:8192
    ds_read_b64_tr_b16 v[10:11], v224 offset:8704
    s_waitcnt lgkmcnt(6)
    v_mfma_f32_16x16x32_bf16 v[44:47], v[12:15], v[166:169], v[44:47]
    s_waitcnt lgkmcnt(4)
    v_mfma_f32_16x16x32_bf16 v[48:51], v[16:19], v[166:169], v[48:51]
    s_waitcnt lgkmcnt(2)
    v_mfma_f32_16x16x32_bf16 v[52:55], v[20:23], v[166:169], v[52:55]
    s_waitcnt lgkmcnt(0)
    v_mfma_f32_16x16x32_bf16 v[56:59], v[8:11], v[166:169], v[56:59]
    s_waitcnt vmcnt(18)
    s_barrier
    s_mov_b32 s48, 294912
    s_add_u32 m0, s47, 90112
    s_nop 0
    buffer_load_dwordx4 v230, s[12:15], s48 offen lds
    s_mov_b32 s48, 295936
    s_add_u32 m0, s47, 91136
    s_nop 0
    buffer_load_dwordx4 v230, s[12:15], s48 offen lds
    s_mov_b32 s48, 296960
    s_add_u32 m0, s47, 92160
    s_nop 0
    buffer_load_dwordx4 v230, s[12:15], s48 offen lds
    s_mov_b32 s48, 297984
    s_add_u32 m0, s47, 93184
    s_nop 0
    buffer_load_dwordx4 v230, s[12:15], s48 offen lds
    s_mov_b32 s48, 299008
    s_add_u32 m0, s47, 94208
    s_nop 0
    buffer_load_dwordx4 v230, s[12:15], s48 offen lds
    s_mov_b32 s48, 300032
    s_add_u32 m0, s47, 95232
    s_nop 0
    buffer_load_dwordx4 v230, s[12:15], s48 offen lds
    s_mov_b32 s48, 301056
    s_add_u32 m0, s47, 96256
    s_nop 0
    buffer_load_dwordx4 v230, s[12:15], s48 offen lds
    s_mov_b32 s48, 302080
    s_add_u32 m0, s47, 97280
    s_nop 0
    buffer_load_dwordx4 v230, s[12:15], s48 offen lds
    s_mov_b32 s48, 303104
    s_add_u32 m0, s47, 98304
    s_nop 0
    buffer_load_dwordx4 v230, s[12:15], s48 offen lds
    ds_read_b64_tr_b16 v[12:13], v225 offset:0
    ds_read_b64_tr_b16 v[14:15], v225 offset:512
    ds_read_b64_tr_b16 v[16:17], v225 offset:1024
    ds_read_b64_tr_b16 v[18:19], v225 offset:1536
    ds_read_b64_tr_b16 v[20:21], v225 offset:2048
    ds_read_b64_tr_b16 v[22:23], v225 offset:2560
    ds_read_b64_tr_b16 v[8:9], v225 offset:3072
    ds_read_b64_tr_b16 v[10:11], v225 offset:3584
    s_waitcnt lgkmcnt(6)
    v_mfma_f32_16x16x32_bf16 v[24:27], v[12:15], v[170:173], v[24:27]
    ds_read_b64_tr_b16 v[12:13], v225 offset:4096
    ds_read_b64_tr_b16 v[14:15], v225 offset:4608
    s_waitcnt lgkmcnt(6)
    v_mfma_f32_16x16x32_bf16 v[28:31], v[16:19], v[170:173], v[28:31]
    ds_read_b64_tr_b16 v[16:17], v225 offset:5120
    ds_read_b64_tr_b16 v[18:19], v225 offset:5632
    s_waitcnt lgkmcnt(6)
    v_mfma_f32_16x16x32_bf16 v[32:35], v[20:23], v[170:173], v[32:35]
    ds_read_b64_tr_b16 v[20:21], v225 offset:6144
    ds_read_b64_tr_b16 v[22:23], v225 offset:6656
    s_waitcnt lgkmcnt(6)
    v_mfma_f32_16x16x32_bf16 v[36:39], v[8:11], v[170:173], v[36:39]
    ds_read_b64_tr_b16 v[8:9], v225 offset:7168
    ds_read_b64_tr_b16 v[10:11], v225 offset:7680
    s_waitcnt lgkmcnt(6)
    v_mfma_f32_16x16x32_bf16 v[40:43], v[12:15], v[170:173], v[40:43]
    ds_read_b64_tr_b16 v[12:13], v225 offset:8192
    ds_read_b64_tr_b16 v[14:15], v225 offset:8704
    s_waitcnt lgkmcnt(6)
    v_mfma_f32_16x16x32_bf16 v[44:47], v[16:19], v[170:173], v[44:47]
    s_waitcnt lgkmcnt(4)
    v_mfma_f32_16x16x32_bf16 v[48:51], v[20:23], v[170:173], v[48:51]
    s_waitcnt lgkmcnt(2)
    v_mfma_f32_16x16x32_bf16 v[52:55], v[8:11], v[170:173], v[52:55]
    s_waitcnt lgkmcnt(0)
    v_mfma_f32_16x16x32_bf16 v[56:59], v[12:15], v[170:173], v[56:59]
    s_waitcnt vmcnt(18)
    s_barrier
    s_mov_b32 s48, 331776
    s_add_u32 m0, s47, 126976
    s_nop 0
    buffer_load_dwordx4 v230, s[12:15], s48 offen lds
    s_mov_b32 s48, 332800
    s_add_u32 m0, s47, 128000
    s_nop 0
    buffer_load_dwordx4 v230, s[12:15], s48 offen lds
    s_mov_b32 s48, 333824
    s_add_u32 m0, s47, 129024
    s_nop 0
    buffer_load_dwordx4 v230, s[12:15], s48 offen lds
    s_mov_b32 s48, 334848
    s_add_u32 m0, s47, 130048
    s_nop 0
    buffer_load_dwordx4 v230, s[12:15], s48 offen lds
    s_mov_b32 s48, 335872
    s_add_u32 m0, s47, 131072
    s_nop 0
    buffer_load_dwordx4 v230, s[12:15], s48 offen lds
    s_mov_b32 s48, 336896
    s_add_u32 m0, s47, 132096
    s_nop 0
    buffer_load_dwordx4 v230, s[12:15], s48 offen lds
    s_mov_b32 s48, 337920
    s_add_u32 m0, s47, 133120
    s_nop 0
    buffer_load_dwordx4 v230, s[12:15], s48 offen lds
    s_mov_b32 s48, 338944
    s_add_u32 m0, s47, 134144
    s_nop 0
    buffer_load_dwordx4 v230, s[12:15], s48 offen lds
    s_mov_b32 s48, 339968
    s_add_u32 m0, s47, 135168
    s_nop 0
    buffer_load_dwordx4 v230, s[12:15], s48 offen lds
    ds_read_b64_tr_b16 v[16:17], v226 offset:0
    ds_read_b64_tr_b16 v[18:19], v226 offset:512
    ds_read_b64_tr_b16 v[20:21], v226 offset:1024
    ds_read_b64_tr_b16 v[22:23], v226 offset:1536
    ds_read_b64_tr_b16 v[8:9], v226 offset:2048
    ds_read_b64_tr_b16 v[10:11], v226 offset:2560
    ds_read_b64_tr_b16 v[12:13], v226 offset:3072
    ds_read_b64_tr_b16 v[14:15], v226 offset:3584
    s_waitcnt lgkmcnt(6)
    v_mfma_f32_16x16x32_bf16 v[24:27], v[16:19], v[174:177], v[24:27]
    ds_read_b64_tr_b16 v[16:17], v226 offset:4096
    ds_read_b64_tr_b16 v[18:19], v226 offset:4608
    s_waitcnt lgkmcnt(6)
    v_mfma_f32_16x16x32_bf16 v[28:31], v[20:23], v[174:177], v[28:31]
    ds_read_b64_tr_b16 v[20:21], v226 offset:5120
    ds_read_b64_tr_b16 v[22:23], v226 offset:5632
    s_waitcnt lgkmcnt(6)
    v_mfma_f32_16x16x32_bf16 v[32:35], v[8:11], v[174:177], v[32:35]
    ds_read_b64_tr_b16 v[8:9], v226 offset:6144
    ds_read_b64_tr_b16 v[10:11], v226 offset:6656
    s_waitcnt lgkmcnt(6)
    v_mfma_f32_16x16x32_bf16 v[36:39], v[12:15], v[174:177], v[36:39]
    ds_read_b64_tr_b16 v[12:13], v226 offset:7168
    ds_read_b64_tr_b16 v[14:15], v226 offset:7680
    s_waitcnt lgkmcnt(6)
    v_mfma_f32_16x16x32_bf16 v[40:43], v[16:19], v[174:177], v[40:43]
    ds_read_b64_tr_b16 v[16:17], v226 offset:8192
    ds_read_b64_tr_b16 v[18:19], v226 offset:8704
    s_waitcnt lgkmcnt(6)
    v_mfma_f32_16x16x32_bf16 v[44:47], v[20:23], v[174:177], v[44:47]
    s_waitcnt lgkmcnt(4)
    v_mfma_f32_16x16x32_bf16 v[48:51], v[8:11], v[174:177], v[48:51]
    s_waitcnt lgkmcnt(2)
    v_mfma_f32_16x16x32_bf16 v[52:55], v[12:15], v[174:177], v[52:55]
    s_waitcnt lgkmcnt(0)
    v_mfma_f32_16x16x32_bf16 v[56:59], v[16:19], v[174:177], v[56:59]
    s_waitcnt vmcnt(18)
    s_barrier
    s_mov_b32 s48, 368640
    s_add_u32 m0, s47, 0
    s_nop 0
    buffer_load_dwordx4 v230, s[12:15], s48 offen lds
    s_mov_b32 s48, 369664
    s_add_u32 m0, s47, 1024
    s_nop 0
    buffer_load_dwordx4 v230, s[12:15], s48 offen lds
    s_mov_b32 s48, 370688
    s_add_u32 m0, s47, 2048
    s_nop 0
    buffer_load_dwordx4 v230, s[12:15], s48 offen lds
    s_mov_b32 s48, 371712
    s_add_u32 m0, s47, 3072
    s_nop 0
    buffer_load_dwordx4 v230, s[12:15], s48 offen lds
    s_mov_b32 s48, 372736
    s_add_u32 m0, s47, 4096
    s_nop 0
    buffer_load_dwordx4 v230, s[12:15], s48 offen lds
    s_mov_b32 s48, 373760
    s_add_u32 m0, s47, 5120
    s_nop 0
    buffer_load_dwordx4 v230, s[12:15], s48 offen lds
    s_mov_b32 s48, 374784
    s_add_u32 m0, s47, 6144
    s_nop 0
    buffer_load_dwordx4 v230, s[12:15], s48 offen lds
    s_mov_b32 s48, 375808
    s_add_u32 m0, s47, 7168
    s_nop 0
    buffer_load_dwordx4 v230, s[12:15], s48 offen lds
    s_mov_b32 s48, 376832
    s_add_u32 m0, s47, 8192
    s_nop 0
    buffer_load_dwordx4 v230, s[12:15], s48 offen lds
    ds_read_b64_tr_b16 v[20:21], v227 offset:0
    ds_read_b64_tr_b16 v[22:23], v227 offset:512
    ds_read_b64_tr_b16 v[8:9], v227 offset:1024
    ds_read_b64_tr_b16 v[10:11], v227 offset:1536
    ds_read_b64_tr_b16 v[12:13], v227 offset:2048
    ds_read_b64_tr_b16 v[14:15], v227 offset:2560
    ds_read_b64_tr_b16 v[16:17], v227 offset:3072
    ds_read_b64_tr_b16 v[18:19], v227 offset:3584
    s_waitcnt lgkmcnt(6)
    v_mfma_f32_16x16x32_bf16 v[24:27], v[20:23], v[178:181], v[24:27]
    ds_read_b64_tr_b16 v[20:21], v227 offset:4096
    ds_read_b64_tr_b16 v[22:23], v227 offset:4608
    s_waitcnt lgkmcnt(6)
    v_mfma_f32_16x16x32_bf16 v[28:31], v[8:11], v[178:181], v[28:31]
    ds_read_b64_tr_b16 v[8:9], v227 offset:5120
    ds_read_b64_tr_b16 v[10:11], v227 offset:5632
    s_waitcnt lgkmcnt(6)
    v_mfma_f32_16x16x32_bf16 v[32:35], v[12:15], v[178:181], v[32:35]
    ds_read_b64_tr_b16 v[12:13], v227 offset:6144
    ds_read_b64_tr_b16 v[14:15], v227 offset:6656
    s_waitcnt lgkmcnt(6)
    v_mfma_f32_16x16x32_bf16 v[36:39], v[16:19], v[178:181], v[36:39]
    ds_read_b64_tr_b16 v[16:17], v227 offset:7168
    ds_read_b64_tr_b16 v[18:19], v227 offset:7680
    s_waitcnt lgkmcnt(6)
    v_mfma_f32_16x16x32_bf16 v[40:43], v[20:23], v[178:181], v[40:43]
    ds_read_b64_tr_b16 v[20:21], v227 offset:8192
    ds_read_b64_tr_b16 v[22:23], v227 offset:8704
    s_waitcnt lgkmcnt(6)
    v_mfma_f32_16x16x32_bf16 v[44:47], v[8:11], v[178:181], v[44:47]
    s_waitcnt lgkmcnt(4)
    v_mfma_f32_16x16x32_bf16 v[48:51], v[12:15], v[178:181], v[48:51]
    s_waitcnt lgkmcnt(2)
    v_mfma_f32_16x16x32_bf16 v[52:55], v[16:19], v[178:181], v[52:55]
    s_waitcnt lgkmcnt(0)
    v_mfma_f32_16x16x32_bf16 v[56:59], v[20:23], v[178:181], v[56:59]
    s_waitcnt vmcnt(18)
    s_barrier
    s_mov_b32 s48, 405504
    s_add_u32 m0, s47, 36864
    s_nop 0
    buffer_load_dwordx4 v230, s[12:15], s48 offen lds
    s_mov_b32 s48, 406528
    s_add_u32 m0, s47, 37888
    s_nop 0
    buffer_load_dwordx4 v230, s[12:15], s48 offen lds
    s_mov_b32 s48, 407552
    s_add_u32 m0, s47, 38912
    s_nop 0
    buffer_load_dwordx4 v230, s[12:15], s48 offen lds
    s_mov_b32 s48, 408576
    s_add_u32 m0, s47, 39936
    s_nop 0
    buffer_load_dwordx4 v230, s[12:15], s48 offen lds
    s_mov_b32 s48, 409600
    s_add_u32 m0, s47, 40960
    s_nop 0
    buffer_load_dwordx4 v230, s[12:15], s48 offen lds
    s_mov_b32 s48, 410624
    s_add_u32 m0, s47, 41984
    s_nop 0
    buffer_load_dwordx4 v230, s[12:15], s48 offen lds
    s_mov_b32 s48, 411648
    s_add_u32 m0, s47, 43008
    s_nop 0
    buffer_load_dwordx4 v230, s[12:15], s48 offen lds
    s_mov_b32 s48, 412672
    s_add_u32 m0, s47, 44032
    s_nop 0
    buffer_load_dwordx4 v230, s[12:15], s48 offen lds
    s_mov_b32 s48, 413696
    s_add_u32 m0, s47, 45056
    s_nop 0
    buffer_load_dwordx4 v230, s[12:15], s48 offen lds
    ds_read_b64_tr_b16 v[8:9], v224 offset:0
    ds_read_b64_tr_b16 v[10:11], v224 offset:512
    ds_read_b64_tr_b16 v[12:13], v224 offset:1024
    ds_read_b64_tr_b16 v[14:15], v224 offset:1536
    ds_read_b64_tr_b16 v[16:17], v224 offset:2048
    ds_read_b64_tr_b16 v[18:19], v224 offset:2560
    ds_read_b64_tr_b16 v[20:21], v224 offset:3072
    ds_read_b64_tr_b16 v[22:23], v224 offset:3584
    s_waitcnt lgkmcnt(6)
    v_mfma_f32_16x16x32_bf16 v[24:27], v[8:11], v[182:185], v[24:27]
    ds_read_b64_tr_b16 v[8:9], v224 offset:4096
    ds_read_b64_tr_b16 v[10:11], v224 offset:4608
    s_waitcnt lgkmcnt(6)
    v_mfma_f32_16x16x32_bf16 v[28:31], v[12:15], v[182:185], v[28:31]
    ds_read_b64_tr_b16 v[12:13], v224 offset:5120
    ds_read_b64_tr_b16 v[14:15], v224 offset:5632
    s_waitcnt lgkmcnt(6)
    v_mfma_f32_16x16x32_bf16 v[32:35], v[16:19], v[182:185], v[32:35]
    ds_read_b64_tr_b16 v[16:17], v224 offset:6144
    ds_read_b64_tr_b16 v[18:19], v224 offset:6656
    s_waitcnt lgkmcnt(6)
    v_mfma_f32_16x16x32_bf16 v[36:39], v[20:23], v[182:185], v[36:39]
    ds_read_b64_tr_b16 v[20:21], v224 offset:7168
    ds_read_b64_tr_b16 v[22:23], v224 offset:7680
    s_waitcnt lgkmcnt(6)
    v_mfma_f32_16x16x32_bf16 v[40:43], v[8:11], v[182:185], v[40:43]
    ds_read_b64_tr_b16 v[8:9], v224 offset:8192
    ds_read_b64_tr_b16 v[10:11], v224 offset:8704
    s_waitcnt lgkmcnt(6)
    v_mfma_f32_16x16x32_bf16 v[44:47], v[12:15], v[182:185], v[44:47]
    s_waitcnt lgkmcnt(4)
    v_mfma_f32_16x16x32_bf16 v[48:51], v[16:19], v[182:185], v[48:51]
    s_waitcnt lgkmcnt(2)
    v_mfma_f32_16x16x32_bf16 v[52:55], v[20:23], v[182:185], v[52:55]
    s_waitcnt lgkmcnt(0)
    v_mfma_f32_16x16x32_bf16 v[56:59], v[8:11], v[182:185], v[56:59]
    s_waitcnt vmcnt(18)
    s_barrier
    s_mov_b32 s48, 442368
    s_add_u32 m0, s47, 90112
    s_nop 0
    buffer_load_dwordx4 v230, s[12:15], s48 offen lds
    s_mov_b32 s48, 443392
    s_add_u32 m0, s47, 91136
    s_nop 0
    buffer_load_dwordx4 v230, s[12:15], s48 offen lds
    s_mov_b32 s48, 444416
    s_add_u32 m0, s47, 92160
    s_nop 0
    buffer_load_dwordx4 v230, s[12:15], s48 offen lds
    s_mov_b32 s48, 445440
    s_add_u32 m0, s47, 93184
    s_nop 0
    buffer_load_dwordx4 v230, s[12:15], s48 offen lds
    s_mov_b32 s48, 446464
    s_add_u32 m0, s47, 94208
    s_nop 0
    buffer_load_dwordx4 v230, s[12:15], s48 offen lds
    s_mov_b32 s48, 447488
    s_add_u32 m0, s47, 95232
    s_nop 0
    buffer_load_dwordx4 v230, s[12:15], s48 offen lds
    s_mov_b32 s48, 448512
    s_add_u32 m0, s47, 96256
    s_nop 0
    buffer_load_dwordx4 v230, s[12:15], s48 offen lds
    s_mov_b32 s48, 449536
    s_add_u32 m0, s47, 97280
    s_nop 0
    buffer_load_dwordx4 v230, s[12:15], s48 offen lds
    s_mov_b32 s48, 450560
    s_add_u32 m0, s47, 98304
    s_nop 0
    buffer_load_dwordx4 v230, s[12:15], s48 offen lds
    ds_read_b64_tr_b16 v[12:13], v225 offset:0
    ds_read_b64_tr_b16 v[14:15], v225 offset:512
    ds_read_b64_tr_b16 v[16:17], v225 offset:1024
    ds_read_b64_tr_b16 v[18:19], v225 offset:1536
    ds_read_b64_tr_b16 v[20:21], v225 offset:2048
    ds_read_b64_tr_b16 v[22:23], v225 offset:2560
    ds_read_b64_tr_b16 v[8:9], v225 offset:3072
    ds_read_b64_tr_b16 v[10:11], v225 offset:3584
    s_waitcnt lgkmcnt(6)
    v_mfma_f32_16x16x32_bf16 v[24:27], v[12:15], v[186:189], v[24:27]
    ds_read_b64_tr_b16 v[12:13], v225 offset:4096
    ds_read_b64_tr_b16 v[14:15], v225 offset:4608
    s_waitcnt lgkmcnt(6)
    v_mfma_f32_16x16x32_bf16 v[28:31], v[16:19], v[186:189], v[28:31]
    ds_read_b64_tr_b16 v[16:17], v225 offset:5120
    ds_read_b64_tr_b16 v[18:19], v225 offset:5632
    s_waitcnt lgkmcnt(6)
    v_mfma_f32_16x16x32_bf16 v[32:35], v[20:23], v[186:189], v[32:35]
    ds_read_b64_tr_b16 v[20:21], v225 offset:6144
    ds_read_b64_tr_b16 v[22:23], v225 offset:6656
    s_waitcnt lgkmcnt(6)
    v_mfma_f32_16x16x32_bf16 v[36:39], v[8:11], v[186:189], v[36:39]
    ds_read_b64_tr_b16 v[8:9], v225 offset:7168
    ds_read_b64_tr_b16 v[10:11], v225 offset:7680
    s_waitcnt lgkmcnt(6)
    v_mfma_f32_16x16x32_bf16 v[40:43], v[12:15], v[186:189], v[40:43]
    ds_read_b64_tr_b16 v[12:13], v225 offset:8192
    ds_read_b64_tr_b16 v[14:15], v225 offset:8704
    s_waitcnt lgkmcnt(6)
    v_mfma_f32_16x16x32_bf16 v[44:47], v[16:19], v[186:189], v[44:47]
    s_waitcnt lgkmcnt(4)
    v_mfma_f32_16x16x32_bf16 v[48:51], v[20:23], v[186:189], v[48:51]
    s_waitcnt lgkmcnt(2)
    v_mfma_f32_16x16x32_bf16 v[52:55], v[8:11], v[186:189], v[52:55]
    s_waitcnt lgkmcnt(0)
    v_mfma_f32_16x16x32_bf16 v[56:59], v[12:15], v[186:189], v[56:59]
    s_waitcnt vmcnt(18)
    s_barrier
    s_mov_b32 s48, 479232
    s_add_u32 m0, s47, 126976
    s_nop 0
    buffer_load_dwordx4 v230, s[12:15], s48 offen lds
    s_mov_b32 s48, 480256
    s_add_u32 m0, s47, 128000
    s_nop 0
    buffer_load_dwordx4 v230, s[12:15], s48 offen lds
    s_mov_b32 s48, 481280
    s_add_u32 m0, s47, 129024
    s_nop 0
    buffer_load_dwordx4 v230, s[12:15], s48 offen lds
    s_mov_b32 s48, 482304
    s_add_u32 m0, s47, 130048
    s_nop 0
    buffer_load_dwordx4 v230, s[12:15], s48 offen lds
    s_mov_b32 s48, 483328
    s_add_u32 m0, s47, 131072
    s_nop 0
    buffer_load_dwordx4 v230, s[12:15], s48 offen lds
    s_mov_b32 s48, 484352
    s_add_u32 m0, s47, 132096
    s_nop 0
    buffer_load_dwordx4 v230, s[12:15], s48 offen lds
    s_mov_b32 s48, 485376
    s_add_u32 m0, s47, 133120
    s_nop 0
    buffer_load_dwordx4 v230, s[12:15], s48 offen lds
    s_mov_b32 s48, 486400
    s_add_u32 m0, s47, 134144
    s_nop 0
    buffer_load_dwordx4 v230, s[12:15], s48 offen lds
    s_mov_b32 s48, 487424
    s_add_u32 m0, s47, 135168
    s_nop 0
    buffer_load_dwordx4 v230, s[12:15], s48 offen lds
    ds_read_b64_tr_b16 v[16:17], v226 offset:0
    ds_read_b64_tr_b16 v[18:19], v226 offset:512
    ds_read_b64_tr_b16 v[20:21], v226 offset:1024
    ds_read_b64_tr_b16 v[22:23], v226 offset:1536
    ds_read_b64_tr_b16 v[8:9], v226 offset:2048
    ds_read_b64_tr_b16 v[10:11], v226 offset:2560
    ds_read_b64_tr_b16 v[12:13], v226 offset:3072
    ds_read_b64_tr_b16 v[14:15], v226 offset:3584
    s_waitcnt lgkmcnt(6)
    v_mfma_f32_16x16x32_bf16 v[24:27], v[16:19], v[190:193], v[24:27]
    ds_read_b64_tr_b16 v[16:17], v226 offset:4096
    ds_read_b64_tr_b16 v[18:19], v226 offset:4608
    s_waitcnt lgkmcnt(6)
    v_mfma_f32_16x16x32_bf16 v[28:31], v[20:23], v[190:193], v[28:31]
    ds_read_b64_tr_b16 v[20:21], v226 offset:5120
    ds_read_b64_tr_b16 v[22:23], v226 offset:5632
    s_waitcnt lgkmcnt(6)
    v_mfma_f32_16x16x32_bf16 v[32:35], v[8:11], v[190:193], v[32:35]
    ds_read_b64_tr_b16 v[8:9], v226 offset:6144
    ds_read_b64_tr_b16 v[10:11], v226 offset:6656
    s_waitcnt lgkmcnt(6)
    v_mfma_f32_16x16x32_bf16 v[36:39], v[12:15], v[190:193], v[36:39]
    ds_read_b64_tr_b16 v[12:13], v226 offset:7168
    ds_read_b64_tr_b16 v[14:15], v226 offset:7680
    s_waitcnt lgkmcnt(6)
    v_mfma_f32_16x16x32_bf16 v[40:43], v[16:19], v[190:193], v[40:43]
    ds_read_b64_tr_b16 v[16:17], v226 offset:8192
    ds_read_b64_tr_b16 v[18:19], v226 offset:8704
    s_waitcnt lgkmcnt(6)
    v_mfma_f32_16x16x32_bf16 v[44:47], v[20:23], v[190:193], v[44:47]
    s_waitcnt lgkmcnt(4)
    v_mfma_f32_16x16x32_bf16 v[48:51], v[8:11], v[190:193], v[48:51]
    s_waitcnt lgkmcnt(2)
    v_mfma_f32_16x16x32_bf16 v[52:55], v[12:15], v[190:193], v[52:55]
    s_waitcnt lgkmcnt(0)
    v_mfma_f32_16x16x32_bf16 v[56:59], v[16:19], v[190:193], v[56:59]
    s_waitcnt vmcnt(18)
    s_barrier
    s_mov_b32 s48, 516096
    s_add_u32 m0, s47, 0
    s_nop 0
    buffer_load_dwordx4 v230, s[12:15], s48 offen lds
    s_mov_b32 s48, 517120
    s_add_u32 m0, s47, 1024
    s_nop 0
    buffer_load_dwordx4 v230, s[12:15], s48 offen lds
    s_mov_b32 s48, 518144
    s_add_u32 m0, s47, 2048
    s_nop 0
    buffer_load_dwordx4 v230, s[12:15], s48 offen lds
    s_mov_b32 s48, 519168
    s_add_u32 m0, s47, 3072
    s_nop 0
    buffer_load_dwordx4 v230, s[12:15], s48 offen lds
    s_mov_b32 s48, 520192
    s_add_u32 m0, s47, 4096
    s_nop 0
    buffer_load_dwordx4 v230, s[12:15], s48 offen lds
    s_mov_b32 s48, 521216
    s_add_u32 m0, s47, 5120
    s_nop 0
    buffer_load_dwordx4 v230, s[12:15], s48 offen lds
    s_mov_b32 s48, 522240
    s_add_u32 m0, s47, 6144
    s_nop 0
    buffer_load_dwordx4 v230, s[12:15], s48 offen lds
    s_mov_b32 s48, 523264
    s_add_u32 m0, s47, 7168
    s_nop 0
    buffer_load_dwordx4 v230, s[12:15], s48 offen lds
    s_mov_b32 s48, 524288
    s_add_u32 m0, s47, 8192
    s_nop 0
    buffer_load_dwordx4 v230, s[12:15], s48 offen lds
    ds_read_b64_tr_b16 v[20:21], v227 offset:0
    ds_read_b64_tr_b16 v[22:23], v227 offset:512
    ds_read_b64_tr_b16 v[8:9], v227 offset:1024
    ds_read_b64_tr_b16 v[10:11], v227 offset:1536
    ds_read_b64_tr_b16 v[12:13], v227 offset:2048
    ds_read_b64_tr_b16 v[14:15], v227 offset:2560
    ds_read_b64_tr_b16 v[16:17], v227 offset:3072
    ds_read_b64_tr_b16 v[18:19], v227 offset:3584
    s_waitcnt lgkmcnt(6)
    v_mfma_f32_16x16x32_bf16 v[24:27], v[20:23], v[194:197], v[24:27]
    ds_read_b64_tr_b16 v[20:21], v227 offset:4096
    ds_read_b64_tr_b16 v[22:23], v227 offset:4608
    s_waitcnt lgkmcnt(6)
    v_mfma_f32_16x16x32_bf16 v[28:31], v[8:11], v[194:197], v[28:31]
    ds_read_b64_tr_b16 v[8:9], v227 offset:5120
    ds_read_b64_tr_b16 v[10:11], v227 offset:5632
    s_waitcnt lgkmcnt(6)
    v_mfma_f32_16x16x32_bf16 v[32:35], v[12:15], v[194:197], v[32:35]
    ds_read_b64_tr_b16 v[12:13], v227 offset:6144
    ds_read_b64_tr_b16 v[14:15], v227 offset:6656
    s_waitcnt lgkmcnt(6)
    v_mfma_f32_16x16x32_bf16 v[36:39], v[16:19], v[194:197], v[36:39]
    ds_read_b64_tr_b16 v[16:17], v227 offset:7168
    ds_read_b64_tr_b16 v[18:19], v227 offset:7680
    s_waitcnt lgkmcnt(6)
    v_mfma_f32_16x16x32_bf16 v[40:43], v[20:23], v[194:197], v[40:43]
    ds_read_b64_tr_b16 v[20:21], v227 offset:8192
    ds_read_b64_tr_b16 v[22:23], v227 offset:8704
    s_waitcnt lgkmcnt(6)
    v_mfma_f32_16x16x32_bf16 v[44:47], v[8:11], v[194:197], v[44:47]
    s_waitcnt lgkmcnt(4)
    v_mfma_f32_16x16x32_bf16 v[48:51], v[12:15], v[194:197], v[48:51]
    s_waitcnt lgkmcnt(2)
    v_mfma_f32_16x16x32_bf16 v[52:55], v[16:19], v[194:197], v[52:55]
    s_waitcnt lgkmcnt(0)
    v_mfma_f32_16x16x32_bf16 v[56:59], v[20:23], v[194:197], v[56:59]
    s_waitcnt vmcnt(18)
    s_barrier
    s_mov_b32 s48, 552960
    s_add_u32 m0, s47, 36864
    s_nop 0
    buffer_load_dwordx4 v230, s[12:15], s48 offen lds
    s_mov_b32 s48, 553984
    s_add_u32 m0, s47, 37888
    s_nop 0
    buffer_load_dwordx4 v230, s[12:15], s48 offen lds
    s_mov_b32 s48, 555008
    s_add_u32 m0, s47, 38912
    s_nop 0
    buffer_load_dwordx4 v230, s[12:15], s48 offen lds
    s_mov_b32 s48, 556032
    s_add_u32 m0, s47, 39936
    s_nop 0
    buffer_load_dwordx4 v230, s[12:15], s48 offen lds
    s_mov_b32 s48, 557056
    s_add_u32 m0, s47, 40960
    s_nop 0
    buffer_load_dwordx4 v230, s[12:15], s48 offen lds
    s_mov_b32 s48, 558080
    s_add_u32 m0, s47, 41984
    s_nop 0
    buffer_load_dwordx4 v230, s[12:15], s48 offen lds
    s_mov_b32 s48, 559104
    s_add_u32 m0, s47, 43008
    s_nop 0
    buffer_load_dwordx4 v230, s[12:15], s48 offen lds
    s_mov_b32 s48, 560128
    s_add_u32 m0, s47, 44032
    s_nop 0
    buffer_load_dwordx4 v230, s[12:15], s48 offen lds
    s_mov_b32 s48, 561152
    s_add_u32 m0, s47, 45056
    s_nop 0
    buffer_load_dwordx4 v230, s[12:15], s48 offen lds
    ds_read_b64_tr_b16 v[8:9], v224 offset:0
    ds_read_b64_tr_b16 v[10:11], v224 offset:512
    ds_read_b64_tr_b16 v[12:13], v224 offset:1024
    ds_read_b64_tr_b16 v[14:15], v224 offset:1536
    ds_read_b64_tr_b16 v[16:17], v224 offset:2048
    ds_read_b64_tr_b16 v[18:19], v224 offset:2560
    ds_read_b64_tr_b16 v[20:21], v224 offset:3072
    ds_read_b64_tr_b16 v[22:23], v224 offset:3584
    s_waitcnt lgkmcnt(6)
    v_mfma_f32_16x16x32_bf16 v[24:27], v[8:11], v[198:201], v[24:27]
    ds_read_b64_tr_b16 v[8:9], v224 offset:4096
    ds_read_b64_tr_b16 v[10:11], v224 offset:4608
    s_waitcnt lgkmcnt(6)
    v_mfma_f32_16x16x32_bf16 v[28:31], v[12:15], v[198:201], v[28:31]
    ds_read_b64_tr_b16 v[12:13], v224 offset:5120
    ds_read_b64_tr_b16 v[14:15], v224 offset:5632
    s_waitcnt lgkmcnt(6)
    v_mfma_f32_16x16x32_bf16 v[32:35], v[16:19], v[198:201], v[32:35]
    ds_read_b64_tr_b16 v[16:17], v224 offset:6144
    ds_read_b64_tr_b16 v[18:19], v224 offset:6656
    s_waitcnt lgkmcnt(6)
    v_mfma_f32_16x16x32_bf16 v[36:39], v[20:23], v[198:201], v[36:39]
    ds_read_b64_tr_b16 v[20:21], v224 offset:7168
    ds_read_b64_tr_b16 v[22:23], v224 offset:7680
    s_waitcnt lgkmcnt(6)
    v_mfma_f32_16x16x32_bf16 v[40:43], v[8:11], v[198:201], v[40:43]
    ds_read_b64_tr_b16 v[8:9], v224 offset:8192
    ds_read_b64_tr_b16 v[10:11], v224 offset:8704
    s_waitcnt lgkmcnt(6)
    v_mfma_f32_16x16x32_bf16 v[44:47], v[12:15], v[198:201], v[44:47]
    s_waitcnt lgkmcnt(4)
    v_mfma_f32_16x16x32_bf16 v[48:51], v[16:19], v[198:201], v[48:51]
    s_waitcnt lgkmcnt(2)
    v_mfma_f32_16x16x32_bf16 v[52:55], v[20:23], v[198:201], v[52:55]
    s_waitcnt lgkmcnt(0)
    v_mfma_f32_16x16x32_bf16 v[56:59], v[8:11], v[198:201], v[56:59]
    s_waitcnt vmcnt(18)
    s_barrier
    s_mov_b32 s48, 589824
    s_add_u32 m0, s47, 90112
    s_nop 0
    buffer_load_dwordx4 v230, s[12:15], s48 offen lds
    s_mov_b32 s48, 590848
    s_add_u32 m0, s47, 91136
    s_nop 0
    buffer_load_dwordx4 v230, s[12:15], s48 offen lds
    s_mov_b32 s48, 591872
    s_add_u32 m0, s47, 92160
    s_nop 0
    buffer_load_dwordx4 v230, s[12:15], s48 offen lds
    s_mov_b32 s48, 592896
    s_add_u32 m0, s47, 93184
    s_nop 0
    buffer_load_dwordx4 v230, s[12:15], s48 offen lds
    s_mov_b32 s48, 593920
    s_add_u32 m0, s47, 94208
    s_nop 0
    buffer_load_dwordx4 v230, s[12:15], s48 offen lds
    s_mov_b32 s48, 594944
    s_add_u32 m0, s47, 95232
    s_nop 0
    buffer_load_dwordx4 v230, s[12:15], s48 offen lds
    s_mov_b32 s48, 595968
    s_add_u32 m0, s47, 96256
    s_nop 0
    buffer_load_dwordx4 v230, s[12:15], s48 offen lds
    s_mov_b32 s48, 596992
    s_add_u32 m0, s47, 97280
    s_nop 0
    buffer_load_dwordx4 v230, s[12:15], s48 offen lds
    s_mov_b32 s48, 598016
    s_add_u32 m0, s47, 98304
    s_nop 0
    buffer_load_dwordx4 v230, s[12:15], s48 offen lds
    ds_read_b64_tr_b16 v[12:13], v225 offset:0
    ds_read_b64_tr_b16 v[14:15], v225 offset:512
    ds_read_b64_tr_b16 v[16:17], v225 offset:1024
    ds_read_b64_tr_b16 v[18:19], v225 offset:1536
    ds_read_b64_tr_b16 v[20:21], v225 offset:2048
    ds_read_b64_tr_b16 v[22:23], v225 offset:2560
    ds_read_b64_tr_b16 v[8:9], v225 offset:3072
    ds_read_b64_tr_b16 v[10:11], v225 offset:3584
    s_waitcnt lgkmcnt(6)
    v_mfma_f32_16x16x32_bf16 v[24:27], v[12:15], v[202:205], v[24:27]
    ds_read_b64_tr_b16 v[12:13], v225 offset:4096
    ds_read_b64_tr_b16 v[14:15], v225 offset:4608
    s_waitcnt lgkmcnt(6)
    v_mfma_f32_16x16x32_bf16 v[28:31], v[16:19], v[202:205], v[28:31]
    ds_read_b64_tr_b16 v[16:17], v225 offset:5120
    ds_read_b64_tr_b16 v[18:19], v225 offset:5632
    s_waitcnt lgkmcnt(6)
    v_mfma_f32_16x16x32_bf16 v[32:35], v[20:23], v[202:205], v[32:35]
    ds_read_b64_tr_b16 v[20:21], v225 offset:6144
    ds_read_b64_tr_b16 v[22:23], v225 offset:6656
    s_waitcnt lgkmcnt(6)
    v_mfma_f32_16x16x32_bf16 v[36:39], v[8:11], v[202:205], v[36:39]
    ds_read_b64_tr_b16 v[8:9], v225 offset:7168
    ds_read_b64_tr_b16 v[10:11], v225 offset:7680
    s_waitcnt lgkmcnt(6)
    v_mfma_f32_16x16x32_bf16 v[40:43], v[12:15], v[202:205], v[40:43]
    ds_read_b64_tr_b16 v[12:13], v225 offset:8192
    ds_read_b64_tr_b16 v[14:15], v225 offset:8704
    s_waitcnt lgkmcnt(6)
    v_mfma_f32_16x16x32_bf16 v[44:47], v[16:19], v[202:205], v[44:47]
    s_waitcnt lgkmcnt(4)
    v_mfma_f32_16x16x32_bf16 v[48:51], v[20:23], v[202:205], v[48:51]
    s_waitcnt lgkmcnt(2)
    v_mfma_f32_16x16x32_bf16 v[52:55], v[8:11], v[202:205], v[52:55]
    s_waitcnt lgkmcnt(0)
    v_mfma_f32_16x16x32_bf16 v[56:59], v[12:15], v[202:205], v[56:59]
    s_waitcnt vmcnt(18)
    s_barrier
    s_mov_b32 s48, 626688
    s_add_u32 m0, s47, 126976
    s_nop 0
    buffer_load_dwordx4 v230, s[12:15], s48 offen lds
    s_mov_b32 s48, 627712
    s_add_u32 m0, s47, 128000
    s_nop 0
    buffer_load_dwordx4 v230, s[12:15], s48 offen lds
    s_mov_b32 s48, 628736
    s_add_u32 m0, s47, 129024
    s_nop 0
    buffer_load_dwordx4 v230, s[12:15], s48 offen lds
    s_mov_b32 s48, 629760
    s_add_u32 m0, s47, 130048
    s_nop 0
    buffer_load_dwordx4 v230, s[12:15], s48 offen lds
    s_mov_b32 s48, 630784
    s_add_u32 m0, s47, 131072
    s_nop 0
    buffer_load_dwordx4 v230, s[12:15], s48 offen lds
    s_mov_b32 s48, 631808
    s_add_u32 m0, s47, 132096
    s_nop 0
    buffer_load_dwordx4 v230, s[12:15], s48 offen lds
    s_mov_b32 s48, 632832
    s_add_u32 m0, s47, 133120
    s_nop 0
    buffer_load_dwordx4 v230, s[12:15], s48 offen lds
    s_mov_b32 s48, 633856
    s_add_u32 m0, s47, 134144
    s_nop 0
    buffer_load_dwordx4 v230, s[12:15], s48 offen lds
    s_mov_b32 s48, 634880
    s_add_u32 m0, s47, 135168
    s_nop 0
    buffer_load_dwordx4 v230, s[12:15], s48 offen lds
    ds_read_b64_tr_b16 v[16:17], v226 offset:0
    ds_read_b64_tr_b16 v[18:19], v226 offset:512
    ds_read_b64_tr_b16 v[20:21], v226 offset:1024
    ds_read_b64_tr_b16 v[22:23], v226 offset:1536
    ds_read_b64_tr_b16 v[8:9], v226 offset:2048
    ds_read_b64_tr_b16 v[10:11], v226 offset:2560
    ds_read_b64_tr_b16 v[12:13], v226 offset:3072
    ds_read_b64_tr_b16 v[14:15], v226 offset:3584
    s_waitcnt lgkmcnt(6)
    v_mfma_f32_16x16x32_bf16 v[24:27], v[16:19], v[206:209], v[24:27]
    ds_read_b64_tr_b16 v[16:17], v226 offset:4096
    ds_read_b64_tr_b16 v[18:19], v226 offset:4608
    s_waitcnt lgkmcnt(6)
    v_mfma_f32_16x16x32_bf16 v[28:31], v[20:23], v[206:209], v[28:31]
    ds_read_b64_tr_b16 v[20:21], v226 offset:5120
    ds_read_b64_tr_b16 v[22:23], v226 offset:5632
    s_waitcnt lgkmcnt(6)
    v_mfma_f32_16x16x32_bf16 v[32:35], v[8:11], v[206:209], v[32:35]
    ds_read_b64_tr_b16 v[8:9], v226 offset:6144
    ds_read_b64_tr_b16 v[10:11], v226 offset:6656
    s_waitcnt lgkmcnt(6)
    v_mfma_f32_16x16x32_bf16 v[36:39], v[12:15], v[206:209], v[36:39]
    ds_read_b64_tr_b16 v[12:13], v226 offset:7168
    ds_read_b64_tr_b16 v[14:15], v226 offset:7680
    s_waitcnt lgkmcnt(6)
    v_mfma_f32_16x16x32_bf16 v[40:43], v[16:19], v[206:209], v[40:43]
    ds_read_b64_tr_b16 v[16:17], v226 offset:8192
    ds_read_b64_tr_b16 v[18:19], v226 offset:8704
    s_waitcnt lgkmcnt(6)
    v_mfma_f32_16x16x32_bf16 v[44:47], v[20:23], v[206:209], v[44:47]
    s_waitcnt lgkmcnt(4)
    v_mfma_f32_16x16x32_bf16 v[48:51], v[8:11], v[206:209], v[48:51]
    s_waitcnt lgkmcnt(2)
    v_mfma_f32_16x16x32_bf16 v[52:55], v[12:15], v[206:209], v[52:55]
    s_waitcnt lgkmcnt(0)
    v_mfma_f32_16x16x32_bf16 v[56:59], v[16:19], v[206:209], v[56:59]
    s_waitcnt vmcnt(18)
    s_barrier
    ds_read_b64_tr_b16 v[20:21], v227 offset:0
    ds_read_b64_tr_b16 v[22:23], v227 offset:512
    ds_read_b64_tr_b16 v[8:9], v227 offset:1024
    ds_read_b64_tr_b16 v[10:11], v227 offset:1536
    ds_read_b64_tr_b16 v[12:13], v227 offset:2048
    ds_read_b64_tr_b16 v[14:15], v227 offset:2560
    ds_read_b64_tr_b16 v[16:17], v227 offset:3072
    ds_read_b64_tr_b16 v[18:19], v227 offset:3584
    s_waitcnt lgkmcnt(6)
    v_mfma_f32_16x16x32_bf16 v[24:27], v[20:23], v[210:213], v[24:27]
    ds_read_b64_tr_b16 v[20:21], v227 offset:4096
    ds_read_b64_tr_b16 v[22:23], v227 offset:4608
    s_waitcnt lgkmcnt(6)
    v_mfma_f32_16x16x32_bf16 v[28:31], v[8:11], v[210:213], v[28:31]
    ds_read_b64_tr_b16 v[8:9], v227 offset:5120
    ds_read_b64_tr_b16 v[10:11], v227 offset:5632
    s_waitcnt lgkmcnt(6)
    v_mfma_f32_16x16x32_bf16 v[32:35], v[12:15], v[210:213], v[32:35]
    ds_read_b64_tr_b16 v[12:13], v227 offset:6144
    ds_read_b64_tr_b16 v[14:15], v227 offset:6656
    s_waitcnt lgkmcnt(6)
    v_mfma_f32_16x16x32_bf16 v[36:39], v[16:19], v[210:213], v[36:39]
    ds_read_b64_tr_b16 v[16:17], v227 offset:7168
    ds_read_b64_tr_b16 v[18:19], v227 offset:7680
    s_waitcnt lgkmcnt(6)
    v_mfma_f32_16x16x32_bf16 v[40:43], v[20:23], v[210:213], v[40:43]
    ds_read_b64_tr_b16 v[20:21], v227 offset:8192
    ds_read_b64_tr_b16 v[22:23], v227 offset:8704
    s_waitcnt lgkmcnt(6)
    v_mfma_f32_16x16x32_bf16 v[44:47], v[8:11], v[210:213], v[44:47]
    s_waitcnt lgkmcnt(4)
    v_mfma_f32_16x16x32_bf16 v[48:51], v[12:15], v[210:213], v[48:51]
    s_waitcnt lgkmcnt(2)
    v_mfma_f32_16x16x32_bf16 v[52:55], v[16:19], v[210:213], v[52:55]
    s_waitcnt lgkmcnt(0)
    v_mfma_f32_16x16x32_bf16 v[56:59], v[20:23], v[210:213], v[56:59]
    s_waitcnt vmcnt(9)
    s_barrier
    ds_read_b64_tr_b16 v[8:9], v224 offset:0
    ds_read_b64_tr_b16 v[10:11], v224 offset:512
    ds_read_b64_tr_b16 v[12:13], v224 offset:1024
    ds_read_b64_tr_b16 v[14:15], v224 offset:1536
    ds_read_b64_tr_b16 v[16:17], v224 offset:2048
    ds_read_b64_tr_b16 v[18:19], v224 offset:2560
    ds_read_b64_tr_b16 v[20:21], v224 offset:3072
    ds_read_b64_tr_b16 v[22:23], v224 offset:3584
    s_waitcnt lgkmcnt(6)
    v_mfma_f32_16x16x32_bf16 v[24:27], v[8:11], v[214:217], v[24:27]
    ds_read_b64_tr_b16 v[8:9], v224 offset:4096
    ds_read_b64_tr_b16 v[10:11], v224 offset:4608
    s_waitcnt lgkmcnt(6)
    v_mfma_f32_16x16x32_bf16 v[28:31], v[12:15], v[214:217], v[28:31]
    ds_read_b64_tr_b16 v[12:13], v224 offset:5120
    ds_read_b64_tr_b16 v[14:15], v224 offset:5632
    s_waitcnt lgkmcnt(6)
    v_mfma_f32_16x16x32_bf16 v[32:35], v[16:19], v[214:217], v[32:35]
    ds_read_b64_tr_b16 v[16:17], v224 offset:6144
    ds_read_b64_tr_b16 v[18:19], v224 offset:6656
    s_waitcnt lgkmcnt(6)
    v_mfma_f32_16x16x32_bf16 v[36:39], v[20:23], v[214:217], v[36:39]
    ds_read_b64_tr_b16 v[20:21], v224 offset:7168
    ds_read_b64_tr_b16 v[22:23], v224 offset:7680
    s_waitcnt lgkmcnt(6)
    v_mfma_f32_16x16x32_bf16 v[40:43], v[8:11], v[214:217], v[40:43]
    ds_read_b64_tr_b16 v[8:9], v224 offset:8192
    ds_read_b64_tr_b16 v[10:11], v224 offset:8704
    s_waitcnt lgkmcnt(6)
    v_mfma_f32_16x16x32_bf16 v[44:47], v[12:15], v[214:217], v[44:47]
    s_waitcnt lgkmcnt(4)
    v_mfma_f32_16x16x32_bf16 v[48:51], v[16:19], v[214:217], v[48:51]
    s_waitcnt lgkmcnt(2)
    v_mfma_f32_16x16x32_bf16 v[52:55], v[20:23], v[214:217], v[52:55]
    s_waitcnt lgkmcnt(0)
    v_mfma_f32_16x16x32_bf16 v[56:59], v[8:11], v[214:217], v[56:59]
    s_waitcnt vmcnt(0)
    s_barrier
    ds_read_b64_tr_b16 v[12:13], v225 offset:0
    ds_read_b64_tr_b16 v[14:15], v225 offset:512
    ds_read_b64_tr_b16 v[16:17], v225 offset:1024
    ds_read_b64_tr_b16 v[18:19], v225 offset:1536
    ds_read_b64_tr_b16 v[20:21], v225 offset:2048
    ds_read_b64_tr_b16 v[22:23], v225 offset:2560
    ds_read_b64_tr_b16 v[8:9], v225 offset:3072
    ds_read_b64_tr_b16 v[10:11], v225 offset:3584
    s_waitcnt lgkmcnt(6)
    v_mfma_f32_16x16x32_bf16 v[24:27], v[12:15], v[218:221], v[24:27]
    ds_read_b64_tr_b16 v[12:13], v225 offset:4096
    ds_read_b64_tr_b16 v[14:15], v225 offset:4608
    s_waitcnt lgkmcnt(6)
    v_mfma_f32_16x16x32_bf16 v[28:31], v[16:19], v[218:221], v[28:31]
    ds_read_b64_tr_b16 v[16:17], v225 offset:5120
    ds_read_b64_tr_b16 v[18:19], v225 offset:5632
    s_waitcnt lgkmcnt(6)
    v_mfma_f32_16x16x32_bf16 v[32:35], v[20:23], v[218:221], v[32:35]
    ds_read_b64_tr_b16 v[20:21], v225 offset:6144
    ds_read_b64_tr_b16 v[22:23], v225 offset:6656
    s_waitcnt lgkmcnt(6)
    v_mfma_f32_16x16x32_bf16 v[36:39], v[8:11], v[218:221], v[36:39]
    ds_read_b64_tr_b16 v[8:9], v225 offset:7168
    ds_read_b64_tr_b16 v[10:11], v225 offset:7680
    s_waitcnt lgkmcnt(6)
    v_mfma_f32_16x16x32_bf16 v[40:43], v[12:15], v[218:221], v[40:43]
    ds_read_b64_tr_b16 v[12:13], v225 offset:8192
    ds_read_b64_tr_b16 v[14:15], v225 offset:8704
    s_waitcnt lgkmcnt(6)
    v_mfma_f32_16x16x32_bf16 v[44:47], v[16:19], v[218:221], v[44:47]
    s_waitcnt lgkmcnt(4)
    v_mfma_f32_16x16x32_bf16 v[48:51], v[20:23], v[218:221], v[48:51]
    s_waitcnt lgkmcnt(2)
    v_mfma_f32_16x16x32_bf16 v[52:55], v[8:11], v[218:221], v[52:55]
    s_waitcnt lgkmcnt(0)
    v_mfma_f32_16x16x32_bf16 v[56:59], v[12:15], v[218:221], v[56:59]
    s_waitcnt vmcnt(0)
    ds_read_b128 v[100:103], v6 offset:0
    ds_read_b128 v[140:143], v6 offset:2304
    ds_read_b128 v[176:179], v6 offset:4608
    ds_read_b128 v[104:107], v6 offset:64
    ds_read_b128 v[144:147], v6 offset:2368
    ds_read_b128 v[180:183], v6 offset:4672
    ds_read_b128 v[108:111], v6 offset:128
    ds_read_b128 v[148:151], v6 offset:2432
    ds_read_b128 v[184:187], v6 offset:4736
    ds_read_b128 v[112:115], v6 offset:192
    ds_read_b128 v[152:155], v6 offset:2496
    ds_read_b128 v[188:191], v6 offset:4800
    ds_read_b128 v[116:119], v6 offset:256
    ds_read_b128 v[156:159], v6 offset:2560
    ds_read_b128 v[192:195], v6 offset:4864
    ds_read_b128 v[120:123], v6 offset:320
    ds_read_b128 v[160:163], v6 offset:2624
    ds_read_b128 v[196:199], v6 offset:4928
    ds_read_b128 v[124:127], v6 offset:384
    ds_read_b128 v[164:167], v6 offset:2688
    ds_read_b128 v[200:203], v6 offset:4992
    ds_read_b128 v[128:131], v6 offset:448
    ds_read_b128 v[168:171], v6 offset:2752
    ds_read_b128 v[204:207], v6 offset:5056
    ds_read_b128 v[132:135], v6 offset:512
    ds_read_b128 v[172:175], v6 offset:2816
    ds_read_b128 v[208:211], v6 offset:5120
    s_waitcnt lgkmcnt(0)
    v_cvt_pk_bf16_f32 v8, v24, v25
    v_lshlrev_b32 v9, 16, v8
    v_and_b32 v8, 0xffff0000, v8
    v_mul_f32 v9, v9, v100
    v_mul_f32 v8, v8, v101
    v_cvt_pk_bf16_f32 v8, v9, v8
    v_lshlrev_b32 v9, 16, v8
    v_and_b32 v8, 0xffff0000, v8
    v_lshlrev_b32 v10, 16, v60
    v_and_b32 v11, 0xffff0000, v60
    v_add_f32 v9, v9, v10
    v_add_f32 v8, v8, v11
    v_cvt_pk_bf16_f32 v60, v9, v8
    v_lshlrev_b32 v24, 16, v60
    v_and_b32 v25, 0xffff0000, v60
    v_cvt_pk_bf16_f32 v8, v26, v27
    v_lshlrev_b32 v9, 16, v8
    v_and_b32 v8, 0xffff0000, v8
    v_mul_f32 v9, v9, v102
    v_mul_f32 v8, v8, v103
    v_cvt_pk_bf16_f32 v8, v9, v8
    v_lshlrev_b32 v9, 16, v8
    v_and_b32 v8, 0xffff0000, v8
    v_lshlrev_b32 v10, 16, v61
    v_and_b32 v11, 0xffff0000, v61
    v_add_f32 v9, v9, v10
    v_add_f32 v8, v8, v11
    v_cvt_pk_bf16_f32 v61, v9, v8
    v_lshlrev_b32 v26, 16, v61
    v_and_b32 v27, 0xffff0000, v61
    v_cvt_pk_bf16_f32 v8, v28, v29
    v_lshlrev_b32 v9, 16, v8
    v_and_b32 v8, 0xffff0000, v8
    v_mul_f32 v9, v9, v104
    v_mul_f32 v8, v8, v105
    v_cvt_pk_bf16_f32 v8, v9, v8
    v_lshlrev_b32 v9, 16, v8
    v_and_b32 v8, 0xffff0000, v8
    v_lshlrev_b32 v10, 16, v62
    v_and_b32 v11, 0xffff0000, v62
    v_add_f32 v9, v9, v10
    v_add_f32 v8, v8, v11
    v_cvt_pk_bf16_f32 v62, v9, v8
    v_lshlrev_b32 v28, 16, v62
    v_and_b32 v29, 0xffff0000, v62
    v_cvt_pk_bf16_f32 v8, v30, v31
    v_lshlrev_b32 v9, 16, v8
    v_and_b32 v8, 0xffff0000, v8
    v_mul_f32 v9, v9, v106
    v_mul_f32 v8, v8, v107
    v_cvt_pk_bf16_f32 v8, v9, v8
    v_lshlrev_b32 v9, 16, v8
    v_and_b32 v8, 0xffff0000, v8
    v_lshlrev_b32 v10, 16, v63
    v_and_b32 v11, 0xffff0000, v63
    v_add_f32 v9, v9, v10
    v_add_f32 v8, v8, v11
    v_cvt_pk_bf16_f32 v63, v9, v8
    v_lshlrev_b32 v30, 16, v63
    v_and_b32 v31, 0xffff0000, v63
    v_cvt_pk_bf16_f32 v8, v32, v33
    v_lshlrev_b32 v9, 16, v8
    v_and_b32 v8, 0xffff0000, v8
    v_mul_f32 v9, v9, v108
    v_mul_f32 v8, v8, v109
    v_cvt_pk_bf16_f32 v8, v9, v8
    v_lshlrev_b32 v9, 16, v8
    v_and_b32 v8, 0xffff0000, v8
    v_lshlrev_b32 v10, 16, v64
    v_and_b32 v11, 0xffff0000, v64
    v_add_f32 v9, v9, v10
    v_add_f32 v8, v8, v11
    v_cvt_pk_bf16_f32 v64, v9, v8
    v_lshlrev_b32 v32, 16, v64
    v_and_b32 v33, 0xffff0000, v64
    v_cvt_pk_bf16_f32 v8, v34, v35
    v_lshlrev_b32 v9, 16, v8
    v_and_b32 v8, 0xffff0000, v8
    v_mul_f32 v9, v9, v110
    v_mul_f32 v8, v8, v111
    v_cvt_pk_bf16_f32 v8, v9, v8
    v_lshlrev_b32 v9, 16, v8
    v_and_b32 v8, 0xffff0000, v8
    v_lshlrev_b32 v10, 16, v65
    v_and_b32 v11, 0xffff0000, v65
    v_add_f32 v9, v9, v10
    v_add_f32 v8, v8, v11
    v_cvt_pk_bf16_f32 v65, v9, v8
    v_lshlrev_b32 v34, 16, v65
    v_and_b32 v35, 0xffff0000, v65
    v_cvt_pk_bf16_f32 v8, v36, v37
    v_lshlrev_b32 v9, 16, v8
    v_and_b32 v8, 0xffff0000, v8
    v_mul_f32 v9, v9, v112
    v_mul_f32 v8, v8, v113
    v_cvt_pk_bf16_f32 v8, v9, v8
    v_lshlrev_b32 v9, 16, v8
    v_and_b32 v8, 0xffff0000, v8
    v_lshlrev_b32 v10, 16, v66
    v_and_b32 v11, 0xffff0000, v66
    v_add_f32 v9, v9, v10
    v_add_f32 v8, v8, v11
    v_cvt_pk_bf16_f32 v66, v9, v8
    v_lshlrev_b32 v36, 16, v66
    v_and_b32 v37, 0xffff0000, v66
    v_cvt_pk_bf16_f32 v8, v38, v39
    v_lshlrev_b32 v9, 16, v8
    v_and_b32 v8, 0xffff0000, v8
    v_mul_f32 v9, v9, v114
    v_mul_f32 v8, v8, v115
    v_cvt_pk_bf16_f32 v8, v9, v8
    v_lshlrev_b32 v9, 16, v8
    v_and_b32 v8, 0xffff0000, v8
    v_lshlrev_b32 v10, 16, v67
    v_and_b32 v11, 0xffff0000, v67
    v_add_f32 v9, v9, v10
    v_add_f32 v8, v8, v11
    v_cvt_pk_bf16_f32 v67, v9, v8
    v_lshlrev_b32 v38, 16, v67
    v_and_b32 v39, 0xffff0000, v67
    v_cvt_pk_bf16_f32 v8, v40, v41
    v_lshlrev_b32 v9, 16, v8
    v_and_b32 v8, 0xffff0000, v8
    v_mul_f32 v9, v9, v116
    v_mul_f32 v8, v8, v117
    v_cvt_pk_bf16_f32 v8, v9, v8
    v_lshlrev_b32 v9, 16, v8
    v_and_b32 v8, 0xffff0000, v8
    v_lshlrev_b32 v10, 16, v68
    v_and_b32 v11, 0xffff0000, v68
    v_add_f32 v9, v9, v10
    v_add_f32 v8, v8, v11
    v_cvt_pk_bf16_f32 v68, v9, v8
    v_lshlrev_b32 v40, 16, v68
    v_and_b32 v41, 0xffff0000, v68
    v_cvt_pk_bf16_f32 v8, v42, v43
    v_lshlrev_b32 v9, 16, v8
    v_and_b32 v8, 0xffff0000, v8
    v_mul_f32 v9, v9, v118
    v_mul_f32 v8, v8, v119
    v_cvt_pk_bf16_f32 v8, v9, v8
    v_lshlrev_b32 v9, 16, v8
    v_and_b32 v8, 0xffff0000, v8
    v_lshlrev_b32 v10, 16, v69
    v_and_b32 v11, 0xffff0000, v69
    v_add_f32 v9, v9, v10
    v_add_f32 v8, v8, v11
    v_cvt_pk_bf16_f32 v69, v9, v8
    v_lshlrev_b32 v42, 16, v69
    v_and_b32 v43, 0xffff0000, v69
    v_cvt_pk_bf16_f32 v8, v44, v45
    v_lshlrev_b32 v9, 16, v8
    v_and_b32 v8, 0xffff0000, v8
    v_mul_f32 v9, v9, v120
    v_mul_f32 v8, v8, v121
    v_cvt_pk_bf16_f32 v8, v9, v8
    v_lshlrev_b32 v9, 16, v8
    v_and_b32 v8, 0xffff0000, v8
    v_lshlrev_b32 v10, 16, v70
    v_and_b32 v11, 0xffff0000, v70
    v_add_f32 v9, v9, v10
    v_add_f32 v8, v8, v11
    v_cvt_pk_bf16_f32 v70, v9, v8
    v_lshlrev_b32 v44, 16, v70
    v_and_b32 v45, 0xffff0000, v70
    v_cvt_pk_bf16_f32 v8, v46, v47
    v_lshlrev_b32 v9, 16, v8
    v_and_b32 v8, 0xffff0000, v8
    v_mul_f32 v9, v9, v122
    v_mul_f32 v8, v8, v123
    v_cvt_pk_bf16_f32 v8, v9, v8
    v_lshlrev_b32 v9, 16, v8
    v_and_b32 v8, 0xffff0000, v8
    v_lshlrev_b32 v10, 16, v71
    v_and_b32 v11, 0xffff0000, v71
    v_add_f32 v9, v9, v10
    v_add_f32 v8, v8, v11
    v_cvt_pk_bf16_f32 v71, v9, v8
    v_lshlrev_b32 v46, 16, v71
    v_and_b32 v47, 0xffff0000, v71
    v_cvt_pk_bf16_f32 v8, v48, v49
    v_lshlrev_b32 v9, 16, v8
    v_and_b32 v8, 0xffff0000, v8
    v_mul_f32 v9, v9, v124
    v_mul_f32 v8, v8, v125
    v_cvt_pk_bf16_f32 v8, v9, v8
    v_lshlrev_b32 v9, 16, v8
    v_and_b32 v8, 0xffff0000, v8
    v_lshlrev_b32 v10, 16, v72
    v_and_b32 v11, 0xffff0000, v72
    v_add_f32 v9, v9, v10
    v_add_f32 v8, v8, v11
    v_cvt_pk_bf16_f32 v72, v9, v8
    v_lshlrev_b32 v48, 16, v72
    v_and_b32 v49, 0xffff0000, v72
    v_cvt_pk_bf16_f32 v8, v50, v51
    v_lshlrev_b32 v9, 16, v8
    v_and_b32 v8, 0xffff0000, v8
    v_mul_f32 v9, v9, v126
    v_mul_f32 v8, v8, v127
    v_cvt_pk_bf16_f32 v8, v9, v8
    v_lshlrev_b32 v9, 16, v8
    v_and_b32 v8, 0xffff0000, v8
    v_lshlrev_b32 v10, 16, v73
    v_and_b32 v11, 0xffff0000, v73
    v_add_f32 v9, v9, v10
    v_add_f32 v8, v8, v11
    v_cvt_pk_bf16_f32 v73, v9, v8
    v_lshlrev_b32 v50, 16, v73
    v_and_b32 v51, 0xffff0000, v73
    v_cvt_pk_bf16_f32 v8, v52, v53
    v_lshlrev_b32 v9, 16, v8
    v_and_b32 v8, 0xffff0000, v8
    v_mul_f32 v9, v9, v128
    v_mul_f32 v8, v8, v129
    v_cvt_pk_bf16_f32 v8, v9, v8
    v_lshlrev_b32 v9, 16, v8
    v_and_b32 v8, 0xffff0000, v8
    v_lshlrev_b32 v10, 16, v74
    v_and_b32 v11, 0xffff0000, v74
    v_add_f32 v9, v9, v10
    v_add_f32 v8, v8, v11
    v_cvt_pk_bf16_f32 v74, v9, v8
    v_lshlrev_b32 v52, 16, v74
    v_and_b32 v53, 0xffff0000, v74
    v_cvt_pk_bf16_f32 v8, v54, v55
    v_lshlrev_b32 v9, 16, v8
    v_and_b32 v8, 0xffff0000, v8
    v_mul_f32 v9, v9, v130
    v_mul_f32 v8, v8, v131
    v_cvt_pk_bf16_f32 v8, v9, v8
    v_lshlrev_b32 v9, 16, v8
    v_and_b32 v8, 0xffff0000, v8
    v_lshlrev_b32 v10, 16, v75
    v_and_b32 v11, 0xffff0000, v75
    v_add_f32 v9, v9, v10
    v_add_f32 v8, v8, v11
    v_cvt_pk_bf16_f32 v75, v9, v8
    v_lshlrev_b32 v54, 16, v75
    v_and_b32 v55, 0xffff0000, v75
    v_cvt_pk_bf16_f32 v8, v56, v57
    v_lshlrev_b32 v9, 16, v8
    v_and_b32 v8, 0xffff0000, v8
    v_mul_f32 v9, v9, v132
    v_mul_f32 v8, v8, v133
    v_cvt_pk_bf16_f32 v8, v9, v8
    v_lshlrev_b32 v9, 16, v8
    v_and_b32 v8, 0xffff0000, v8
    v_lshlrev_b32 v10, 16, v76
    v_and_b32 v11, 0xffff0000, v76
    v_add_f32 v9, v9, v10
    v_add_f32 v8, v8, v11
    v_cvt_pk_bf16_f32 v76, v9, v8
    v_lshlrev_b32 v56, 16, v76
    v_and_b32 v57, 0xffff0000, v76
    v_cvt_pk_bf16_f32 v8, v58, v59
    v_lshlrev_b32 v9, 16, v8
    v_and_b32 v8, 0xffff0000, v8
    v_mul_f32 v9, v9, v134
    v_mul_f32 v8, v8, v135
    v_cvt_pk_bf16_f32 v8, v9, v8
    v_lshlrev_b32 v9, 16, v8
    v_and_b32 v8, 0xffff0000, v8
    v_lshlrev_b32 v10, 16, v77
    v_and_b32 v11, 0xffff0000, v77
    v_add_f32 v9, v9, v10
    v_add_f32 v8, v8, v11
    v_cvt_pk_bf16_f32 v77, v9, v8
    v_lshlrev_b32 v58, 16, v77
    v_and_b32 v59, 0xffff0000, v77
    buffer_store_dwordx2 v[60:61], v5, s[32:35], 0 offen offset:0
    buffer_store_dwordx2 v[62:63], v5, s[32:35], 0 offen offset:32
    buffer_store_dwordx2 v[64:65], v5, s[32:35], 0 offen offset:64
    buffer_store_dwordx2 v[66:67], v5, s[32:35], 0 offen offset:96
    buffer_store_dwordx2 v[68:69], v5, s[32:35], 0 offen offset:128
    buffer_store_dwordx2 v[70:71], v5, s[32:35], 0 offen offset:160
    buffer_store_dwordx2 v[72:73], v5, s[32:35], 0 offen offset:192
    buffer_store_dwordx2 v[74:75], v5, s[32:35], 0 offen offset:224
    buffer_store_dwordx2 v[76:77], v5, s[32:35], 0 offen offset:256
    v_xor_b32 v13, 16, v1
    v_lshlrev_b32 v13, 2, v13
    v_xor_b32 v14, 32, v1
    v_lshlrev_b32 v14, 2, v14
    s_lshl_b32 s48, s3, 6
    v_lshlrev_b32 v15, 2, v3
    v_add_u32 v15, 89600, v15
    v_add_u32 v16, s48, v15
    v_mov_b32 v12, 0
    v_add_f32 v12, v12, v24
    v_add_f32 v12, v12, v25
    v_add_f32 v12, v12, v26
    v_add_f32 v12, v12, v27
    v_add_f32 v12, v12, v28
    v_add_f32 v12, v12, v29
    v_add_f32 v12, v12, v30
    v_add_f32 v12, v12, v31
    v_add_f32 v12, v12, v32
    v_add_f32 v12, v12, v33
    v_add_f32 v12, v12, v34
    v_add_f32 v12, v12, v35
    v_add_f32 v12, v12, v36
    v_add_f32 v12, v12, v37
    v_add_f32 v12, v12, v38
    v_add_f32 v12, v12, v39
    v_add_f32 v12, v12, v40
    v_add_f32 v12, v12, v41
    v_add_f32 v12, v12, v42
    v_add_f32 v12, v12, v43
    v_add_f32 v12, v12, v44
    v_add_f32 v12, v12, v45
    v_add_f32 v12, v12, v46
    v_add_f32 v12, v12, v47
    v_add_f32 v12, v12, v48
    v_add_f32 v12, v12, v49
    v_add_f32 v12, v12, v50
    v_add_f32 v12, v12, v51
    v_add_f32 v12, v12, v52
    v_add_f32 v12, v12, v53
    v_add_f32 v12, v12, v54
    v_add_f32 v12, v12, v55
    v_add_f32 v12, v12, v56
    v_add_f32 v12, v12, v57
    v_add_f32 v12, v12, v58
    v_add_f32 v12, v12, v59
    ds_bpermute_b32 v17, v13, v12
    s_waitcnt lgkmcnt(0)
    v_add_f32 v12, v12, v17
    ds_bpermute_b32 v17, v14, v12
    s_waitcnt lgkmcnt(0)
    v_add_f32 v12, v12, v17
    ds_write_b32 v16, v12 offset:0
    s_waitcnt lgkmcnt(0)
    s_barrier
    ds_read_b32 v18, v15 offset:0
    ds_read_b32 v19, v15 offset:64
    ds_read_b32 v20, v15 offset:128
    ds_read_b32 v21, v15 offset:192
    s_waitcnt lgkmcnt(0)
    v_add_f32 v12, v18, v19
    v_add_f32 v17, v20, v21
    v_add_f32 v12, v12, v17
    s_mov_b32 s49, 0x3ae38e39
    v_mul_f32 v22, s49, v12
    v_mov_b32 v12, 0
    v_sub_f32 v8, v24, v22
    v_fmac_f32 v12, v8, v8
    v_sub_f32 v8, v25, v22
    v_fmac_f32 v12, v8, v8
    v_sub_f32 v8, v26, v22
    v_fmac_f32 v12, v8, v8
    v_sub_f32 v8, v27, v22
    v_fmac_f32 v12, v8, v8
    v_sub_f32 v8, v28, v22
    v_fmac_f32 v12, v8, v8
    v_sub_f32 v8, v29, v22
    v_fmac_f32 v12, v8, v8
    v_sub_f32 v8, v30, v22
    v_fmac_f32 v12, v8, v8
    v_sub_f32 v8, v31, v22
    v_fmac_f32 v12, v8, v8
    v_sub_f32 v8, v32, v22
    v_fmac_f32 v12, v8, v8
    v_sub_f32 v8, v33, v22
    v_fmac_f32 v12, v8, v8
    v_sub_f32 v8, v34, v22
    v_fmac_f32 v12, v8, v8
    v_sub_f32 v8, v35, v22
    v_fmac_f32 v12, v8, v8
    v_sub_f32 v8, v36, v22
    v_fmac_f32 v12, v8, v8
    v_sub_f32 v8, v37, v22
    v_fmac_f32 v12, v8, v8
    v_sub_f32 v8, v38, v22
    v_fmac_f32 v12, v8, v8
    v_sub_f32 v8, v39, v22
    v_fmac_f32 v12, v8, v8
    v_sub_f32 v8, v40, v22
    v_fmac_f32 v12, v8, v8
    v_sub_f32 v8, v41, v22
    v_fmac_f32 v12, v8, v8
    v_sub_f32 v8, v42, v22
    v_fmac_f32 v12, v8, v8
    v_sub_f32 v8, v43, v22
    v_fmac_f32 v12, v8, v8
    v_sub_f32 v8, v44, v22
    v_fmac_f32 v12, v8, v8
    v_sub_f32 v8, v45, v22
    v_fmac_f32 v12, v8, v8
    v_sub_f32 v8, v46, v22
    v_fmac_f32 v12, v8, v8
    v_sub_f32 v8, v47, v22
    v_fmac_f32 v12, v8, v8
    v_sub_f32 v8, v48, v22
    v_fmac_f32 v12, v8, v8
    v_sub_f32 v8, v49, v22
    v_fmac_f32 v12, v8, v8
    v_sub_f32 v8, v50, v22
    v_fmac_f32 v12, v8, v8
    v_sub_f32 v8, v51, v22
    v_fmac_f32 v12, v8, v8
    v_sub_f32 v8, v52, v22
    v_fmac_f32 v12, v8, v8
    v_sub_f32 v8, v53, v22
    v_fmac_f32 v12, v8, v8
    v_sub_f32 v8, v54, v22
    v_fmac_f32 v12, v8, v8
    v_sub_f32 v8, v55, v22
    v_fmac_f32 v12, v8, v8
    v_sub_f32 v8, v56, v22
    v_fmac_f32 v12, v8, v8
    v_sub_f32 v8, v57, v22
    v_fmac_f32 v12, v8, v8
    v_sub_f32 v8, v58, v22
    v_fmac_f32 v12, v8, v8
    v_sub_f32 v8, v59, v22
    v_fmac_f32 v12, v8, v8
    ds_bpermute_b32 v17, v13, v12
    s_waitcnt lgkmcnt(0)
    v_add_f32 v12, v12, v17
    ds_bpermute_b32 v17, v14, v12
    s_waitcnt lgkmcnt(0)
    v_add_f32 v12, v12, v17
    ds_write_b32 v16, v12 offset:256
    s_waitcnt lgkmcnt(0)
    s_barrier
    ds_read_b32 v18, v15 offset:256
    ds_read_b32 v19, v15 offset:320
    ds_read_b32 v20, v15 offset:384
    ds_read_b32 v21, v15 offset:448
    s_waitcnt lgkmcnt(0)
    v_add_f32 v12, v18, v19
    v_add_f32 v17, v20, v21
    v_add_f32 v12, v12, v17
    v_mul_f32 v23, s49, v12
    v_cvt_pk_bf16_f32 v22, v22, v22
    v_and_b32 v22, 0xffff0000, v22
    v_cvt_pk_bf16_f32 v23, v23, v23
    v_and_b32 v23, 0xffff0000, v23
    v_add_f32 v23, 0x3727c5ac, v23
    v_cvt_pk_bf16_f32 v23, v23, v23
    v_and_b32 v23, 0xffff0000, v23
    v_sqrt_f32 v23, v23
    s_nop 0
    v_cvt_pk_bf16_f32 v23, v23, v23
    v_and_b32 v23, 0xffff0000, v23
    v_rcp_f32 v23, v23
    s_lshr_b32 s48, s40, 5
    s_mul_i32 s48, s48, 36864
    s_add_u32 s48, s48, s47
    s_and_b32 s49, s40, 16
    s_lshl_b32 s49, s49, 4
    s_add_u32 s48, s48, s49
    v_lshrrev_b32 v12, 1, v4
    v_lshlrev_b32 v12, 9, v12
    v_lshl_add_u32 v12, v3, 4, v12
    v_and_b32 v13, 1, v4
    v_lshl_add_u32 v12, v13, 3, v12
    v_add_u32 v12, s48, v12
    v_sub_f32 v8, v24, v22
    v_sub_f32 v9, v25, v22
    v_cvt_pk_bf16_f32 v8, v8, v9
    v_and_b32 v9, 0xffff0000, v8
    v_lshlrev_b32 v8, 16, v8
    v_mul_f32 v8, v8, v23
    v_mul_f32 v9, v9, v23
    v_cvt_pk_bf16_f32 v8, v8, v9
    v_and_b32 v9, 0xffff0000, v8
    v_lshlrev_b32 v8, 16, v8
    v_mul_f32 v8, v8, v176
    v_mul_f32 v9, v9, v177
    v_cvt_pk_bf16_f32 v8, v8, v9
    v_and_b32 v9, 0xffff0000, v8
    v_lshlrev_b32 v8, 16, v8
    v_add_f32 v8, v8, v140
    v_add_f32 v9, v9, v141
    v_cvt_pk_bf16_f32 v78, v8, v9
    v_sub_f32 v8, v26, v22
    v_sub_f32 v9, v27, v22
    v_cvt_pk_bf16_f32 v8, v8, v9
    v_and_b32 v9, 0xffff0000, v8
    v_lshlrev_b32 v8, 16, v8
    v_mul_f32 v8, v8, v23
    v_mul_f32 v9, v9, v23
    v_cvt_pk_bf16_f32 v8, v8, v9
    v_and_b32 v9, 0xffff0000, v8
    v_lshlrev_b32 v8, 16, v8
    v_mul_f32 v8, v8, v178
    v_mul_f32 v9, v9, v179
    v_cvt_pk_bf16_f32 v8, v8, v9
    v_and_b32 v9, 0xffff0000, v8
    v_lshlrev_b32 v8, 16, v8
    v_add_f32 v8, v8, v142
    v_add_f32 v9, v9, v143
    v_cvt_pk_bf16_f32 v79, v8, v9
    s_mov_b32 s48, 0
    buffer_store_dwordx2 v[78:79], v12, s[36:39], s48 offen
    v_sub_f32 v8, v28, v22
    v_sub_f32 v9, v29, v22
    v_cvt_pk_bf16_f32 v8, v8, v9
    v_and_b32 v9, 0xffff0000, v8
    v_lshlrev_b32 v8, 16, v8
    v_mul_f32 v8, v8, v23
    v_mul_f32 v9, v9, v23
    v_cvt_pk_bf16_f32 v8, v8, v9
    v_and_b32 v9, 0xffff0000, v8
    v_lshlrev_b32 v8, 16, v8
    v_mul_f32 v8, v8, v180
    v_mul_f32 v9, v9, v181
    v_cvt_pk_bf16_f32 v8, v8, v9
    v_and_b32 v9, 0xffff0000, v8
    v_lshlrev_b32 v8, 16, v8
    v_add_f32 v8, v8, v144
    v_add_f32 v9, v9, v145
    v_cvt_pk_bf16_f32 v80, v8, v9
    v_sub_f32 v8, v30, v22
    v_sub_f32 v9, v31, v22
    v_cvt_pk_bf16_f32 v8, v8, v9
    v_and_b32 v9, 0xffff0000, v8
    v_lshlrev_b32 v8, 16, v8
    v_mul_f32 v8, v8, v23
    v_mul_f32 v9, v9, v23
    v_cvt_pk_bf16_f32 v8, v8, v9
    v_and_b32 v9, 0xffff0000, v8
    v_lshlrev_b32 v8, 16, v8
    v_mul_f32 v8, v8, v182
    v_mul_f32 v9, v9, v183
    v_cvt_pk_bf16_f32 v8, v8, v9
    v_and_b32 v9, 0xffff0000, v8
    v_lshlrev_b32 v8, 16, v8
    v_add_f32 v8, v8, v146
    v_add_f32 v9, v9, v147
    v_cvt_pk_bf16_f32 v81, v8, v9
    s_mov_b32 s48, 1024
    buffer_store_dwordx2 v[80:81], v12, s[36:39], s48 offen
    v_sub_f32 v8, v32, v22
    v_sub_f32 v9, v33, v22
    v_cvt_pk_bf16_f32 v8, v8, v9
    v_and_b32 v9, 0xffff0000, v8
    v_lshlrev_b32 v8, 16, v8
    v_mul_f32 v8, v8, v23
    v_mul_f32 v9, v9, v23
    v_cvt_pk_bf16_f32 v8, v8, v9
    v_and_b32 v9, 0xffff0000, v8
    v_lshlrev_b32 v8, 16, v8
    v_mul_f32 v8, v8, v184
    v_mul_f32 v9, v9, v185
    v_cvt_pk_bf16_f32 v8, v8, v9
    v_and_b32 v9, 0xffff0000, v8
    v_lshlrev_b32 v8, 16, v8
    v_add_f32 v8, v8, v148
    v_add_f32 v9, v9, v149
    v_cvt_pk_bf16_f32 v82, v8, v9
    v_sub_f32 v8, v34, v22
    v_sub_f32 v9, v35, v22
    v_cvt_pk_bf16_f32 v8, v8, v9
    v_and_b32 v9, 0xffff0000, v8
    v_lshlrev_b32 v8, 16, v8
    v_mul_f32 v8, v8, v23
    v_mul_f32 v9, v9, v23
    v_cvt_pk_bf16_f32 v8, v8, v9
    v_and_b32 v9, 0xffff0000, v8
    v_lshlrev_b32 v8, 16, v8
    v_mul_f32 v8, v8, v186
    v_mul_f32 v9, v9, v187
    v_cvt_pk_bf16_f32 v8, v8, v9
    v_and_b32 v9, 0xffff0000, v8
    v_lshlrev_b32 v8, 16, v8
    v_add_f32 v8, v8, v150
    v_add_f32 v9, v9, v151
    v_cvt_pk_bf16_f32 v83, v8, v9
    s_mov_b32 s48, 2048
    buffer_store_dwordx2 v[82:83], v12, s[36:39], s48 offen
    v_sub_f32 v8, v36, v22
    v_sub_f32 v9, v37, v22
    v_cvt_pk_bf16_f32 v8, v8, v9
    v_and_b32 v9, 0xffff0000, v8
    v_lshlrev_b32 v8, 16, v8
    v_mul_f32 v8, v8, v23
    v_mul_f32 v9, v9, v23
    v_cvt_pk_bf16_f32 v8, v8, v9
    v_and_b32 v9, 0xffff0000, v8
    v_lshlrev_b32 v8, 16, v8
    v_mul_f32 v8, v8, v188
    v_mul_f32 v9, v9, v189
    v_cvt_pk_bf16_f32 v8, v8, v9
    v_and_b32 v9, 0xffff0000, v8
    v_lshlrev_b32 v8, 16, v8
    v_add_f32 v8, v8, v152
    v_add_f32 v9, v9, v153
    v_cvt_pk_bf16_f32 v84, v8, v9
    v_sub_f32 v8, v38, v22
    v_sub_f32 v9, v39, v22
    v_cvt_pk_bf16_f32 v8, v8, v9
    v_and_b32 v9, 0xffff0000, v8
    v_lshlrev_b32 v8, 16, v8
    v_mul_f32 v8, v8, v23
    v_mul_f32 v9, v9, v23
    v_cvt_pk_bf16_f32 v8, v8, v9
    v_and_b32 v9, 0xffff0000, v8
    v_lshlrev_b32 v8, 16, v8
    v_mul_f32 v8, v8, v190
    v_mul_f32 v9, v9, v191
    v_cvt_pk_bf16_f32 v8, v8, v9
    v_and_b32 v9, 0xffff0000, v8
    v_lshlrev_b32 v8, 16, v8
    v_add_f32 v8, v8, v154
    v_add_f32 v9, v9, v155
    v_cvt_pk_bf16_f32 v85, v8, v9
    s_mov_b32 s48, 3072
    buffer_store_dwordx2 v[84:85], v12, s[36:39], s48 offen
    v_sub_f32 v8, v40, v22
    v_sub_f32 v9, v41, v22
    v_cvt_pk_bf16_f32 v8, v8, v9
    v_and_b32 v9, 0xffff0000, v8
    v_lshlrev_b32 v8, 16, v8
    v_mul_f32 v8, v8, v23
    v_mul_f32 v9, v9, v23
    v_cvt_pk_bf16_f32 v8, v8, v9
    v_and_b32 v9, 0xffff0000, v8
    v_lshlrev_b32 v8, 16, v8
    v_mul_f32 v8, v8, v192
    v_mul_f32 v9, v9, v193
    v_cvt_pk_bf16_f32 v8, v8, v9
    v_and_b32 v9, 0xffff0000, v8
    v_lshlrev_b32 v8, 16, v8
    v_add_f32 v8, v8, v156
    v_add_f32 v9, v9, v157
    v_cvt_pk_bf16_f32 v86, v8, v9
    v_sub_f32 v8, v42, v22
    v_sub_f32 v9, v43, v22
    v_cvt_pk_bf16_f32 v8, v8, v9
    v_and_b32 v9, 0xffff0000, v8
    v_lshlrev_b32 v8, 16, v8
    v_mul_f32 v8, v8, v23
    v_mul_f32 v9, v9, v23
    v_cvt_pk_bf16_f32 v8, v8, v9
    v_and_b32 v9, 0xffff0000, v8
    v_lshlrev_b32 v8, 16, v8
    v_mul_f32 v8, v8, v194
    v_mul_f32 v9, v9, v195
    v_cvt_pk_bf16_f32 v8, v8, v9
    v_and_b32 v9, 0xffff0000, v8
    v_lshlrev_b32 v8, 16, v8
    v_add_f32 v8, v8, v158
    v_add_f32 v9, v9, v159
    v_cvt_pk_bf16_f32 v87, v8, v9
    s_mov_b32 s48, 4096
    buffer_store_dwordx2 v[86:87], v12, s[36:39], s48 offen
    v_sub_f32 v8, v44, v22
    v_sub_f32 v9, v45, v22
    v_cvt_pk_bf16_f32 v8, v8, v9
    v_and_b32 v9, 0xffff0000, v8
    v_lshlrev_b32 v8, 16, v8
    v_mul_f32 v8, v8, v23
    v_mul_f32 v9, v9, v23
    v_cvt_pk_bf16_f32 v8, v8, v9
    v_and_b32 v9, 0xffff0000, v8
    v_lshlrev_b32 v8, 16, v8
    v_mul_f32 v8, v8, v196
    v_mul_f32 v9, v9, v197
    v_cvt_pk_bf16_f32 v8, v8, v9
    v_and_b32 v9, 0xffff0000, v8
    v_lshlrev_b32 v8, 16, v8
    v_add_f32 v8, v8, v160
    v_add_f32 v9, v9, v161
    v_cvt_pk_bf16_f32 v88, v8, v9
    v_sub_f32 v8, v46, v22
    v_sub_f32 v9, v47, v22
    v_cvt_pk_bf16_f32 v8, v8, v9
    v_and_b32 v9, 0xffff0000, v8
    v_lshlrev_b32 v8, 16, v8
    v_mul_f32 v8, v8, v23
    v_mul_f32 v9, v9, v23
    v_cvt_pk_bf16_f32 v8, v8, v9
    v_and_b32 v9, 0xffff0000, v8
    v_lshlrev_b32 v8, 16, v8
    v_mul_f32 v8, v8, v198
    v_mul_f32 v9, v9, v199
    v_cvt_pk_bf16_f32 v8, v8, v9
    v_and_b32 v9, 0xffff0000, v8
    v_lshlrev_b32 v8, 16, v8
    v_add_f32 v8, v8, v162
    v_add_f32 v9, v9, v163
    v_cvt_pk_bf16_f32 v89, v8, v9
    s_mov_b32 s48, 5120
    buffer_store_dwordx2 v[88:89], v12, s[36:39], s48 offen
    v_sub_f32 v8, v48, v22
    v_sub_f32 v9, v49, v22
    v_cvt_pk_bf16_f32 v8, v8, v9
    v_and_b32 v9, 0xffff0000, v8
    v_lshlrev_b32 v8, 16, v8
    v_mul_f32 v8, v8, v23
    v_mul_f32 v9, v9, v23
    v_cvt_pk_bf16_f32 v8, v8, v9
    v_and_b32 v9, 0xffff0000, v8
    v_lshlrev_b32 v8, 16, v8
    v_mul_f32 v8, v8, v200
    v_mul_f32 v9, v9, v201
    v_cvt_pk_bf16_f32 v8, v8, v9
    v_and_b32 v9, 0xffff0000, v8
    v_lshlrev_b32 v8, 16, v8
    v_add_f32 v8, v8, v164
    v_add_f32 v9, v9, v165
    v_cvt_pk_bf16_f32 v90, v8, v9
    v_sub_f32 v8, v50, v22
    v_sub_f32 v9, v51, v22
    v_cvt_pk_bf16_f32 v8, v8, v9
    v_and_b32 v9, 0xffff0000, v8
    v_lshlrev_b32 v8, 16, v8
    v_mul_f32 v8, v8, v23
    v_mul_f32 v9, v9, v23
    v_cvt_pk_bf16_f32 v8, v8, v9
    v_and_b32 v9, 0xffff0000, v8
    v_lshlrev_b32 v8, 16, v8
    v_mul_f32 v8, v8, v202
    v_mul_f32 v9, v9, v203
    v_cvt_pk_bf16_f32 v8, v8, v9
    v_and_b32 v9, 0xffff0000, v8
    v_lshlrev_b32 v8, 16, v8
    v_add_f32 v8, v8, v166
    v_add_f32 v9, v9, v167
    v_cvt_pk_bf16_f32 v91, v8, v9
    s_mov_b32 s48, 6144
    buffer_store_dwordx2 v[90:91], v12, s[36:39], s48 offen
    v_sub_f32 v8, v52, v22
    v_sub_f32 v9, v53, v22
    v_cvt_pk_bf16_f32 v8, v8, v9
    v_and_b32 v9, 0xffff0000, v8
    v_lshlrev_b32 v8, 16, v8
    v_mul_f32 v8, v8, v23
    v_mul_f32 v9, v9, v23
    v_cvt_pk_bf16_f32 v8, v8, v9
    v_and_b32 v9, 0xffff0000, v8
    v_lshlrev_b32 v8, 16, v8
    v_mul_f32 v8, v8, v204
    v_mul_f32 v9, v9, v205
    v_cvt_pk_bf16_f32 v8, v8, v9
    v_and_b32 v9, 0xffff0000, v8
    v_lshlrev_b32 v8, 16, v8
    v_add_f32 v8, v8, v168
    v_add_f32 v9, v9, v169
    v_cvt_pk_bf16_f32 v92, v8, v9
    v_sub_f32 v8, v54, v22
    v_sub_f32 v9, v55, v22
    v_cvt_pk_bf16_f32 v8, v8, v9
    v_and_b32 v9, 0xffff0000, v8
    v_lshlrev_b32 v8, 16, v8
    v_mul_f32 v8, v8, v23
    v_mul_f32 v9, v9, v23
    v_cvt_pk_bf16_f32 v8, v8, v9
    v_and_b32 v9, 0xffff0000, v8
    v_lshlrev_b32 v8, 16, v8
    v_mul_f32 v8, v8, v206
    v_mul_f32 v9, v9, v207
    v_cvt_pk_bf16_f32 v8, v8, v9
    v_and_b32 v9, 0xffff0000, v8
    v_lshlrev_b32 v8, 16, v8
    v_add_f32 v8, v8, v170
    v_add_f32 v9, v9, v171
    v_cvt_pk_bf16_f32 v93, v8, v9
    s_mov_b32 s48, 7168
    buffer_store_dwordx2 v[92:93], v12, s[36:39], s48 offen
    v_sub_f32 v8, v56, v22
    v_sub_f32 v9, v57, v22
    v_cvt_pk_bf16_f32 v8, v8, v9
    v_and_b32 v9, 0xffff0000, v8
    v_lshlrev_b32 v8, 16, v8
    v_mul_f32 v8, v8, v23
    v_mul_f32 v9, v9, v23
    v_cvt_pk_bf16_f32 v8, v8, v9
    v_and_b32 v9, 0xffff0000, v8
    v_lshlrev_b32 v8, 16, v8
    v_mul_f32 v8, v8, v208
    v_mul_f32 v9, v9, v209
    v_cvt_pk_bf16_f32 v8, v8, v9
    v_and_b32 v9, 0xffff0000, v8
    v_lshlrev_b32 v8, 16, v8
    v_add_f32 v8, v8, v172
    v_add_f32 v9, v9, v173
    v_cvt_pk_bf16_f32 v94, v8, v9
    v_sub_f32 v8, v58, v22
    v_sub_f32 v9, v59, v22
    v_cvt_pk_bf16_f32 v8, v8, v9
    v_and_b32 v9, 0xffff0000, v8
    v_lshlrev_b32 v8, 16, v8
    v_mul_f32 v8, v8, v23
    v_mul_f32 v9, v9, v23
    v_cvt_pk_bf16_f32 v8, v8, v9
    v_and_b32 v9, 0xffff0000, v8
    v_lshlrev_b32 v8, 16, v8
    v_mul_f32 v8, v8, v210
    v_mul_f32 v9, v9, v211
    v_cvt_pk_bf16_f32 v8, v8, v9
    v_and_b32 v9, 0xffff0000, v8
    v_lshlrev_b32 v8, 16, v8
    v_add_f32 v8, v8, v174
    v_add_f32 v9, v9, v175
    v_cvt_pk_bf16_f32 v95, v8, v9
    s_mov_b32 s48, 8192
    buffer_store_dwordx2 v[94:95], v12, s[36:39], s48 offen
    s_endpgm
K2_COPY:
    s_sub_u32 s3, s2, 128
    s_load_dwordx2 s[4:5], s[0:1], 96
    s_load_dwordx2 s[8:9], s[0:1], 40
    s_load_dwordx2 s[10:11], s[0:1], 48
    s_load_dwordx2 s[12:13], s[0:1], 56
    s_lshl_b32 s30, s3, 2
    s_add_u32 s31, s30, 4
    s_min_u32 s31, s31, 486
    s_waitcnt lgkmcnt(0)
CPB_LOOP:
    s_cmp_ge_u32 s30, s31
    s_cbranch_scc1 CPB_END
    s_mov_b32 s3, s30
    s_add_u32 s30, s30, 1
    s_cmp_ge_u32 s3, 324
    s_cbranch_scc1 CPB_C4
    s_cmp_ge_u32 s3, 162
    s_cselect_b32 s28, s10, s8
    s_cselect_b32 s29, s11, s9
    s_cselect_b32 s27, 162, 0
    s_mov_b32 s16, s28
    s_and_b32 s17, s29, 0xffff
    s_mov_b32 s18, 5308416
    s_mov_b32 s19, 0x00020000
    s_add_u32 s20, s4, 52559872
    s_addc_u32 s21, s5, 0
    s_and_b32 s21, s21, 0xffff
    s_mov_b32 s22, 10616832
    s_mov_b32 s23, 0x00020000
    s_lshl_b32 s24, s3, 11
    v_add_u32 v2, s24, v0
    s_lshl_b32 s27, s27, 11
    s_mov_b32 s24, 1242757
    s_mov_b32 s25, 715827883
    v_add_u32 v3, 0, v2
    v_subrev_u32 v4, s27, v3
    v_mul_hi_u32 v5, v4, s24
    v_mul_u32_u24 v6, 3456, v5
    v_sub_u32 v6, v4, v6
    v_mul_hi_u32 v7, v6, s25
    v_mul_u32_u24 v8, 6, v7
    v_sub_u32 v8, v6, v8
    v_mul_u32_u24 v7, 9216, v7
    v_mul_u32_u24 v5, 96, v5
    v_lshl_add_u32 v7, v8, 4, v7
    v_add_u32 v4, v7, v5
    buffer_load_dwordx4 v[16:19], v4, s[16:19], 0 offen
    v_add_u32 v3, 256, v2
    v_subrev_u32 v4, s27, v3
    v_mul_hi_u32 v5, v4, s24
    v_mul_u32_u24 v6, 3456, v5
    v_sub_u32 v6, v4, v6
    v_mul_hi_u32 v7, v6, s25
    v_mul_u32_u24 v8, 6, v7
    v_sub_u32 v8, v6, v8
    v_mul_u32_u24 v7, 9216, v7
    v_mul_u32_u24 v5, 96, v5
    v_lshl_add_u32 v7, v8, 4, v7
    v_add_u32 v4, v7, v5
    buffer_load_dwordx4 v[20:23], v4, s[16:19], 0 offen
    v_add_u32 v3, 512, v2
    v_subrev_u32 v4, s27, v3
    v_mul_hi_u32 v5, v4, s24
    v_mul_u32_u24 v6, 3456, v5
    v_sub_u32 v6, v4, v6
    v_mul_hi_u32 v7, v6, s25
    v_mul_u32_u24 v8, 6, v7
    v_sub_u32 v8, v6, v8
    v_mul_u32_u24 v7, 9216, v7
    v_mul_u32_u24 v5, 96, v5
    v_lshl_add_u32 v7, v8, 4, v7
    v_add_u32 v4, v7, v5
    buffer_load_dwordx4 v[24:27], v4, s[16:19], 0 offen
    v_add_u32 v3, 768, v2
    v_subrev_u32 v4, s27, v3
    v_mul_hi_u32 v5, v4, s24
    v_mul_u32_u24 v6, 3456, v5
    v_sub_u32 v6, v4, v6
    v_mul_hi_u32 v7, v6, s25
    v_mul_u32_u24 v8, 6, v7
    v_sub_u32 v8, v6, v8
    v_mul_u32_u24 v7, 9216, v7
    v_mul_u32_u24 v5, 96, v5
    v_lshl_add_u32 v7, v8, 4, v7
    v_add_u32 v4, v7, v5
    buffer_load_dwordx4 v[28:31], v4, s[16:19], 0 offen
    v_add_u32 v3, 1024, v2
    v_subrev_u32 v4, s27, v3
    v_mul_hi_u32 v5, v4, s24
    v_mul_u32_u24 v6, 3456, v5
    v_sub_u32 v6, v4, v6
    v_mul_hi_u32 v7, v6, s25
    v_mul_u32_u24 v8, 6, v7
    v_sub_u32 v8, v6, v8
    v_mul_u32_u24 v7, 9216, v7
    v_mul_u32_u24 v5, 96, v5
    v_lshl_add_u32 v7, v8, 4, v7
    v_add_u32 v4, v7, v5
    buffer_load_dwordx4 v[32:35], v4, s[16:19], 0 offen
    v_add_u32 v3, 1280, v2
    v_subrev_u32 v4, s27, v3
    v_mul_hi_u32 v5, v4, s24
    v_mul_u32_u24 v6, 3456, v5
    v_sub_u32 v6, v4, v6
    v_mul_hi_u32 v7, v6, s25
    v_mul_u32_u24 v8, 6, v7
    v_sub_u32 v8, v6, v8
    v_mul_u32_u24 v7, 9216, v7
    v_mul_u32_u24 v5, 96, v5
    v_lshl_add_u32 v7, v8, 4, v7
    v_add_u32 v4, v7, v5
    buffer_load_dwordx4 v[36:39], v4, s[16:19], 0 offen
    v_add_u32 v3, 1536, v2
    v_subrev_u32 v4, s27, v3
    v_mul_hi_u32 v5, v4, s24
    v_mul_u32_u24 v6, 3456, v5
    v_sub_u32 v6, v4, v6
    v_mul_hi_u32 v7, v6, s25
    v_mul_u32_u24 v8, 6, v7
    v_sub_u32 v8, v6, v8
    v_mul_u32_u24 v7, 9216, v7
    v_mul_u32_u24 v5, 96, v5
    v_lshl_add_u32 v7, v8, 4, v7
    v_add_u32 v4, v7, v5
    buffer_load_dwordx4 v[40:43], v4, s[16:19], 0 offen
    v_add_u32 v3, 1792, v2
    v_subrev_u32 v4, s27, v3
    v_mul_hi_u32 v5, v4, s24
    v_mul_u32_u24 v6, 3456, v5
    v_sub_u32 v6, v4, v6
    v_mul_hi_u32 v7, v6, s25
    v_mul_u32_u24 v8, 6, v7
    v_sub_u32 v8, v6, v8
    v_mul_u32_u24 v7, 9216, v7
    v_mul_u32_u24 v5, 96, v5
    v_lshl_add_u32 v7, v8, 4, v7
    v_add_u32 v4, v7, v5
    buffer_load_dwordx4 v[44:47], v4, s[16:19], 0 offen
    v_lshlrev_b32 v2, 4, v2
    s_waitcnt vmcnt(0)
    s_mov_b32 s26, 0
    buffer_store_dwordx4 v[16:19], v2, s[20:23], s26 offen
    s_mov_b32 s26, 4096
    buffer_store_dwordx4 v[20:23], v2, s[20:23], s26 offen
    s_mov_b32 s26, 8192
    buffer_store_dwordx4 v[24:27], v2, s[20:23], s26 offen
    s_mov_b32 s26, 12288
    buffer_store_dwordx4 v[28:31], v2, s[20:23], s26 offen
    s_mov_b32 s26, 16384
    buffer_store_dwordx4 v[32:35], v2, s[20:23], s26 offen
    s_mov_b32 s26, 20480
    buffer_store_dwordx4 v[36:39], v2, s[20:23], s26 offen
    s_mov_b32 s26, 24576
    buffer_store_dwordx4 v[40:43], v2, s[20:23], s26 offen
    s_mov_b32 s26, 28672
    buffer_store_dwordx4 v[44:47], v2, s[20:23], s26 offen
    s_branch CPB_LOOP
CPB_C4:
    s_sub_u32 s3, s3, 324
    s_mov_b32 s16, s12
    s_and_b32 s17, s13, 0xffff
    s_mov_b32 s18, 5308416
    s_mov_b32 s19, 0x00020000
    s_add_u32 s20, s4, 63176704
    s_addc_u32 s21, s5, 0
    s_and_b32 s21, s21, 0xffff
    s_mov_b32 s22, 5308416
    s_mov_b32 s23, 0x00020000
    s_lshl_b32 s24, s3, 11
    v_add_u32 v2, s24, v0
    s_mov_b32 s24, 828505
    s_mov_b32 s25, 238609295
    s_mov_b32 s27, 82944
    v_add_u32 v3, 0, v2
    v_lshrrev_b32 v5, 4, v3
    v_mul_hi_u32 v5, v5, s24
    v_mul_lo_u32 v6, v5, s27
    v_sub_u32 v6, v3, v6
    v_mul_hi_u32 v7, v6, s25
    v_mul_u32_u24 v8, 18, v7
    v_sub_u32 v8, v6, v8
    v_add_u32 v9, 10, v8
    v_subrev_u32 v10, 18, v9
    v_cmp_gt_u32 vcc, 18, v9
    s_nop 1
    v_cndmask_b32 v9, v10, v9, vcc
    v_and_b32 v10, 8, v7
    v_cmp_eq_u32 vcc, 0, v10
    s_nop 1
    v_cndmask_b32 v8, v9, v8, vcc
    v_mul_u32_u24 v7, 1152, v7
    v_mul_u32_u24 v5, 288, v5
    v_lshl_add_u32 v7, v8, 4, v7
    v_add_u32 v4, v7, v5
    buffer_load_dwordx4 v[16:19], v4, s[16:19], 0 offen
    v_add_u32 v3, 256, v2
    v_lshrrev_b32 v5, 4, v3
    v_mul_hi_u32 v5, v5, s24
    v_mul_lo_u32 v6, v5, s27
    v_sub_u32 v6, v3, v6
    v_mul_hi_u32 v7, v6, s25
    v_mul_u32_u24 v8, 18, v7
    v_sub_u32 v8, v6, v8
    v_add_u32 v9, 10, v8
    v_subrev_u32 v10, 18, v9
    v_cmp_gt_u32 vcc, 18, v9
    s_nop 1
    v_cndmask_b32 v9, v10, v9, vcc
    v_and_b32 v10, 8, v7
    v_cmp_eq_u32 vcc, 0, v10
    s_nop 1
    v_cndmask_b32 v8, v9, v8, vcc
    v_mul_u32_u24 v7, 1152, v7
    v_mul_u32_u24 v5, 288, v5
    v_lshl_add_u32 v7, v8, 4, v7
    v_add_u32 v4, v7, v5
    buffer_load_dwordx4 v[20:23], v4, s[16:19], 0 offen
    v_add_u32 v3, 512, v2
    v_lshrrev_b32 v5, 4, v3
    v_mul_hi_u32 v5, v5, s24
    v_mul_lo_u32 v6, v5, s27
    v_sub_u32 v6, v3, v6
    v_mul_hi_u32 v7, v6, s25
    v_mul_u32_u24 v8, 18, v7
    v_sub_u32 v8, v6, v8
    v_add_u32 v9, 10, v8
    v_subrev_u32 v10, 18, v9
    v_cmp_gt_u32 vcc, 18, v9
    s_nop 1
    v_cndmask_b32 v9, v10, v9, vcc
    v_and_b32 v10, 8, v7
    v_cmp_eq_u32 vcc, 0, v10
    s_nop 1
    v_cndmask_b32 v8, v9, v8, vcc
    v_mul_u32_u24 v7, 1152, v7
    v_mul_u32_u24 v5, 288, v5
    v_lshl_add_u32 v7, v8, 4, v7
    v_add_u32 v4, v7, v5
    buffer_load_dwordx4 v[24:27], v4, s[16:19], 0 offen
    v_add_u32 v3, 768, v2
    v_lshrrev_b32 v5, 4, v3
    v_mul_hi_u32 v5, v5, s24
    v_mul_lo_u32 v6, v5, s27
    v_sub_u32 v6, v3, v6
    v_mul_hi_u32 v7, v6, s25
    v_mul_u32_u24 v8, 18, v7
    v_sub_u32 v8, v6, v8
    v_add_u32 v9, 10, v8
    v_subrev_u32 v10, 18, v9
    v_cmp_gt_u32 vcc, 18, v9
    s_nop 1
    v_cndmask_b32 v9, v10, v9, vcc
    v_and_b32 v10, 8, v7
    v_cmp_eq_u32 vcc, 0, v10
    s_nop 1
    v_cndmask_b32 v8, v9, v8, vcc
    v_mul_u32_u24 v7, 1152, v7
    v_mul_u32_u24 v5, 288, v5
    v_lshl_add_u32 v7, v8, 4, v7
    v_add_u32 v4, v7, v5
    buffer_load_dwordx4 v[28:31], v4, s[16:19], 0 offen
    v_add_u32 v3, 1024, v2
    v_lshrrev_b32 v5, 4, v3
    v_mul_hi_u32 v5, v5, s24
    v_mul_lo_u32 v6, v5, s27
    v_sub_u32 v6, v3, v6
    v_mul_hi_u32 v7, v6, s25
    v_mul_u32_u24 v8, 18, v7
    v_sub_u32 v8, v6, v8
    v_add_u32 v9, 10, v8
    v_subrev_u32 v10, 18, v9
    v_cmp_gt_u32 vcc, 18, v9
    s_nop 1
    v_cndmask_b32 v9, v10, v9, vcc
    v_and_b32 v10, 8, v7
    v_cmp_eq_u32 vcc, 0, v10
    s_nop 1
    v_cndmask_b32 v8, v9, v8, vcc
    v_mul_u32_u24 v7, 1152, v7
    v_mul_u32_u24 v5, 288, v5
    v_lshl_add_u32 v7, v8, 4, v7
    v_add_u32 v4, v7, v5
    buffer_load_dwordx4 v[32:35], v4, s[16:19], 0 offen
    v_add_u32 v3, 1280, v2
    v_lshrrev_b32 v5, 4, v3
    v_mul_hi_u32 v5, v5, s24
    v_mul_lo_u32 v6, v5, s27
    v_sub_u32 v6, v3, v6
    v_mul_hi_u32 v7, v6, s25
    v_mul_u32_u24 v8, 18, v7
    v_sub_u32 v8, v6, v8
    v_add_u32 v9, 10, v8
    v_subrev_u32 v10, 18, v9
    v_cmp_gt_u32 vcc, 18, v9
    s_nop 1
    v_cndmask_b32 v9, v10, v9, vcc
    v_and_b32 v10, 8, v7
    v_cmp_eq_u32 vcc, 0, v10
    s_nop 1
    v_cndmask_b32 v8, v9, v8, vcc
    v_mul_u32_u24 v7, 1152, v7
    v_mul_u32_u24 v5, 288, v5
    v_lshl_add_u32 v7, v8, 4, v7
    v_add_u32 v4, v7, v5
    buffer_load_dwordx4 v[36:39], v4, s[16:19], 0 offen
    v_add_u32 v3, 1536, v2
    v_lshrrev_b32 v5, 4, v3
    v_mul_hi_u32 v5, v5, s24
    v_mul_lo_u32 v6, v5, s27
    v_sub_u32 v6, v3, v6
    v_mul_hi_u32 v7, v6, s25
    v_mul_u32_u24 v8, 18, v7
    v_sub_u32 v8, v6, v8
    v_add_u32 v9, 10, v8
    v_subrev_u32 v10, 18, v9
    v_cmp_gt_u32 vcc, 18, v9
    s_nop 1
    v_cndmask_b32 v9, v10, v9, vcc
    v_and_b32 v10, 8, v7
    v_cmp_eq_u32 vcc, 0, v10
    s_nop 1
    v_cndmask_b32 v8, v9, v8, vcc
    v_mul_u32_u24 v7, 1152, v7
    v_mul_u32_u24 v5, 288, v5
    v_lshl_add_u32 v7, v8, 4, v7
    v_add_u32 v4, v7, v5
    buffer_load_dwordx4 v[40:43], v4, s[16:19], 0 offen
    v_add_u32 v3, 1792, v2
    v_lshrrev_b32 v5, 4, v3
    v_mul_hi_u32 v5, v5, s24
    v_mul_lo_u32 v6, v5, s27
    v_sub_u32 v6, v3, v6
    v_mul_hi_u32 v7, v6, s25
    v_mul_u32_u24 v8, 18, v7
    v_sub_u32 v8, v6, v8
    v_add_u32 v9, 10, v8
    v_subrev_u32 v10, 18, v9
    v_cmp_gt_u32 vcc, 18, v9
    s_nop 1
    v_cndmask_b32 v9, v10, v9, vcc
    v_and_b32 v10, 8, v7
    v_cmp_eq_u32 vcc, 0, v10
    s_nop 1
    v_cndmask_b32 v8, v9, v8, vcc
    v_mul_u32_u24 v7, 1152, v7
    v_mul_u32_u24 v5, 288, v5
    v_lshl_add_u32 v7, v8, 4, v7
    v_add_u32 v4, v7, v5
    buffer_load_dwordx4 v[44:47], v4, s[16:19], 0 offen
    v_lshlrev_b32 v2, 4, v2
    s_waitcnt vmcnt(0)
    s_mov_b32 s26, 0
    buffer_store_dwordx4 v[16:19], v2, s[20:23], s26 offen
    s_mov_b32 s26, 4096
    buffer_store_dwordx4 v[20:23], v2, s[20:23], s26 offen
    s_mov_b32 s26, 8192
    buffer_store_dwordx4 v[24:27], v2, s[20:23], s26 offen
    s_mov_b32 s26, 12288
    buffer_store_dwordx4 v[28:31], v2, s[20:23], s26 offen
    s_mov_b32 s26, 16384
    buffer_store_dwordx4 v[32:35], v2, s[20:23], s26 offen
    s_mov_b32 s26, 20480
    buffer_store_dwordx4 v[36:39], v2, s[20:23], s26 offen
    s_mov_b32 s26, 24576
    buffer_store_dwordx4 v[40:43], v2, s[20:23], s26 offen
    s_mov_b32 s26, 28672
    buffer_store_dwordx4 v[44:47], v2, s[20:23], s26 offen
    s_branch CPB_LOOP
CPB_END:
K2_END:
    s_endpgm
.globl k3_kernel
.p2align 8
.type k3_kernel,@function
k3_kernel:
    s_cmp_ge_u32 s2, 256
    s_cbranch_scc1 K3_END
    s_load_dwordx2 s[4:5], s[0:1], 96
    s_load_dwordx2 s[6:7], s[0:1], 40
    s_load_dwordx2 s[8:9], s[0:1], 48
    v_lshrrev_b32 v2, 6, v0
    v_and_b32 v1, 63, v0
    s_nop 0
    v_readfirstlane_b32 s3, v2
    s_and_b32 s41, s2, 31
    s_lshr_b32 s40, s2, 5
    s_waitcnt lgkmcnt(0)
    s_add_u32 s12, s4, 52559872
    s_addc_u32 s13, s5, 0
    s_and_b32 s13, s13, 0xffff
    s_mov_b32 s14, 10616832
    s_mov_b32 s15, 0x00020000
    s_add_u32 s16, s4, 10092544
    s_addc_u32 s17, s5, 0
    s_and_b32 s17, s17, 0xffff
    s_mov_b32 s18, 2359296
    s_mov_b32 s19, 0x00020000
    s_add_u32 s20, s4, 12451840
    s_addc_u32 s21, s5, 0
    s_and_b32 s21, s21, 0xffff
    s_mov_b32 s22, 18874368
    s_mov_b32 s23, 0x00020000
    s_lshl_b32 s42, s40, 8
    s_lshl_b32 s43, s3, 5
    s_add_u32 s42, s42, s43
    v_and_b32 v3, 31, v1
    v_lshrrev_b32 v4, 5, v1
    v_add_u32 v5, s42, v3
    s_lshr_b32 s43, s42, 5
    s_mul_i32 s43, s43, 36864
    v_lshlrev_b32 v6, 4, v1
    v_add_u32 v6, s43, v6
    s_and_b32 s44, s3, 3
    s_lshr_b32 s45, s3, 2
    s_mul_i32 s46, s45, 5308416
    s_mul_i32 s47, s41, 165888
    s_add_u32 s46, s46, s47
    s_mul_i32 s47, s44, 2304
    s_add_u32 s46, s46, s47
    v_lshlrev_b32 v244, 4, v1
    v_add_u32 v244, s46, v244
    s_mul_i32 s49, s44, 2304
    s_mul_i32 s50, s45, 9344
    s_add_u32 s49, s49, s50
    s_mov_b32 s51, 0
    s_add_u32 m0, s49, 0
    s_nop 0
    buffer_load_dwordx4 v244, s[12:15], s51 offen lds
    s_mov_b32 s51, 1024
    s_add_u32 m0, s49, 1024
    s_nop 0
    buffer_load_dwordx4 v244, s[12:15], s51 offen lds
    s_mov_b64 exec, 0xffff
    s_mov_b32 s51, 2048
    s_add_u32 m0, s49, 2048
    s_nop 0
    buffer_load_dwordx4 v244, s[12:15], s51 offen lds
    s_mov_b64 exec, -1
    s_mov_b32 s43, 0
    buffer_load_dwordx4 v[100:103], v6, s[16:19], s43 offen offset:0
    buffer_load_dwordx4 v[104:107], v6, s[16:19], s43 offen offset:1024
    buffer_load_dwordx4 v[108:111], v6, s[16:19], s43 offen offset:2048
    buffer_load_dwordx4 v[112:115], v6, s[16:19], s43 offen offset:3072
    s_mov_b32 s43, 4096
    buffer_load_dwordx4 v[116:119], v6, s[16:19], s43 offen offset:0
    buffer_load_dwordx4 v[120:123], v6, s[16:19], s43 offen offset:1024
    s_mov_b32 s51, 9216
    s_add_u32 m0, s49, 18688
    s_nop 0
    buffer_load_dwordx4 v244, s[12:15], s51 offen lds
    s_mov_b32 s51, 10240
    s_add_u32 m0, s49, 19712
    s_nop 0
    buffer_load_dwordx4 v244, s[12:15], s51 offen lds
    s_mov_b64 exec, 0xffff
    s_mov_b32 s51, 11264
    s_add_u32 m0, s49, 20736
    s_nop 0
    buffer_load_dwordx4 v244, s[12:15], s51 offen lds
    s_mov_b64 exec, -1
    s_mov_b32 s43, 6144
    buffer_load_dwordx4 v[124:127], v6, s[16:19], s43 offen offset:0
    buffer_load_dwordx4 v[128:131], v6, s[16:19], s43 offen offset:1024
    buffer_load_dwordx4 v[132:135], v6, s[16:19], s43 offen offset:2048
    buffer_load_dwordx4 v[136:139], v6, s[16:19], s43 offen offset:3072
    s_mov_b32 s43, 10240
    buffer_load_dwordx4 v[140:143], v6, s[16:19], s43 offen offset:0
    buffer_load_dwordx4 v[144:147], v6, s[16:19], s43 offen offset:1024
    v_lshrrev_b32 v8, 4, v1
    v_and_b32 v9, 1, v8
    v_mul_u32_u24 v9, 9344, v9
    v_lshrrev_b32 v8, 1, v8
    v_and_b32 v10, 15, v1
    v_lshrrev_b32 v10, 2, v10
    v_lshl_add_u32 v8, v8, 3, v10
    v_mul_u32_u24 v8, 96, v8
    v_and_b32 v10, 3, v1
    v_lshl_add_u32 v8, v10, 3, v8
    v_add_u32 v247, v8, v9
    v_mov_b32 v248, v247
    v_add_u32 v251, 74752, v247
    v_lshrrev_b32 v249, 4, v5
    s_mov_b32 s54, 147456
    v_mul_lo_u32 v249, v249, s54
    v_and_b32 v8, 15, v5
    v_lshl_add_u32 v249, v8, 4, v249
    v_lshl_add_u32 v249, v4, 8, v249
    s_mul_i32 s54, s41, 4608
    v_add_u32 v249, s54, v249
    s_mov_b32 s54, 2048
    s_mov_b32 s52, 0xc0135761
    s_mov_b32 s53, 0xbdd2d3e8
    v_mov_b32 v250, s52
    s_waitcnt vmcnt(15)
    s_barrier
    s_mov_b32 s51, 18432
    s_add_u32 m0, s49, 37376
    s_nop 0
    buffer_load_dwordx4 v244, s[12:15], s51 offen lds
    s_mov_b32 s51, 19456
    s_add_u32 m0, s49, 38400
    s_nop 0
    buffer_load_dwordx4 v244, s[12:15], s51 offen lds
    s_mov_b64 exec, 0xffff
    s_mov_b32 s51, 20480
    s_add_u32 m0, s49, 39424
    s_nop 0
    buffer_load_dwordx4 v244, s[12:15], s51 offen lds
    s_mov_b64 exec, -1
    s_mov_b32 s43, 12288
    buffer_load_dwordx4 v[148:151], v6, s[16:19], s43 offen offset:0
    buffer_load_dwordx4 v[152:155], v6, s[16:19], s43 offen offset:1024
    buffer_load_dwordx4 v[156:159], v6, s[16:19], s43 offen offset:2048
    buffer_load_dwordx4 v[160:163], v6, s[16:19], s43 offen offset:3072
    s_mov_b32 s43, 16384
    buffer_load_dwordx4 v[164:167], v6, s[16:19], s43 offen offset:0
    buffer_load_dwordx4 v[168:171], v6, s[16:19], s43 offen offset:1024
    s_mov_b32 s51, 27648
    s_add_u32 m0, s49, 56064
    s_nop 0
    buffer_load_dwordx4 v244, s[12:15], s51 offen lds
    s_mov_b32 s51, 28672
    s_add_u32 m0, s49, 57088
    s_nop 0
    buffer_load_dwordx4 v244, s[12:15], s51 offen lds
    s_mov_b64 exec, 0xffff
    s_mov_b32 s51, 29696
    s_add_u32 m0, s49, 58112
    s_nop 0
    buffer_load_dwordx4 v244, s[12:15], s51 offen lds
    s_mov_b64 exec, -1
    s_mov_b32 s43, 18432
    buffer_load_dwordx4 v[172:175], v6, s[16:19], s43 offen offset:0
    buffer_load_dwordx4 v[176:179], v6, s[16:19], s43 offen offset:1024
    buffer_load_dwordx4 v[180:183], v6, s[16:19], s43 offen offset:2048
    buffer_load_dwordx4 v[184:187], v6, s[16:19], s43 offen offset:3072
    s_mov_b32 s43, 22528
    buffer_load_dwordx4 v[188:191], v6, s[16:19], s43 offen offset:0
    buffer_load_dwordx4 v[192:195], v6, s[16:19], s43 offen offset:1024
    ds_read_b64_tr_b16 v[8:9], v248 offset:0
    ds_read_b64_tr_b16 v[10:11], v248 offset:384
    ds_read_b64_tr_b16 v[12:13], v248 offset:1536
    ds_read_b64_tr_b16 v[14:15], v248 offset:1920
    ds_read_b64_tr_b16 v[16:17], v248 offset:3072
    ds_read_b64_tr_b16 v[18:19], v248 offset:3456
    ds_read_b64_tr_b16 v[20:21], v248 offset:4608
    ds_read_b64_tr_b16 v[22:23], v248 offset:4992
    s_waitcnt vmcnt(27)
    s_waitcnt lgkmcnt(6)
    v_mfma_f32_32x32x16_bf16 v[24:39], v[8:11], v[100:103], 0
    ds_read_b64_tr_b16 v[8:9], v248 offset:6144
    ds_read_b64_tr_b16 v[10:11], v248 offset:6528
    s_waitcnt lgkmcnt(6)
    v_mfma_f32_32x32x16_bf16 v[24:39], v[12:15], v[104:107], v[24:39]
    ds_read_b64_tr_b16 v[12:13], v248 offset:7680
    ds_read_b64_tr_b16 v[14:15], v248 offset:8064
    s_waitcnt lgkmcnt(6)
    v_mfma_f32_32x32x16_bf16 v[24:39], v[16:19], v[108:111], v[24:39]
    s_waitcnt vmcnt(24)
    s_barrier
    s_mov_b32 s51, 36864
    s_add_u32 m0, s49, 74752
    s_nop 0
    buffer_load_dwordx4 v244, s[12:15], s51 offen lds
    s_mov_b32 s51, 37888
    s_add_u32 m0, s49, 75776
    s_nop 0
    buffer_load_dwordx4 v244, s[12:15], s51 offen lds
    s_mov_b64 exec, 0xffff
    s_mov_b32 s51, 38912
    s_add_u32 m0, s49, 76800
    s_nop 0
    buffer_load_dwordx4 v244, s[12:15], s51 offen lds
    s_mov_b64 exec, -1
    s_mov_b32 s43, 24576
    buffer_load_dwordx4 v[196:199], v6, s[16:19], s43 offen offset:0
    buffer_load_dwordx4 v[200:203], v6, s[16:19], s43 offen offset:1024
    buffer_load_dwordx4 v[204:207], v6, s[16:19], s43 offen offset:2048
    buffer_load_dwordx4 v[208:211], v6, s[16:19], s43 offen offset:3072
    s_mov_b32 s43, 28672
    buffer_load_dwordx4 v[212:215], v6, s[16:19], s43 offen offset:0
    buffer_load_dwordx4 v[216:219], v6, s[16:19], s43 offen offset:1024
    ds_read_b64_tr_b16 v[16:17], v248 offset:18688
    ds_read_b64_tr_b16 v[18:19], v248 offset:19072
    s_waitcnt lgkmcnt(6)
    v_mfma_f32_32x32x16_bf16 v[24:39], v[20:23], v[112:115], v[24:39]
    ds_read_b64_tr_b16 v[20:21], v248 offset:20224
    ds_read_b64_tr_b16 v[22:23], v248 offset:20608
    s_waitcnt lgkmcnt(6)
    v_mfma_f32_32x32x16_bf16 v[24:39], v[8:11], v[116:119], v[24:39]
    ds_read_b64_tr_b16 v[8:9], v248 offset:21760
    ds_read_b64_tr_b16 v[10:11], v248 offset:22144
    s_waitcnt lgkmcnt(6)
    v_mfma_f32_32x32x16_bf16 v[24:39], v[12:15], v[120:123], v[24:39]
    ds_read_b64_tr_b16 v[12:13], v248 offset:32
    ds_read_b64_tr_b16 v[14:15], v248 offset:416
    s_waitcnt vmcnt(27)
    s_waitcnt lgkmcnt(6)
    v_mfma_f32_32x32x16_bf16 v[24:39], v[16:19], v[124:127], v[24:39]
    ds_read_b64_tr_b16 v[16:17], v248 offset:23296
    ds_read_b64_tr_b16 v[18:19], v248 offset:23680
    s_waitcnt lgkmcnt(6)
    v_mfma_f32_32x32x16_bf16 v[24:39], v[20:23], v[128:131], v[24:39]
    ds_read_b64_tr_b16 v[20:21], v248 offset:1568
    ds_read_b64_tr_b16 v[22:23], v248 offset:1952
    s_waitcnt lgkmcnt(6)
    v_mfma_f32_32x32x16_bf16 v[24:39], v[8:11], v[132:135], v[24:39]
    ds_read_b64_tr_b16 v[8:9], v248 offset:24832
    ds_read_b64_tr_b16 v[10:11], v248 offset:25216
    s_waitcnt lgkmcnt(6)
    v_mfma_f32_32x32x16_bf16 v[40:55], v[12:15], v[100:103], 0
    ds_read_b64_tr_b16 v[12:13], v248 offset:3104
    ds_read_b64_tr_b16 v[14:15], v248 offset:3488
    s_waitcnt lgkmcnt(6)
    v_mfma_f32_32x32x16_bf16 v[24:39], v[16:19], v[136:139], v[24:39]
    ds_read_b64_tr_b16 v[16:17], v248 offset:26368
    ds_read_b64_tr_b16 v[18:19], v248 offset:26752
    s_waitcnt lgkmcnt(6)
    v_mfma_f32_32x32x16_bf16 v[40:55], v[20:23], v[104:107], v[40:55]
    ds_read_b64_tr_b16 v[20:21], v248 offset:4640
    ds_read_b64_tr_b16 v[22:23], v248 offset:5024
    s_waitcnt lgkmcnt(6)
    v_mfma_f32_32x32x16_bf16 v[24:39], v[8:11], v[140:143], v[24:39]
    s_waitcnt vmcnt(24)
    s_barrier
    s_mov_b32 s51, 46080
    s_add_u32 m0, s49, 93440
    s_nop 0
    buffer_load_dwordx4 v244, s[12:15], s51 offen lds
    s_mov_b32 s51, 47104
    s_add_u32 m0, s49, 94464
    s_nop 0
    buffer_load_dwordx4 v244, s[12:15], s51 offen lds
    s_mov_b64 exec, 0xffff
    s_mov_b32 s51, 48128
    s_add_u32 m0, s49, 95488
    s_nop 0
    buffer_load_dwordx4 v244, s[12:15], s51 offen lds
    s_mov_b64 exec, -1
    s_mov_b32 s43, 30720
    buffer_load_dwordx4 v[220:223], v6, s[16:19], s43 offen offset:0
    buffer_load_dwordx4 v[224:227], v6, s[16:19], s43 offen offset:1024
    buffer_load_dwordx4 v[228:231], v6, s[16:19], s43 offen offset:2048
    buffer_load_dwordx4 v[232:235], v6, s[16:19], s43 offen offset:3072
    s_mov_b32 s43, 34816
    buffer_load_dwordx4 v[236:239], v6, s[16:19], s43 offen offset:0
    buffer_load_dwordx4 v[240:243], v6, s[16:19], s43 offen offset:1024
    ds_read_b64_tr_b16 v[8:9], v248 offset:37376
    ds_read_b64_tr_b16 v[10:11], v248 offset:37760
    s_waitcnt lgkmcnt(6)
    v_mfma_f32_32x32x16_bf16 v[40:55], v[12:15], v[108:111], v[40:55]
    ds_read_b64_tr_b16 v[12:13], v248 offset:6176
    ds_read_b64_tr_b16 v[14:15], v248 offset:6560
    s_waitcnt lgkmcnt(6)
    v_mfma_f32_32x32x16_bf16 v[24:39], v[16:19], v[144:147], v[24:39]
    ds_read_b64_tr_b16 v[16:17], v248 offset:38912
    ds_read_b64_tr_b16 v[18:19], v248 offset:39296
    s_waitcnt lgkmcnt(6)
    v_mfma_f32_32x32x16_bf16 v[40:55], v[20:23], v[112:115], v[40:55]
    ds_read_b64_tr_b16 v[20:21], v248 offset:7712
    ds_read_b64_tr_b16 v[22:23], v248 offset:8096
    s_waitcnt vmcnt(27)
    s_waitcnt lgkmcnt(6)
    v_mfma_f32_32x32x16_bf16 v[24:39], v[8:11], v[148:151], v[24:39]
    ds_read_b64_tr_b16 v[8:9], v248 offset:40448
    ds_read_b64_tr_b16 v[10:11], v248 offset:40832
    s_waitcnt lgkmcnt(6)
    v_mfma_f32_32x32x16_bf16 v[40:55], v[12:15], v[116:119], v[40:55]
    ds_read_b64_tr_b16 v[12:13], v248 offset:18720
    ds_read_b64_tr_b16 v[14:15], v248 offset:19104
    s_waitcnt lgkmcnt(6)
    v_mfma_f32_32x32x16_bf16 v[24:39], v[16:19], v[152:155], v[24:39]
    ds_read_b64_tr_b16 v[16:17], v248 offset:41984
    ds_read_b64_tr_b16 v[18:19], v248 offset:42368
    s_waitcnt lgkmcnt(6)
    v_mfma_f32_32x32x16_bf16 v[40:55], v[20:23], v[120:123], v[40:55]
    ds_read_b64_tr_b16 v[20:21], v248 offset:20256
    ds_read_b64_tr_b16 v[22:23], v248 offset:20640
    s_waitcnt lgkmcnt(6)
    v_mfma_f32_32x32x16_bf16 v[24:39], v[8:11], v[156:159], v[24:39]
    ds_read_b64_tr_b16 v[8:9], v248 offset:43520
    ds_read_b64_tr_b16 v[10:11], v248 offset:43904
    s_waitcnt lgkmcnt(6)
    v_mfma_f32_32x32x16_bf16 v[40:55], v[12:15], v[124:127], v[40:55]
    ds_read_b64_tr_b16 v[12:13], v248 offset:21792
    ds_read_b64_tr_b16 v[14:15], v248 offset:22176
    s_waitcnt lgkmcnt(6)
    v_mfma_f32_32x32x16_bf16 v[24:39], v[16:19], v[160:163], v[24:39]
    ds_read_b64_tr_b16 v[16:17], v248 offset:64
    ds_read_b64_tr_b16 v[18:19], v248 offset:448
    s_waitcnt lgkmcnt(6)
    v_mfma_f32_32x32x16_bf16 v[40:55], v[20:23], v[128:131], v[40:55]
    ds_read_b64_tr_b16 v[20:21], v248 offset:45056
    ds_read_b64_tr_b16 v[22:23], v248 offset:45440
    s_waitcnt lgkmcnt(6)
    v_mfma_f32_32x32x16_bf16 v[24:39], v[8:11], v[164:167], v[24:39]
    ds_read_b64_tr_b16 v[8:9], v248 offset:23328
    ds_read_b64_tr_b16 v[10:11], v248 offset:23712
    s_waitcnt lgkmcnt(6)
    v_mfma_f32_32x32x16_bf16 v[40:55], v[12:15], v[132:135], v[40:55]
    ds_read_b64_tr_b16 v[12:13], v248 offset:1600
    ds_read_b64_tr_b16 v[14:15], v248 offset:1984
    s_waitcnt lgkmcnt(6)
    v_mfma_f32_32x32x16_bf16 v[56:71], v[16:19], v[100:103], 0
    s_waitcnt vmcnt(24)
    s_barrier
    s_mov_b32 s51, 55296
    s_add_u32 m0, s49, 112128
    s_nop 0
    buffer_load_dwordx4 v244, s[12:15], s51 offen lds
    s_mov_b32 s51, 56320
    s_add_u32 m0, s49, 113152
    s_nop 0
    buffer_load_dwordx4 v244, s[12:15], s51 offen lds
    s_mov_b64 exec, 0xffff
    s_mov_b32 s51, 57344
    s_add_u32 m0, s49, 114176
    s_nop 0
    buffer_load_dwordx4 v244, s[12:15], s51 offen lds
    s_mov_b64 exec, -1
    ds_read_b64_tr_b16 v[16:17], v248 offset:56064
    ds_read_b64_tr_b16 v[18:19], v248 offset:56448
    s_waitcnt lgkmcnt(6)
    v_mfma_f32_32x32x16_bf16 v[24:39], v[20:23], v[168:171], v[24:39]
    ds_read_b64_tr_b16 v[20:21], v248 offset:24864
    ds_read_b64_tr_b16 v[22:23], v248 offset:25248
    s_waitcnt lgkmcnt(6)
    v_mfma_f32_32x32x16_bf16 v[40:55], v[8:11], v[136:139], v[40:55]
    ds_read_b64_tr_b16 v[8:9], v248 offset:3136
    ds_read_b64_tr_b16 v[10:11], v248 offset:3520
    s_waitcnt lgkmcnt(6)
    v_mfma_f32_32x32x16_bf16 v[56:71], v[12:15], v[104:107], v[56:71]
    ds_read_b64_tr_b16 v[12:13], v248 offset:57600
    ds_read_b64_tr_b16 v[14:15], v248 offset:57984
    s_waitcnt vmcnt(21)
    s_waitcnt lgkmcnt(6)
    v_mfma_f32_32x32x16_bf16 v[24:39], v[16:19], v[172:175], v[24:39]
    ds_read_b64_tr_b16 v[16:17], v248 offset:26400
    ds_read_b64_tr_b16 v[18:19], v248 offset:26784
    s_waitcnt lgkmcnt(6)
    v_mfma_f32_32x32x16_bf16 v[40:55], v[20:23], v[140:143], v[40:55]
    ds_read_b64_tr_b16 v[20:21], v248 offset:4672
    ds_read_b64_tr_b16 v[22:23], v248 offset:5056
    s_waitcnt lgkmcnt(6)
    v_mfma_f32_32x32x16_bf16 v[56:71], v[8:11], v[108:111], v[56:71]
    ds_read_b64_tr_b16 v[8:9], v248 offset:59136
    ds_read_b64_tr_b16 v[10:11], v248 offset:59520
    s_waitcnt lgkmcnt(6)
    v_mfma_f32_32x32x16_bf16 v[24:39], v[12:15], v[176:179], v[24:39]
    ds_read_b64_tr_b16 v[12:13], v248 offset:37408
    ds_read_b64_tr_b16 v[14:15], v248 offset:37792
    s_waitcnt lgkmcnt(6)
    v_mfma_f32_32x32x16_bf16 v[40:55], v[16:19], v[144:147], v[40:55]
    ds_read_b64_tr_b16 v[16:17], v248 offset:6208
    ds_read_b64_tr_b16 v[18:19], v248 offset:6592
    s_waitcnt lgkmcnt(6)
    v_mfma_f32_32x32x16_bf16 v[56:71], v[20:23], v[112:115], v[56:71]
    ds_read_b64_tr_b16 v[20:21], v248 offset:60672
    ds_read_b64_tr_b16 v[22:23], v248 offset:61056
    s_waitcnt lgkmcnt(6)
    v_mfma_f32_32x32x16_bf16 v[24:39], v[8:11], v[180:183], v[24:39]
    ds_read_b64_tr_b16 v[8:9], v248 offset:38944
    ds_read_b64_tr_b16 v[10:11], v248 offset:39328
    s_waitcnt lgkmcnt(6)
    v_mfma_f32_32x32x16_bf16 v[40:55], v[12:15], v[148:151], v[40:55]
    ds_read_b64_tr_b16 v[12:13], v248 offset:7744
    ds_read_b64_tr_b16 v[14:15], v248 offset:8128
    s_waitcnt lgkmcnt(6)
    v_mfma_f32_32x32x16_bf16 v[56:71], v[16:19], v[116:119], v[56:71]
    ds_read_b64_tr_b16 v[16:17], v248 offset:62208
    ds_read_b64_tr_b16 v[18:19], v248 offset:62592
    s_waitcnt lgkmcnt(6)
    v_mfma_f32_32x32x16_bf16 v[24:39], v[20:23], v[184:187], v[24:39]
    ds_read_b64_tr_b16 v[20:21], v248 offset:40480
    ds_read_b64_tr_b16 v[22:23], v248 offset:40864
    s_waitcnt lgkmcnt(6)
    v_mfma_f32_32x32x16_bf16 v[40:55], v[8:11], v[152:155], v[40:55]
    ds_read_b64_tr_b16 v[8:9], v248 offset:18752
    ds_read_b64_tr_b16 v[10:11], v248 offset:19136
    s_waitcnt lgkmcnt(6)
    v_mfma_f32_32x32x16_bf16 v[56:71], v[12:15], v[120:123], v[56:71]
    ds_read_b64_tr_b16 v[12:13], v248 offset:63744
    ds_read_b64_tr_b16 v[14:15], v248 offset:64128
    s_waitcnt lgkmcnt(6)
    v_mfma_f32_32x32x16_bf16 v[24:39], v[16:19], v[188:191], v[24:39]
    ds_read_b64_tr_b16 v[16:17], v248 offset:42016
    ds_read_b64_tr_b16 v[18:19], v248 offset:42400
    s_waitcnt lgkmcnt(6)
    v_mfma_f32_32x32x16_bf16 v[40:55], v[20:23], v[156:159], v[40:55]
    ds_read_b64_tr_b16 v[20:21], v248 offset:20288
    ds_read_b64_tr_b16 v[22:23], v248 offset:20672
    s_waitcnt lgkmcnt(6)
    v_mfma_f32_32x32x16_bf16 v[56:71], v[8:11], v[124:127], v[56:71]
    s_waitcnt vmcnt(18)
    s_barrier
    s_mov_b32 s51, 64512
    s_add_u32 m0, s49, 130816
    s_nop 0
    buffer_load_dwordx4 v244, s[12:15], s51 offen lds
    s_mov_b32 s51, 65536
    s_add_u32 m0, s49, 131840
    s_nop 0
    buffer_load_dwordx4 v244, s[12:15], s51 offen lds
    s_mov_b64 exec, 0xffff
    s_mov_b32 s51, 66560
    s_add_u32 m0, s49, 132864
    s_nop 0
    buffer_load_dwordx4 v244, s[12:15], s51 offen lds
    s_mov_b64 exec, -1
    ds_read_b64_tr_b16 v[8:9], v251 offset:0
    ds_read_b64_tr_b16 v[10:11], v251 offset:384
    s_waitcnt lgkmcnt(6)
    v_mfma_f32_32x32x16_bf16 v[24:39], v[12:15], v[192:195], v[24:39]
    ds_read_b64_tr_b16 v[12:13], v248 offset:43552
    ds_read_b64_tr_b16 v[14:15], v248 offset:43936
    s_waitcnt lgkmcnt(6)
    v_mfma_f32_32x32x16_bf16 v[40:55], v[16:19], v[160:163], v[40:55]
    ds_read_b64_tr_b16 v[16:17], v248 offset:21824
    ds_read_b64_tr_b16 v[18:19], v248 offset:22208
    s_waitcnt lgkmcnt(6)
    v_mfma_f32_32x32x16_bf16 v[56:71], v[20:23], v[128:131], v[56:71]
    ds_read_b64_tr_b16 v[20:21], v251 offset:1536
    ds_read_b64_tr_b16 v[22:23], v251 offset:1920
    s_waitcnt vmcnt(15)
    s_waitcnt lgkmcnt(6)
    v_mfma_f32_32x32x16_bf16 v[24:39], v[8:11], v[196:199], v[24:39]
    ds_read_b64_tr_b16 v[8:9], v248 offset:45088
    ds_read_b64_tr_b16 v[10:11], v248 offset:45472
    s_waitcnt lgkmcnt(6)
    v_mfma_f32_32x32x16_bf16 v[40:55], v[12:15], v[164:167], v[40:55]
    ds_read_b64_tr_b16 v[12:13], v248 offset:23360
    ds_read_b64_tr_b16 v[14:15], v248 offset:23744
    s_waitcnt lgkmcnt(6)
    v_mfma_f32_32x32x16_bf16 v[56:71], v[16:19], v[132:135], v[56:71]
    ds_read_b64_tr_b16 v[16:17], v251 offset:3072
    ds_read_b64_tr_b16 v[18:19], v251 offset:3456
    s_waitcnt lgkmcnt(6)
    v_mfma_f32_32x32x16_bf16 v[24:39], v[20:23], v[200:203], v[24:39]
    ds_read_b64_tr_b16 v[20:21], v248 offset:56096
    ds_read_b64_tr_b16 v[22:23], v248 offset:56480
    s_waitcnt lgkmcnt(6)
    v_mfma_f32_32x32x16_bf16 v[40:55], v[8:11], v[168:171], v[40:55]
    ds_read_b64_tr_b16 v[8:9], v248 offset:24896
    ds_read_b64_tr_b16 v[10:11], v248 offset:25280
    s_waitcnt lgkmcnt(6)
    v_mfma_f32_32x32x16_bf16 v[56:71], v[12:15], v[136:139], v[56:71]
    ds_read_b64_tr_b16 v[12:13], v251 offset:4608
    ds_read_b64_tr_b16 v[14:15], v251 offset:4992
    s_waitcnt lgkmcnt(6)
    v_mfma_f32_32x32x16_bf16 v[24:39], v[16:19], v[204:207], v[24:39]
    ds_read_b64_tr_b16 v[16:17], v248 offset:57632
    ds_read_b64_tr_b16 v[18:19], v248 offset:58016
    s_waitcnt lgkmcnt(6)
    v_mfma_f32_32x32x16_bf16 v[40:55], v[20:23], v[172:175], v[40:55]
    ds_read_b64_tr_b16 v[20:21], v248 offset:26432
    ds_read_b64_tr_b16 v[22:23], v248 offset:26816
    s_waitcnt lgkmcnt(6)
    v_mfma_f32_32x32x16_bf16 v[56:71], v[8:11], v[140:143], v[56:71]
    ds_read_b64_tr_b16 v[8:9], v251 offset:6144
    ds_read_b64_tr_b16 v[10:11], v251 offset:6528
    s_waitcnt lgkmcnt(6)
    v_mfma_f32_32x32x16_bf16 v[24:39], v[12:15], v[208:211], v[24:39]
    ds_read_b64_tr_b16 v[12:13], v248 offset:59168
    ds_read_b64_tr_b16 v[14:15], v248 offset:59552
    s_waitcnt lgkmcnt(6)
    v_mfma_f32_32x32x16_bf16 v[40:55], v[16:19], v[176:179], v[40:55]
    ds_read_b64_tr_b16 v[16:17], v248 offset:37440
    ds_read_b64_tr_b16 v[18:19], v248 offset:37824
    s_waitcnt lgkmcnt(6)
    v_mfma_f32_32x32x16_bf16 v[56:71], v[20:23], v[144:147], v[56:71]
    ds_read_b64_tr_b16 v[20:21], v251 offset:7680
    ds_read_b64_tr_b16 v[22:23], v251 offset:8064
    s_waitcnt lgkmcnt(6)
    v_mfma_f32_32x32x16_bf16 v[24:39], v[8:11], v[212:215], v[24:39]
    ds_read_b64_tr_b16 v[8:9], v248 offset:60704
    ds_read_b64_tr_b16 v[10:11], v248 offset:61088
    s_waitcnt lgkmcnt(6)
    v_mfma_f32_32x32x16_bf16 v[40:55], v[12:15], v[180:183], v[40:55]
    ds_read_b64_tr_b16 v[12:13], v248 offset:38976
    ds_read_b64_tr_b16 v[14:15], v248 offset:39360
    s_waitcnt lgkmcnt(6)
    v_mfma_f32_32x32x16_bf16 v[56:71], v[16:19], v[148:151], v[56:71]
    s_waitcnt vmcnt(12)
    s_barrier
    s_mov_b32 s51, 73728
    s_add_u32 m0, s49, 0
    s_nop 0
    buffer_load_dwordx4 v244, s[12:15], s51 offen lds
    s_mov_b32 s51, 74752
    s_add_u32 m0, s49, 1024
    s_nop 0
    buffer_load_dwordx4 v244, s[12:15], s51 offen lds
    s_mov_b64 exec, 0xffff
    s_mov_b32 s51, 75776
    s_add_u32 m0, s49, 2048
    s_nop 0
    buffer_load_dwordx4 v244, s[12:15], s51 offen lds
    s_mov_b64 exec, -1
    ds_read_b64_tr_b16 v[16:17], v251 offset:18688
    ds_read_b64_tr_b16 v[18:19], v251 offset:19072
    s_waitcnt lgkmcnt(6)
    v_mfma_f32_32x32x16_bf16 v[24:39], v[20:23], v[216:219], v[24:39]
    ds_read_b64_tr_b16 v[20:21], v248 offset:62240
    ds_read_b64_tr_b16 v[22:23], v248 offset:62624
    s_waitcnt lgkmcnt(6)
    v_mfma_f32_32x32x16_bf16 v[40:55], v[8:11], v[184:187], v[40:55]
    ds_read_b64_tr_b16 v[8:9], v248 offset:40512
    ds_read_b64_tr_b16 v[10:11], v248 offset:40896
    s_waitcnt lgkmcnt(6)
    v_mfma_f32_32x32x16_bf16 v[56:71], v[12:15], v[152:155], v[56:71]
    ds_read_b64_tr_b16 v[12:13], v251 offset:20224
    ds_read_b64_tr_b16 v[14:15], v251 offset:20608
    s_waitcnt vmcnt(9)
    s_waitcnt lgkmcnt(6)
    v_mfma_f32_32x32x16_bf16 v[24:39], v[16:19], v[220:223], v[24:39]
    ds_read_b64_tr_b16 v[16:17], v248 offset:63776
    ds_read_b64_tr_b16 v[18:19], v248 offset:64160
    s_waitcnt lgkmcnt(6)
    v_mfma_f32_32x32x16_bf16 v[40:55], v[20:23], v[188:191], v[40:55]
    ds_read_b64_tr_b16 v[20:21], v248 offset:42048
    ds_read_b64_tr_b16 v[22:23], v248 offset:42432
    s_waitcnt lgkmcnt(6)
    v_mfma_f32_32x32x16_bf16 v[56:71], v[8:11], v[156:159], v[56:71]
    ds_read_b64_tr_b16 v[8:9], v251 offset:21760
    ds_read_b64_tr_b16 v[10:11], v251 offset:22144
    s_waitcnt lgkmcnt(6)
    v_mfma_f32_32x32x16_bf16 v[24:39], v[12:15], v[224:227], v[24:39]
    ds_read_b64_tr_b16 v[12:13], v251 offset:32
    ds_read_b64_tr_b16 v[14:15], v251 offset:416
    s_waitcnt lgkmcnt(6)
    v_mfma_f32_32x32x16_bf16 v[40:55], v[16:19], v[192:195], v[40:55]
    ds_read_b64_tr_b16 v[16:17], v248 offset:43584
    ds_read_b64_tr_b16 v[18:19], v248 offset:43968
    s_waitcnt lgkmcnt(6)
    v_mfma_f32_32x32x16_bf16 v[56:71], v[20:23], v[160:163], v[56:71]
    ds_read_b64_tr_b16 v[20:21], v251 offset:23296
    ds_read_b64_tr_b16 v[22:23], v251 offset:23680
    s_waitcnt lgkmcnt(6)
    v_mfma_f32_32x32x16_bf16 v[24:39], v[8:11], v[228:231], v[24:39]
    ds_read_b64_tr_b16 v[8:9], v251 offset:1568
    ds_read_b64_tr_b16 v[10:11], v251 offset:1952
    s_waitcnt lgkmcnt(6)
    v_mfma_f32_32x32x16_bf16 v[40:55], v[12:15], v[196:199], v[40:55]
    ds_read_b64_tr_b16 v[12:13], v248 offset:45120
    ds_read_b64_tr_b16 v[14:15], v248 offset:45504
    s_waitcnt lgkmcnt(6)
    v_mfma_f32_32x32x16_bf16 v[56:71], v[16:19], v[164:167], v[56:71]
    ds_read_b64_tr_b16 v[16:17], v251 offset:24832
    ds_read_b64_tr_b16 v[18:19], v251 offset:25216
    s_waitcnt lgkmcnt(6)
    v_mfma_f32_32x32x16_bf16 v[24:39], v[20:23], v[232:235], v[24:39]
    ds_read_b64_tr_b16 v[20:21], v251 offset:3104
    ds_read_b64_tr_b16 v[22:23], v251 offset:3488
    s_waitcnt lgkmcnt(6)
    v_mfma_f32_32x32x16_bf16 v[40:55], v[8:11], v[200:203], v[40:55]
    ds_read_b64_tr_b16 v[8:9], v248 offset:56128
    ds_read_b64_tr_b16 v[10:11], v248 offset:56512
    s_waitcnt lgkmcnt(6)
    v_mfma_f32_32x32x16_bf16 v[56:71], v[12:15], v[168:171], v[56:71]
    ds_read_b64_tr_b16 v[12:13], v251 offset:26368
    ds_read_b64_tr_b16 v[14:15], v251 offset:26752
    s_waitcnt lgkmcnt(6)
    v_mfma_f32_32x32x16_bf16 v[24:39], v[16:19], v[236:239], v[24:39]
    ds_read_b64_tr_b16 v[16:17], v251 offset:4640
    ds_read_b64_tr_b16 v[18:19], v251 offset:5024
    s_waitcnt lgkmcnt(6)
    v_mfma_f32_32x32x16_bf16 v[40:55], v[20:23], v[204:207], v[40:55]
    ds_read_b64_tr_b16 v[20:21], v248 offset:57664
    ds_read_b64_tr_b16 v[22:23], v248 offset:58048
    s_waitcnt lgkmcnt(6)
    v_mfma_f32_32x32x16_bf16 v[56:71], v[8:11], v[172:175], v[56:71]
    ds_read_b64_tr_b16 v[8:9], v251 offset:6176
    ds_read_b64_tr_b16 v[10:11], v251 offset:6560
    s_waitcnt lgkmcnt(6)
    v_mfma_f32_32x32x16_bf16 v[24:39], v[12:15], v[240:243], v[24:39]
    ds_read_b64_tr_b16 v[12:13], v248 offset:59200
    ds_read_b64_tr_b16 v[14:15], v248 offset:59584
    s_waitcnt lgkmcnt(6)
    v_mfma_f32_32x32x16_bf16 v[40:55], v[16:19], v[208:211], v[40:55]
    ds_read_b64_tr_b16 v[16:17], v251 offset:7712
    ds_read_b64_tr_b16 v[18:19], v251 offset:8096
    s_waitcnt lgkmcnt(6)
    v_mfma_f32_32x32x16_bf16 v[56:71], v[20:23], v[176:179], v[56:71]
    ds_read_b64_tr_b16 v[20:21], v248 offset:60736
    ds_read_b64_tr_b16 v[22:23], v248 offset:61120
    s_waitcnt lgkmcnt(6)
    v_mfma_f32_32x32x16_bf16 v[40:55], v[8:11], v[212:215], v[40:55]
    v_mul_f32 v72, v24, v24
    v_fma_f32 v72, v72, s53, v250
    v_mul_f32 v72, v72, v24
    v_mul_f32 v73, v25, v25
    v_fma_f32 v73, v73, s53, v250
    ds_read_b64_tr_b16 v[8:9], v251 offset:18720
    ds_read_b64_tr_b16 v[10:11], v251 offset:19104
    s_waitcnt lgkmcnt(6)
    v_mfma_f32_32x32x16_bf16 v[56:71], v[12:15], v[180:183], v[56:71]
    v_mul_f32 v73, v73, v25
    v_mul_f32 v74, v26, v26
    v_fma_f32 v74, v74, s53, v250
    v_mul_f32 v74, v74, v26
    v_mul_f32 v75, v27, v27
    ds_read_b64_tr_b16 v[12:13], v248 offset:62272
    ds_read_b64_tr_b16 v[14:15], v248 offset:62656
    s_waitcnt lgkmcnt(6)
    v_mfma_f32_32x32x16_bf16 v[40:55], v[16:19], v[216:219], v[40:55]
    v_fma_f32 v75, v75, s53, v250
    v_mul_f32 v75, v75, v27
    v_mul_f32 v76, v28, v28
    v_fma_f32 v76, v76, s53, v250
    v_mul_f32 v76, v76, v28
    ds_read_b64_tr_b16 v[16:17], v251 offset:20256
    ds_read_b64_tr_b16 v[18:19], v251 offset:20640
    s_waitcnt lgkmcnt(6)
    v_mfma_f32_32x32x16_bf16 v[56:71], v[20:23], v[184:187], v[56:71]
    v_mul_f32 v77, v29, v29
    v_fma_f32 v77, v77, s53, v250
    v_mul_f32 v77, v77, v29
    v_mul_f32 v78, v30, v30
    v_fma_f32 v78, v78, s53, v250
    ds_read_b64_tr_b16 v[20:21], v248 offset:63808
    ds_read_b64_tr_b16 v[22:23], v248 offset:64192
    s_waitcnt lgkmcnt(6)
    v_mfma_f32_32x32x16_bf16 v[40:55], v[8:11], v[220:223], v[40:55]
    v_mul_f32 v78, v78, v30
    v_mul_f32 v79, v31, v31
    v_fma_f32 v79, v79, s53, v250
    v_mul_f32 v79, v79, v31
    v_exp_f32 v72, v72
    ds_read_b64_tr_b16 v[8:9], v251 offset:21792
    ds_read_b64_tr_b16 v[10:11], v251 offset:22176
    s_waitcnt lgkmcnt(6)
    v_mfma_f32_32x32x16_bf16 v[56:71], v[12:15], v[188:191], v[56:71]
    v_exp_f32 v73, v73
    v_exp_f32 v74, v74
    v_exp_f32 v75, v75
    v_exp_f32 v76, v76
    v_exp_f32 v77, v77
    ds_read_b64_tr_b16 v[12:13], v251 offset:64
    ds_read_b64_tr_b16 v[14:15], v251 offset:448
    s_waitcnt lgkmcnt(6)
    v_mfma_f32_32x32x16_bf16 v[40:55], v[16:19], v[224:227], v[40:55]
    v_exp_f32 v78, v78
    v_exp_f32 v79, v79
    v_mul_f32 v80, v24, v32
    v_mul_f32 v81, v25, v33
    v_mul_f32 v82, v26, v34
    ds_read_b64_tr_b16 v[16:17], v251 offset:23328
    ds_read_b64_tr_b16 v[18:19], v251 offset:23712
    s_waitcnt lgkmcnt(6)
    v_mfma_f32_32x32x16_bf16 v[56:71], v[20:23], v[192:195], v[56:71]
    v_mul_f32 v83, v27, v35
    v_mul_f32 v84, v28, v36
    v_mul_f32 v85, v29, v37
    v_mul_f32 v86, v30, v38
    v_mul_f32 v87, v31, v39
    ds_read_b64_tr_b16 v[20:21], v251 offset:1600
    ds_read_b64_tr_b16 v[22:23], v251 offset:1984
    s_waitcnt lgkmcnt(6)
    v_mfma_f32_32x32x16_bf16 v[40:55], v[8:11], v[228:231], v[40:55]
    v_add_f32 v72, 1.0, v72
    v_add_f32 v73, 1.0, v73
    v_add_f32 v74, 1.0, v74
    v_add_f32 v75, 1.0, v75
    v_add_f32 v76, 1.0, v76
    ds_read_b64_tr_b16 v[8:9], v251 offset:24864
    ds_read_b64_tr_b16 v[10:11], v251 offset:25248
    s_waitcnt lgkmcnt(6)
    v_mfma_f32_32x32x16_bf16 v[56:71], v[12:15], v[196:199], v[56:71]
    v_add_f32 v77, 1.0, v77
    v_add_f32 v78, 1.0, v78
    v_add_f32 v79, 1.0, v79
    v_rcp_f32 v72, v72
    v_rcp_f32 v73, v73
    ds_read_b64_tr_b16 v[12:13], v251 offset:3136
    ds_read_b64_tr_b16 v[14:15], v251 offset:3520
    s_waitcnt lgkmcnt(6)
    v_mfma_f32_32x32x16_bf16 v[40:55], v[16:19], v[232:235], v[40:55]
    v_rcp_f32 v74, v74
    v_rcp_f32 v75, v75
    v_rcp_f32 v76, v76
    v_rcp_f32 v77, v77
    v_rcp_f32 v78, v78
    ds_read_b64_tr_b16 v[16:17], v251 offset:26400
    ds_read_b64_tr_b16 v[18:19], v251 offset:26784
    s_waitcnt lgkmcnt(6)
    v_mfma_f32_32x32x16_bf16 v[56:71], v[20:23], v[200:203], v[56:71]
    v_rcp_f32 v79, v79
    s_nop 0
    v_mul_f32 v72, v72, v80
    v_mul_f32 v73, v73, v81
    v_mul_f32 v74, v74, v82
    ds_read_b64_tr_b16 v[20:21], v251 offset:4672
    ds_read_b64_tr_b16 v[22:23], v251 offset:5056
    s_waitcnt lgkmcnt(6)
    v_mfma_f32_32x32x16_bf16 v[40:55], v[8:11], v[236:239], v[40:55]
    v_mul_f32 v75, v75, v83
    v_mul_f32 v76, v76, v84
    v_mul_f32 v77, v77, v85
    v_mul_f32 v78, v78, v86
    v_mul_f32 v79, v79, v87
    s_waitcnt vmcnt(6)
    s_barrier
    s_mov_b32 s51, 82944
    s_add_u32 m0, s49, 18688
    s_nop 0
    buffer_load_dwordx4 v244, s[12:15], s51 offen lds
    s_mov_b32 s51, 83968
    s_add_u32 m0, s49, 19712
    s_nop 0
    buffer_load_dwordx4 v244, s[12:15], s51 offen lds
    s_mov_b64 exec, 0xffff
    s_mov_b32 s51, 84992
    s_add_u32 m0, s49, 20736
    s_nop 0
    buffer_load_dwordx4 v244, s[12:15], s51 offen lds
    s_mov_b64 exec, -1
    ds_read_b64_tr_b16 v[8:9], v251 offset:37376
    ds_read_b64_tr_b16 v[10:11], v251 offset:37760
    s_waitcnt lgkmcnt(6)
    v_mfma_f32_32x32x16_bf16 v[56:71], v[12:15], v[204:207], v[56:71]
    v_cvt_pk_bf16_f32 v88, v72, v73
    v_cvt_pk_bf16_f32 v89, v74, v75
    v_cvt_pk_bf16_f32 v90, v76, v77
    v_cvt_pk_bf16_f32 v91, v78, v79
    s_nop 1
    ds_read_b64_tr_b16 v[12:13], v251 offset:6208
    ds_read_b64_tr_b16 v[14:15], v251 offset:6592
    s_waitcnt lgkmcnt(6)
    v_mfma_f32_32x32x16_bf16 v[40:55], v[16:19], v[240:243], v[40:55]
    v_permlane32_swap_b32 v88, v90
    v_permlane32_swap_b32 v89, v91
    buffer_store_dwordx4 v[88:91], v249, s[20:23], 0 offen offset:0
    ds_read_b64_tr_b16 v[16:17], v251 offset:38912
    ds_read_b64_tr_b16 v[18:19], v251 offset:39296
    s_waitcnt lgkmcnt(6)
    v_mfma_f32_32x32x16_bf16 v[56:71], v[20:23], v[208:211], v[56:71]
    ds_read_b64_tr_b16 v[20:21], v251 offset:7744
    ds_read_b64_tr_b16 v[22:23], v251 offset:8128
    s_waitcnt lgkmcnt(6)
    v_mfma_f32_32x32x16_bf16 v[24:39], v[8:11], v[100:103], 0
    ds_read_b64_tr_b16 v[8:9], v251 offset:40448
    ds_read_b64_tr_b16 v[10:11], v251 offset:40832
    s_waitcnt lgkmcnt(6)
    v_mfma_f32_32x32x16_bf16 v[56:71], v[12:15], v[212:215], v[56:71]
    v_mul_f32 v72, v40, v40
    v_fma_f32 v72, v72, s53, v250
    v_mul_f32 v72, v72, v40
    v_mul_f32 v73, v41, v41
    v_fma_f32 v73, v73, s53, v250
    ds_read_b64_tr_b16 v[12:13], v251 offset:18752
    ds_read_b64_tr_b16 v[14:15], v251 offset:19136
    s_waitcnt lgkmcnt(6)
    v_mfma_f32_32x32x16_bf16 v[24:39], v[16:19], v[104:107], v[24:39]
    v_mul_f32 v73, v73, v41
    v_mul_f32 v74, v42, v42
    v_fma_f32 v74, v74, s53, v250
    v_mul_f32 v74, v74, v42
    v_mul_f32 v75, v43, v43
    ds_read_b64_tr_b16 v[16:17], v251 offset:41984
    ds_read_b64_tr_b16 v[18:19], v251 offset:42368
    s_waitcnt lgkmcnt(6)
    v_mfma_f32_32x32x16_bf16 v[56:71], v[20:23], v[216:219], v[56:71]
    v_fma_f32 v75, v75, s53, v250
    v_mul_f32 v75, v75, v43
    v_mul_f32 v76, v44, v44
    v_fma_f32 v76, v76, s53, v250
    v_mul_f32 v76, v76, v44
    ds_read_b64_tr_b16 v[20:21], v251 offset:20288
    ds_read_b64_tr_b16 v[22:23], v251 offset:20672
    s_waitcnt lgkmcnt(6)
    v_mfma_f32_32x32x16_bf16 v[24:39], v[8:11], v[108:111], v[24:39]
    v_mul_f32 v77, v45, v45
    v_fma_f32 v77, v77, s53, v250
    v_mul_f32 v77, v77, v45
    v_mul_f32 v78, v46, v46
    v_fma_f32 v78, v78, s53, v250
    ds_read_b64_tr_b16 v[8:9], v251 offset:43520
    ds_read_b64_tr_b16 v[10:11], v251 offset:43904
    s_waitcnt lgkmcnt(6)
    v_mfma_f32_32x32x16_bf16 v[56:71], v[12:15], v[220:223], v[56:71]
    v_mul_f32 v78, v78, v46
    v_mul_f32 v79, v47, v47
    v_fma_f32 v79, v79, s53, v250
    v_mul_f32 v79, v79, v47
    v_exp_f32 v72, v72
    ds_read_b64_tr_b16 v[12:13], v251 offset:21824
    ds_read_b64_tr_b16 v[14:15], v251 offset:22208
    s_waitcnt lgkmcnt(6)
    v_mfma_f32_32x32x16_bf16 v[24:39], v[16:19], v[112:115], v[24:39]
    v_exp_f32 v73, v73
    v_exp_f32 v74, v74
    v_exp_f32 v75, v75
    v_exp_f32 v76, v76
    v_exp_f32 v77, v77
    ds_read_b64_tr_b16 v[16:17], v251 offset:45056
    ds_read_b64_tr_b16 v[18:19], v251 offset:45440
    s_waitcnt lgkmcnt(6)
    v_mfma_f32_32x32x16_bf16 v[56:71], v[20:23], v[224:227], v[56:71]
    v_exp_f32 v78, v78
    v_exp_f32 v79, v79
    v_mul_f32 v80, v40, v48
    v_mul_f32 v81, v41, v49
    v_mul_f32 v82, v42, v50
    ds_read_b64_tr_b16 v[20:21], v251 offset:23360
    ds_read_b64_tr_b16 v[22:23], v251 offset:23744
    s_waitcnt lgkmcnt(6)
    v_mfma_f32_32x32x16_bf16 v[24:39], v[8:11], v[116:119], v[24:39]
    v_mul_f32 v83, v43, v51
    v_mul_f32 v84, v44, v52
    v_mul_f32 v85, v45, v53
    v_mul_f32 v86, v46, v54
    v_mul_f32 v87, v47, v55
    s_waitcnt vmcnt(7)
    s_barrier
    s_mov_b32 s51, 92160
    s_add_u32 m0, s49, 37376
    s_nop 0
    buffer_load_dwordx4 v244, s[12:15], s51 offen lds
    s_mov_b32 s51, 93184
    s_add_u32 m0, s49, 38400
    s_nop 0
    buffer_load_dwordx4 v244, s[12:15], s51 offen lds
    s_mov_b64 exec, 0xffff
    s_mov_b32 s51, 94208
    s_add_u32 m0, s49, 39424
    s_nop 0
    buffer_load_dwordx4 v244, s[12:15], s51 offen lds
    s_mov_b64 exec, -1
    ds_read_b64_tr_b16 v[8:9], v251 offset:56064
    ds_read_b64_tr_b16 v[10:11], v251 offset:56448
    s_waitcnt lgkmcnt(6)
    v_mfma_f32_32x32x16_bf16 v[56:71], v[12:15], v[228:231], v[56:71]
    v_add_f32 v72, 1.0, v72
    v_add_f32 v73, 1.0, v73
    v_add_f32 v74, 1.0, v74
    v_add_f32 v75, 1.0, v75
    v_add_f32 v76, 1.0, v76
    ds_read_b64_tr_b16 v[12:13], v251 offset:24896
    ds_read_b64_tr_b16 v[14:15], v251 offset:25280
    s_waitcnt lgkmcnt(6)
    v_mfma_f32_32x32x16_bf16 v[24:39], v[16:19], v[120:123], v[24:39]
    v_add_f32 v77, 1.0, v77
    v_add_f32 v78, 1.0, v78
    v_add_f32 v79, 1.0, v79
    v_rcp_f32 v72, v72
    v_rcp_f32 v73, v73
    ds_read_b64_tr_b16 v[16:17], v251 offset:57600
    ds_read_b64_tr_b16 v[18:19], v251 offset:57984
    s_waitcnt lgkmcnt(6)
    v_mfma_f32_32x32x16_bf16 v[56:71], v[20:23], v[232:235], v[56:71]
    v_rcp_f32 v74, v74
    v_rcp_f32 v75, v75
    v_rcp_f32 v76, v76
    v_rcp_f32 v77, v77
    v_rcp_f32 v78, v78
    ds_read_b64_tr_b16 v[20:21], v251 offset:26432
    ds_read_b64_tr_b16 v[22:23], v251 offset:26816
    s_waitcnt lgkmcnt(6)
    v_mfma_f32_32x32x16_bf16 v[24:39], v[8:11], v[124:127], v[24:39]
    v_rcp_f32 v79, v79
    s_nop 0
    v_mul_f32 v72, v72, v80
    v_mul_f32 v73, v73, v81
    v_mul_f32 v74, v74, v82
    ds_read_b64_tr_b16 v[8:9], v251 offset:59136
    ds_read_b64_tr_b16 v[10:11], v251 offset:59520
    s_waitcnt lgkmcnt(6)
    v_mfma_f32_32x32x16_bf16 v[56:71], v[12:15], v[236:239], v[56:71]
    v_mul_f32 v75, v75, v83
    v_mul_f32 v76, v76, v84
    v_mul_f32 v77, v77, v85
    v_mul_f32 v78, v78, v86
    v_mul_f32 v79, v79, v87
    ds_read_b64_tr_b16 v[12:13], v251 offset:37408
    ds_read_b64_tr_b16 v[14:15], v251 offset:37792
    s_waitcnt lgkmcnt(6)
    v_mfma_f32_32x32x16_bf16 v[24:39], v[16:19], v[128:131], v[24:39]
    v_cvt_pk_bf16_f32 v88, v72, v73
    v_cvt_pk_bf16_f32 v89, v74, v75
    v_cvt_pk_bf16_f32 v90, v76, v77
    v_cvt_pk_bf16_f32 v91, v78, v79
    s_nop 1
    ds_read_b64_tr_b16 v[16:17], v251 offset:60672
    ds_read_b64_tr_b16 v[18:19], v251 offset:61056
    s_waitcnt lgkmcnt(6)
    v_mfma_f32_32x32x16_bf16 v[56:71], v[20:23], v[240:243], v[56:71]
    v_permlane32_swap_b32 v88, v90
    v_permlane32_swap_b32 v89, v91
    buffer_store_dwordx4 v[88:91], v249, s[20:23], 0 offen offset:512
    ds_read_b64_tr_b16 v[20:21], v251 offset:38944
    ds_read_b64_tr_b16 v[22:23], v251 offset:39328
    s_waitcnt lgkmcnt(6)
    v_mfma_f32_32x32x16_bf16 v[24:39], v[8:11], v[132:135], v[24:39]
    ds_read_b64_tr_b16 v[8:9], v251 offset:62208
    ds_read_b64_tr_b16 v[10:11], v251 offset:62592
    s_waitcnt lgkmcnt(6)
    v_mfma_f32_32x32x16_bf16 v[40:55], v[12:15], v[100:103], 0
    ds_read_b64_tr_b16 v[12:13], v251 offset:40480
    ds_read_b64_tr_b16 v[14:15], v251 offset:40864
    s_waitcnt lgkmcnt(6)
    v_mfma_f32_32x32x16_bf16 v[24:39], v[16:19], v[136:139], v[24:39]
    v_mul_f32 v72, v56, v56
    v_fma_f32 v72, v72, s53, v250
    v_mul_f32 v72, v72, v56
    v_mul_f32 v73, v57, v57
    v_fma_f32 v73, v73, s53, v250
    ds_read_b64_tr_b16 v[16:17], v251 offset:63744
    ds_read_b64_tr_b16 v[18:19], v251 offset:64128
    s_waitcnt lgkmcnt(6)
    v_mfma_f32_32x32x16_bf16 v[40:55], v[20:23], v[104:107], v[40:55]
    v_mul_f32 v73, v73, v57
    v_mul_f32 v74, v58, v58
    v_fma_f32 v74, v74, s53, v250
    v_mul_f32 v74, v74, v58
    v_mul_f32 v75, v59, v59
    ds_read_b64_tr_b16 v[20:21], v251 offset:42016
    ds_read_b64_tr_b16 v[22:23], v251 offset:42400
    s_waitcnt lgkmcnt(6)
    v_mfma_f32_32x32x16_bf16 v[24:39], v[8:11], v[140:143], v[24:39]
    v_fma_f32 v75, v75, s53, v250
    v_mul_f32 v75, v75, v59
    v_mul_f32 v76, v60, v60
    v_fma_f32 v76, v76, s53, v250
    v_mul_f32 v76, v76, v60
    s_waitcnt vmcnt(8)
    s_barrier
    s_mov_b32 s51, 101376
    s_add_u32 m0, s49, 56064
    s_nop 0
    buffer_load_dwordx4 v244, s[12:15], s51 offen lds
    s_mov_b32 s51, 102400
    s_add_u32 m0, s49, 57088
    s_nop 0
    buffer_load_dwordx4 v244, s[12:15], s51 offen lds
    s_mov_b64 exec, 0xffff
    s_mov_b32 s51, 103424
    s_add_u32 m0, s49, 58112
    s_nop 0
    buffer_load_dwordx4 v244, s[12:15], s51 offen lds
    s_mov_b64 exec, -1
    ds_read_b64_tr_b16 v[8:9], v248 offset:0
    ds_read_b64_tr_b16 v[10:11], v248 offset:384
    s_waitcnt lgkmcnt(6)
    v_mfma_f32_32x32x16_bf16 v[40:55], v[12:15], v[108:111], v[40:55]
    v_mul_f32 v77, v61, v61
    v_fma_f32 v77, v77, s53, v250
    v_mul_f32 v77, v77, v61
    v_mul_f32 v78, v62, v62
    v_fma_f32 v78, v78, s53, v250
    ds_read_b64_tr_b16 v[12:13], v251 offset:43552
    ds_read_b64_tr_b16 v[14:15], v251 offset:43936
    s_waitcnt lgkmcnt(6)
    v_mfma_f32_32x32x16_bf16 v[24:39], v[16:19], v[144:147], v[24:39]
    v_mul_f32 v78, v78, v62
    v_mul_f32 v79, v63, v63
    v_fma_f32 v79, v79, s53, v250
    v_mul_f32 v79, v79, v63
    v_exp_f32 v72, v72
    ds_read_b64_tr_b16 v[16:17], v248 offset:1536
    ds_read_b64_tr_b16 v[18:19], v248 offset:1920
    s_waitcnt lgkmcnt(6)
    v_mfma_f32_32x32x16_bf16 v[40:55], v[20:23], v[112:115], v[40:55]
    v_exp_f32 v73, v73
    v_exp_f32 v74, v74
    v_exp_f32 v75, v75
    v_exp_f32 v76, v76
    v_exp_f32 v77, v77
    ds_read_b64_tr_b16 v[20:21], v251 offset:45088
    ds_read_b64_tr_b16 v[22:23], v251 offset:45472
    s_waitcnt lgkmcnt(6)
    v_mfma_f32_32x32x16_bf16 v[24:39], v[8:11], v[148:151], v[24:39]
    v_exp_f32 v78, v78
    v_exp_f32 v79, v79
    v_mul_f32 v80, v56, v64
    v_mul_f32 v81, v57, v65
    v_mul_f32 v82, v58, v66
    ds_read_b64_tr_b16 v[8:9], v248 offset:3072
    ds_read_b64_tr_b16 v[10:11], v248 offset:3456
    s_waitcnt lgkmcnt(6)
    v_mfma_f32_32x32x16_bf16 v[40:55], v[12:15], v[116:119], v[40:55]
    v_mul_f32 v83, v59, v67
    v_mul_f32 v84, v60, v68
    v_mul_f32 v85, v61, v69
    v_mul_f32 v86, v62, v70
    v_mul_f32 v87, v63, v71
    ds_read_b64_tr_b16 v[12:13], v251 offset:56096
    ds_read_b64_tr_b16 v[14:15], v251 offset:56480
    s_waitcnt lgkmcnt(6)
    v_mfma_f32_32x32x16_bf16 v[24:39], v[16:19], v[152:155], v[24:39]
    v_add_f32 v72, 1.0, v72
    v_add_f32 v73, 1.0, v73
    v_add_f32 v74, 1.0, v74
    v_add_f32 v75, 1.0, v75
    v_add_f32 v76, 1.0, v76
    ds_read_b64_tr_b16 v[16:17], v248 offset:4608
    ds_read_b64_tr_b16 v[18:19], v248 offset:4992
    s_waitcnt lgkmcnt(6)
    v_mfma_f32_32x32x16_bf16 v[40:55], v[20:23], v[120:123], v[40:55]
    v_add_f32 v77, 1.0, v77
    v_add_f32 v78, 1.0, v78
    v_add_f32 v79, 1.0, v79
    v_rcp_f32 v72, v72
    v_rcp_f32 v73, v73
    ds_read_b64_tr_b16 v[20:21], v251 offset:57632
    ds_read_b64_tr_b16 v[22:23], v251 offset:58016
    s_waitcnt lgkmcnt(6)
    v_mfma_f32_32x32x16_bf16 v[24:39], v[8:11], v[156:159], v[24:39]
    v_rcp_f32 v74, v74
    v_rcp_f32 v75, v75
    v_rcp_f32 v76, v76
    v_rcp_f32 v77, v77
    v_rcp_f32 v78, v78
    ds_read_b64_tr_b16 v[8:9], v248 offset:6144
    ds_read_b64_tr_b16 v[10:11], v248 offset:6528
    s_waitcnt lgkmcnt(6)
    v_mfma_f32_32x32x16_bf16 v[40:55], v[12:15], v[124:127], v[40:55]
    v_rcp_f32 v79, v79
    s_nop 0
    v_mul_f32 v72, v72, v80
    v_mul_f32 v73, v73, v81
    v_mul_f32 v74, v74, v82
    ds_read_b64_tr_b16 v[12:13], v251 offset:59168
    ds_read_b64_tr_b16 v[14:15], v251 offset:59552
    s_waitcnt lgkmcnt(6)
    v_mfma_f32_32x32x16_bf16 v[24:39], v[16:19], v[160:163], v[24:39]
    v_mul_f32 v75, v75, v83
    v_mul_f32 v76, v76, v84
    v_mul_f32 v77, v77, v85
    v_mul_f32 v78, v78, v86
    v_mul_f32 v79, v79, v87
    ds_read_b64_tr_b16 v[16:17], v251 offset:37440
    ds_read_b64_tr_b16 v[18:19], v251 offset:37824
    s_waitcnt lgkmcnt(6)
    v_mfma_f32_32x32x16_bf16 v[40:55], v[20:23], v[128:131], v[40:55]
    v_cvt_pk_bf16_f32 v88, v72, v73
    v_cvt_pk_bf16_f32 v89, v74, v75
    v_cvt_pk_bf16_f32 v90, v76, v77
    v_cvt_pk_bf16_f32 v91, v78, v79
    s_nop 1
    ds_read_b64_tr_b16 v[20:21], v248 offset:7680
    ds_read_b64_tr_b16 v[22:23], v248 offset:8064
    s_waitcnt lgkmcnt(6)
    v_mfma_f32_32x32x16_bf16 v[24:39], v[8:11], v[164:167], v[24:39]
    v_permlane32_swap_b32 v88, v90
    v_permlane32_swap_b32 v89, v91
    buffer_store_dwordx4 v[88:91], v249, s[20:23], 0 offen offset:1024
    ds_read_b64_tr_b16 v[8:9], v251 offset:60704
    ds_read_b64_tr_b16 v[10:11], v251 offset:61088
    s_waitcnt lgkmcnt(6)
    v_mfma_f32_32x32x16_bf16 v[40:55], v[12:15], v[132:135], v[40:55]
    ds_read_b64_tr_b16 v[12:13], v251 offset:38976
    ds_read_b64_tr_b16 v[14:15], v251 offset:39360
    s_waitcnt lgkmcnt(6)
    v_mfma_f32_32x32x16_bf16 v[56:71], v[16:19], v[100:103], 0
    s_waitcnt vmcnt(9)
    s_barrier
    s_mov_b32 s51, 110592
    s_add_u32 m0, s49, 74752
    s_nop 0
    buffer_load_dwordx4 v244, s[12:15], s51 offen lds
    s_mov_b32 s51, 111616
    s_add_u32 m0, s49, 75776
    s_nop 0
    buffer_load_dwordx4 v244, s[12:15], s51 offen lds
    s_mov_b64 exec, 0xffff
    s_mov_b32 s51, 112640
    s_add_u32 m0, s49, 76800
    s_nop 0
    buffer_load_dwordx4 v244, s[12:15], s51 offen lds
    s_mov_b64 exec, -1
    ds_read_b64_tr_b16 v[16:17], v248 offset:18688
    ds_read_b64_tr_b16 v[18:19], v248 offset:19072
    s_waitcnt lgkmcnt(6)
    v_mfma_f32_32x32x16_bf16 v[24:39], v[20:23], v[168:171], v[24:39]
    ds_read_b64_tr_b16 v[20:21], v251 offset:62240
    ds_read_b64_tr_b16 v[22:23], v251 offset:62624
    s_waitcnt lgkmcnt(6)
    v_mfma_f32_32x32x16_bf16 v[40:55], v[8:11], v[136:139], v[40:55]
    ds_read_b64_tr_b16 v[8:9], v251 offset:40512
    ds_read_b64_tr_b16 v[10:11], v251 offset:40896
    s_waitcnt lgkmcnt(6)
    v_mfma_f32_32x32x16_bf16 v[56:71], v[12:15], v[104:107], v[56:71]
    ds_read_b64_tr_b16 v[12:13], v248 offset:20224
    ds_read_b64_tr_b16 v[14:15], v248 offset:20608
    s_waitcnt lgkmcnt(6)
    v_mfma_f32_32x32x16_bf16 v[24:39], v[16:19], v[172:175], v[24:39]
    ds_read_b64_tr_b16 v[16:17], v251 offset:63776
    ds_read_b64_tr_b16 v[18:19], v251 offset:64160
    s_waitcnt lgkmcnt(6)
    v_mfma_f32_32x32x16_bf16 v[40:55], v[20:23], v[140:143], v[40:55]
    ds_read_b64_tr_b16 v[20:21], v251 offset:42048
    ds_read_b64_tr_b16 v[22:23], v251 offset:42432
    s_waitcnt lgkmcnt(6)
    v_mfma_f32_32x32x16_bf16 v[56:71], v[8:11], v[108:111], v[56:71]
    ds_read_b64_tr_b16 v[8:9], v248 offset:21760
    ds_read_b64_tr_b16 v[10:11], v248 offset:22144
    s_waitcnt lgkmcnt(6)
    v_mfma_f32_32x32x16_bf16 v[24:39], v[12:15], v[176:179], v[24:39]
    ds_read_b64_tr_b16 v[12:13], v248 offset:32
    ds_read_b64_tr_b16 v[14:15], v248 offset:416
    s_waitcnt lgkmcnt(6)
    v_mfma_f32_32x32x16_bf16 v[40:55], v[16:19], v[144:147], v[40:55]
    ds_read_b64_tr_b16 v[16:17], v251 offset:43584
    ds_read_b64_tr_b16 v[18:19], v251 offset:43968
    s_waitcnt lgkmcnt(6)
    v_mfma_f32_32x32x16_bf16 v[56:71], v[20:23], v[112:115], v[56:71]
    ds_read_b64_tr_b16 v[20:21], v248 offset:23296
    ds_read_b64_tr_b16 v[22:23], v248 offset:23680
    s_waitcnt lgkmcnt(6)
    v_mfma_f32_32x32x16_bf16 v[24:39], v[8:11], v[180:183], v[24:39]
    ds_read_b64_tr_b16 v[8:9], v248 offset:1568
    ds_read_b64_tr_b16 v[10:11], v248 offset:1952
    s_waitcnt lgkmcnt(6)
    v_mfma_f32_32x32x16_bf16 v[40:55], v[12:15], v[148:151], v[40:55]
    ds_read_b64_tr_b16 v[12:13], v251 offset:45120
    ds_read_b64_tr_b16 v[14:15], v251 offset:45504
    s_waitcnt lgkmcnt(6)
    v_mfma_f32_32x32x16_bf16 v[56:71], v[16:19], v[116:119], v[56:71]
    ds_read_b64_tr_b16 v[16:17], v248 offset:24832
    ds_read_b64_tr_b16 v[18:19], v248 offset:25216
    s_waitcnt lgkmcnt(6)
    v_mfma_f32_32x32x16_bf16 v[24:39], v[20:23], v[184:187], v[24:39]
    ds_read_b64_tr_b16 v[20:21], v248 offset:3104
    ds_read_b64_tr_b16 v[22:23], v248 offset:3488
    s_waitcnt lgkmcnt(6)
    v_mfma_f32_32x32x16_bf16 v[40:55], v[8:11], v[152:155], v[40:55]
    ds_read_b64_tr_b16 v[8:9], v251 offset:56128
    ds_read_b64_tr_b16 v[10:11], v251 offset:56512
    s_waitcnt lgkmcnt(6)
    v_mfma_f32_32x32x16_bf16 v[56:71], v[12:15], v[120:123], v[56:71]
    ds_read_b64_tr_b16 v[12:13], v248 offset:26368
    ds_read_b64_tr_b16 v[14:15], v248 offset:26752
    s_waitcnt lgkmcnt(6)
    v_mfma_f32_32x32x16_bf16 v[24:39], v[16:19], v[188:191], v[24:39]
    ds_read_b64_tr_b16 v[16:17], v248 offset:4640
    ds_read_b64_tr_b16 v[18:19], v248 offset:5024
    s_waitcnt lgkmcnt(6)
    v_mfma_f32_32x32x16_bf16 v[40:55], v[20:23], v[156:159], v[40:55]
    ds_read_b64_tr_b16 v[20:21], v251 offset:57664
    ds_read_b64_tr_b16 v[22:23], v251 offset:58048
    s_waitcnt lgkmcnt(6)
    v_mfma_f32_32x32x16_bf16 v[56:71], v[8:11], v[124:127], v[56:71]
    s_waitcnt vmcnt(8)
    s_barrier
    s_mov_b32 s51, 119808
    s_add_u32 m0, s49, 93440
    s_nop 0
    buffer_load_dwordx4 v244, s[12:15], s51 offen lds
    s_mov_b32 s51, 120832
    s_add_u32 m0, s49, 94464
    s_nop 0
    buffer_load_dwordx4 v244, s[12:15], s51 offen lds
    s_mov_b64 exec, 0xffff
    s_mov_b32 s51, 121856
    s_add_u32 m0, s49, 95488
    s_nop 0
    buffer_load_dwordx4 v244, s[12:15], s51 offen lds
    s_mov_b64 exec, -1
    ds_read_b64_tr_b16 v[8:9], v248 offset:37376
    ds_read_b64_tr_b16 v[10:11], v248 offset:37760
    s_waitcnt lgkmcnt(6)
    v_mfma_f32_32x32x16_bf16 v[24:39], v[12:15], v[192:195], v[24:39]
    ds_read_b64_tr_b16 v[12:13], v248 offset:6176
    ds_read_b64_tr_b16 v[14:15], v248 offset:6560
    s_waitcnt lgkmcnt(6)
    v_mfma_f32_32x32x16_bf16 v[40:55], v[16:19], v[160:163], v[40:55]
    ds_read_b64_tr_b16 v[16:17], v251 offset:59200
    ds_read_b64_tr_b16 v[18:19], v251 offset:59584
    s_waitcnt lgkmcnt(6)
    v_mfma_f32_32x32x16_bf16 v[56:71], v[20:23], v[128:131], v[56:71]
    ds_read_b64_tr_b16 v[20:21], v248 offset:38912
    ds_read_b64_tr_b16 v[22:23], v248 offset:39296
    s_waitcnt lgkmcnt(6)
    v_mfma_f32_32x32x16_bf16 v[24:39], v[8:11], v[196:199], v[24:39]
    ds_read_b64_tr_b16 v[8:9], v248 offset:7712
    ds_read_b64_tr_b16 v[10:11], v248 offset:8096
    s_waitcnt lgkmcnt(6)
    v_mfma_f32_32x32x16_bf16 v[40:55], v[12:15], v[164:167], v[40:55]
    ds_read_b64_tr_b16 v[12:13], v251 offset:60736
    ds_read_b64_tr_b16 v[14:15], v251 offset:61120
    s_waitcnt lgkmcnt(6)
    v_mfma_f32_32x32x16_bf16 v[56:71], v[16:19], v[132:135], v[56:71]
    ds_read_b64_tr_b16 v[16:17], v248 offset:40448
    ds_read_b64_tr_b16 v[18:19], v248 offset:40832
    s_waitcnt lgkmcnt(6)
    v_mfma_f32_32x32x16_bf16 v[24:39], v[20:23], v[200:203], v[24:39]
    ds_read_b64_tr_b16 v[20:21], v248 offset:18720
    ds_read_b64_tr_b16 v[22:23], v248 offset:19104
    s_waitcnt lgkmcnt(6)
    v_mfma_f32_32x32x16_bf16 v[40:55], v[8:11], v[168:171], v[40:55]
    ds_read_b64_tr_b16 v[8:9], v251 offset:62272
    ds_read_b64_tr_b16 v[10:11], v251 offset:62656
    s_waitcnt lgkmcnt(6)
    v_mfma_f32_32x32x16_bf16 v[56:71], v[12:15], v[136:139], v[56:71]
    ds_read_b64_tr_b16 v[12:13], v248 offset:41984
    ds_read_b64_tr_b16 v[14:15], v248 offset:42368
    s_waitcnt lgkmcnt(6)
    v_mfma_f32_32x32x16_bf16 v[24:39], v[16:19], v[204:207], v[24:39]
    ds_read_b64_tr_b16 v[16:17], v248 offset:20256
    ds_read_b64_tr_b16 v[18:19], v248 offset:20640
    s_waitcnt lgkmcnt(6)
    v_mfma_f32_32x32x16_bf16 v[40:55], v[20:23], v[172:175], v[40:55]
    ds_read_b64_tr_b16 v[20:21], v251 offset:63808
    ds_read_b64_tr_b16 v[22:23], v251 offset:64192
    s_waitcnt lgkmcnt(6)
    v_mfma_f32_32x32x16_bf16 v[56:71], v[8:11], v[140:143], v[56:71]
    ds_read_b64_tr_b16 v[8:9], v248 offset:43520
    ds_read_b64_tr_b16 v[10:11], v248 offset:43904
    s_waitcnt lgkmcnt(6)
    v_mfma_f32_32x32x16_bf16 v[24:39], v[12:15], v[208:211], v[24:39]
    ds_read_b64_tr_b16 v[12:13], v248 offset:21792
    ds_read_b64_tr_b16 v[14:15], v248 offset:22176
    s_waitcnt lgkmcnt(6)
    v_mfma_f32_32x32x16_bf16 v[40:55], v[16:19], v[176:179], v[40:55]
    ds_read_b64_tr_b16 v[16:17], v248 offset:64
    ds_read_b64_tr_b16 v[18:19], v248 offset:448
    s_waitcnt lgkmcnt(6)
    v_mfma_f32_32x32x16_bf16 v[56:71], v[20:23], v[144:147], v[56:71]
    ds_read_b64_tr_b16 v[20:21], v248 offset:45056
    ds_read_b64_tr_b16 v[22:23], v248 offset:45440
    s_waitcnt lgkmcnt(6)
    v_mfma_f32_32x32x16_bf16 v[24:39], v[8:11], v[212:215], v[24:39]
    ds_read_b64_tr_b16 v[8:9], v248 offset:23328
    ds_read_b64_tr_b16 v[10:11], v248 offset:23712
    s_waitcnt lgkmcnt(6)
    v_mfma_f32_32x32x16_bf16 v[40:55], v[12:15], v[180:183], v[40:55]
    ds_read_b64_tr_b16 v[12:13], v248 offset:1600
    ds_read_b64_tr_b16 v[14:15], v248 offset:1984
    s_waitcnt lgkmcnt(6)
    v_mfma_f32_32x32x16_bf16 v[56:71], v[16:19], v[148:151], v[56:71]
    s_waitcnt vmcnt(7)
    s_barrier
    s_mov_b32 s51, 129024
    s_add_u32 m0, s49, 112128
    s_nop 0
    buffer_load_dwordx4 v244, s[12:15], s51 offen lds
    s_mov_b32 s51, 130048
    s_add_u32 m0, s49, 113152
    s_nop 0
    buffer_load_dwordx4 v244, s[12:15], s51 offen lds
    s_mov_b64 exec, 0xffff
    s_mov_b32 s51, 131072
    s_add_u32 m0, s49, 114176
    s_nop 0
    buffer_load_dwordx4 v244, s[12:15], s51 offen lds
    s_mov_b64 exec, -1
    ds_read_b64_tr_b16 v[16:17], v248 offset:56064
    ds_read_b64_tr_b16 v[18:19], v248 offset:56448
    s_waitcnt lgkmcnt(6)
    v_mfma_f32_32x32x16_bf16 v[24:39], v[20:23], v[216:219], v[24:39]
    ds_read_b64_tr_b16 v[20:21], v248 offset:24864
    ds_read_b64_tr_b16 v[22:23], v248 offset:25248
    s_waitcnt lgkmcnt(6)
    v_mfma_f32_32x32x16_bf16 v[40:55], v[8:11], v[184:187], v[40:55]
    ds_read_b64_tr_b16 v[8:9], v248 offset:3136
    ds_read_b64_tr_b16 v[10:11], v248 offset:3520
    s_waitcnt lgkmcnt(6)
    v_mfma_f32_32x32x16_bf16 v[56:71], v[12:15], v[152:155], v[56:71]
    ds_read_b64_tr_b16 v[12:13], v248 offset:57600
    ds_read_b64_tr_b16 v[14:15], v248 offset:57984
    s_waitcnt lgkmcnt(6)
    v_mfma_f32_32x32x16_bf16 v[24:39], v[16:19], v[220:223], v[24:39]
    ds_read_b64_tr_b16 v[16:17], v248 offset:26400
    ds_read_b64_tr_b16 v[18:19], v248 offset:26784
    s_waitcnt lgkmcnt(6)
    v_mfma_f32_32x32x16_bf16 v[40:55], v[20:23], v[188:191], v[40:55]
    ds_read_b64_tr_b16 v[20:21], v248 offset:4672
    ds_read_b64_tr_b16 v[22:23], v248 offset:5056
    s_waitcnt lgkmcnt(6)
    v_mfma_f32_32x32x16_bf16 v[56:71], v[8:11], v[156:159], v[56:71]
    ds_read_b64_tr_b16 v[8:9], v248 offset:59136
    ds_read_b64_tr_b16 v[10:11], v248 offset:59520
    s_waitcnt lgkmcnt(6)
    v_mfma_f32_32x32x16_bf16 v[24:39], v[12:15], v[224:227], v[24:39]
    ds_read_b64_tr_b16 v[12:13], v248 offset:37408
    ds_read_b64_tr_b16 v[14:15], v248 offset:37792
    s_waitcnt lgkmcnt(6)
    v_mfma_f32_32x32x16_bf16 v[40:55], v[16:19], v[192:195], v[40:55]
    ds_read_b64_tr_b16 v[16:17], v248 offset:6208
    ds_read_b64_tr_b16 v[18:19], v248 offset:6592
    s_waitcnt lgkmcnt(6)
    v_mfma_f32_32x32x16_bf16 v[56:71], v[20:23], v[160:163], v[56:71]
    ds_read_b64_tr_b16 v[20:21], v248 offset:60672
    ds_read_b64_tr_b16 v[22:23], v248 offset:61056
    s_waitcnt lgkmcnt(6)
    v_mfma_f32_32x32x16_bf16 v[24:39], v[8:11], v[228:231], v[24:39]
    ds_read_b64_tr_b16 v[8:9], v248 offset:38944
    ds_read_b64_tr_b16 v[10:11], v248 offset:39328
    s_waitcnt lgkmcnt(6)
    v_mfma_f32_32x32x16_bf16 v[40:55], v[12:15], v[196:199], v[40:55]
    ds_read_b64_tr_b16 v[12:13], v248 offset:7744
    ds_read_b64_tr_b16 v[14:15], v248 offset:8128
    s_waitcnt lgkmcnt(6)
    v_mfma_f32_32x32x16_bf16 v[56:71], v[16:19], v[164:167], v[56:71]
    ds_read_b64_tr_b16 v[16:17], v248 offset:62208
    ds_read_b64_tr_b16 v[18:19], v248 offset:62592
    s_waitcnt lgkmcnt(6)
    v_mfma_f32_32x32x16_bf16 v[24:39], v[20:23], v[232:235], v[24:39]
    ds_read_b64_tr_b16 v[20:21], v248 offset:40480
    ds_read_b64_tr_b16 v[22:23], v248 offset:40864
    s_waitcnt lgkmcnt(6)
    v_mfma_f32_32x32x16_bf16 v[40:55], v[8:11], v[200:203], v[40:55]
    ds_read_b64_tr_b16 v[8:9], v248 offset:18752
    ds_read_b64_tr_b16 v[10:11], v248 offset:19136
    s_waitcnt lgkmcnt(6)
    v_mfma_f32_32x32x16_bf16 v[56:71], v[12:15], v[168:171], v[56:71]
    ds_read_b64_tr_b16 v[12:13], v248 offset:63744
    ds_read_b64_tr_b16 v[14:15], v248 offset:64128
    s_waitcnt lgkmcnt(6)
    v_mfma_f32_32x32x16_bf16 v[24:39], v[16:19], v[236:239], v[24:39]
    ds_read_b64_tr_b16 v[16:17], v248 offset:42016
    ds_read_b64_tr_b16 v[18:19], v248 offset:42400
    s_waitcnt lgkmcnt(6)
    v_mfma_f32_32x32x16_bf16 v[40:55], v[20:23], v[204:207], v[40:55]
    ds_read_b64_tr_b16 v[20:21], v248 offset:20288
    ds_read_b64_tr_b16 v[22:23], v248 offset:20672
    s_waitcnt lgkmcnt(6)
    v_mfma_f32_32x32x16_bf16 v[56:71], v[8:11], v[172:175], v[56:71]
    ds_read_b64_tr_b16 v[8:9], v248 offset:43552
    ds_read_b64_tr_b16 v[10:11], v248 offset:43936
    s_waitcnt lgkmcnt(6)
    v_mfma_f32_32x32x16_bf16 v[24:39], v[12:15], v[240:243], v[24:39]
    ds_read_b64_tr_b16 v[12:13], v248 offset:21824
    ds_read_b64_tr_b16 v[14:15], v248 offset:22208
    s_waitcnt lgkmcnt(6)
    v_mfma_f32_32x32x16_bf16 v[40:55], v[16:19], v[208:211], v[40:55]
    ds_read_b64_tr_b16 v[16:17], v248 offset:45088
    ds_read_b64_tr_b16 v[18:19], v248 offset:45472
    s_waitcnt lgkmcnt(6)
    v_mfma_f32_32x32x16_bf16 v[56:71], v[20:23], v[176:179], v[56:71]
    ds_read_b64_tr_b16 v[20:21], v248 offset:23360
    ds_read_b64_tr_b16 v[22:23], v248 offset:23744
    s_waitcnt lgkmcnt(6)
    v_mfma_f32_32x32x16_bf16 v[40:55], v[8:11], v[212:215], v[40:55]
    v_mul_f32 v72, v24, v24
    v_fma_f32 v72, v72, s53, v250
    v_mul_f32 v72, v72, v24
    v_mul_f32 v73, v25, v25
    v_fma_f32 v73, v73, s53, v250
    ds_read_b64_tr_b16 v[8:9], v248 offset:56096
    ds_read_b64_tr_b16 v[10:11], v248 offset:56480
    s_waitcnt lgkmcnt(6)
    v_mfma_f32_32x32x16_bf16 v[56:71], v[12:15], v[180:183], v[56:71]
    v_mul_f32 v73, v73, v25
    v_mul_f32 v74, v26, v26
    v_fma_f32 v74, v74, s53, v250
    v_mul_f32 v74, v74, v26
    v_mul_f32 v75, v27, v27
    ds_read_b64_tr_b16 v[12:13], v248 offset:24896
    ds_read_b64_tr_b16 v[14:15], v248 offset:25280
    s_waitcnt lgkmcnt(6)
    v_mfma_f32_32x32x16_bf16 v[40:55], v[16:19], v[216:219], v[40:55]
    v_fma_f32 v75, v75, s53, v250
    v_mul_f32 v75, v75, v27
    v_mul_f32 v76, v28, v28
    v_fma_f32 v76, v76, s53, v250
    v_mul_f32 v76, v76, v28
    ds_read_b64_tr_b16 v[16:17], v248 offset:57632
    ds_read_b64_tr_b16 v[18:19], v248 offset:58016
    s_waitcnt lgkmcnt(6)
    v_mfma_f32_32x32x16_bf16 v[56:71], v[20:23], v[184:187], v[56:71]
    v_mul_f32 v77, v29, v29
    v_fma_f32 v77, v77, s53, v250
    v_mul_f32 v77, v77, v29
    v_mul_f32 v78, v30, v30
    v_fma_f32 v78, v78, s53, v250
    ds_read_b64_tr_b16 v[20:21], v248 offset:26432
    ds_read_b64_tr_b16 v[22:23], v248 offset:26816
    s_waitcnt lgkmcnt(6)
    v_mfma_f32_32x32x16_bf16 v[40:55], v[8:11], v[220:223], v[40:55]
    v_mul_f32 v78, v78, v30
    v_mul_f32 v79, v31, v31
    v_fma_f32 v79, v79, s53, v250
    v_mul_f32 v79, v79, v31
    v_exp_f32 v72, v72
    ds_read_b64_tr_b16 v[8:9], v248 offset:59168
    ds_read_b64_tr_b16 v[10:11], v248 offset:59552
    s_waitcnt lgkmcnt(6)
    v_mfma_f32_32x32x16_bf16 v[56:71], v[12:15], v[188:191], v[56:71]
    v_exp_f32 v73, v73
    v_exp_f32 v74, v74
    v_exp_f32 v75, v75
    v_exp_f32 v76, v76
    v_exp_f32 v77, v77
    ds_read_b64_tr_b16 v[12:13], v248 offset:37440
    ds_read_b64_tr_b16 v[14:15], v248 offset:37824
    s_waitcnt lgkmcnt(6)
    v_mfma_f32_32x32x16_bf16 v[40:55], v[16:19], v[224:227], v[40:55]
    v_exp_f32 v78, v78
    v_exp_f32 v79, v79
    v_mul_f32 v80, v24, v32
    v_mul_f32 v81, v25, v33
    v_mul_f32 v82, v26, v34
    ds_read_b64_tr_b16 v[16:17], v248 offset:60704
    ds_read_b64_tr_b16 v[18:19], v248 offset:61088
    s_waitcnt lgkmcnt(6)
    v_mfma_f32_32x32x16_bf16 v[56:71], v[20:23], v[192:195], v[56:71]
    v_mul_f32 v83, v27, v35
    v_mul_f32 v84, v28, v36
    v_mul_f32 v85, v29, v37
    v_mul_f32 v86, v30, v38
    v_mul_f32 v87, v31, v39
    ds_read_b64_tr_b16 v[20:21], v248 offset:38976
    ds_read_b64_tr_b16 v[22:23], v248 offset:39360
    s_waitcnt lgkmcnt(6)
    v_mfma_f32_32x32x16_bf16 v[40:55], v[8:11], v[228:231], v[40:55]
    v_add_f32 v72, 1.0, v72
    v_add_f32 v73, 1.0, v73
    v_add_f32 v74, 1.0, v74
    v_add_f32 v75, 1.0, v75
    v_add_f32 v76, 1.0, v76
    ds_read_b64_tr_b16 v[8:9], v248 offset:62240
    ds_read_b64_tr_b16 v[10:11], v248 offset:62624
    s_waitcnt lgkmcnt(6)
    v_mfma_f32_32x32x16_bf16 v[56:71], v[12:15], v[196:199], v[56:71]
    v_add_f32 v77, 1.0, v77
    v_add_f32 v78, 1.0, v78
    v_add_f32 v79, 1.0, v79
    v_rcp_f32 v72, v72
    v_rcp_f32 v73, v73
    ds_read_b64_tr_b16 v[12:13], v248 offset:40512
    ds_read_b64_tr_b16 v[14:15], v248 offset:40896
    s_waitcnt lgkmcnt(6)
    v_mfma_f32_32x32x16_bf16 v[40:55], v[16:19], v[232:235], v[40:55]
    v_rcp_f32 v74, v74
    v_rcp_f32 v75, v75
    v_rcp_f32 v76, v76
    v_rcp_f32 v77, v77
    v_rcp_f32 v78, v78
    ds_read_b64_tr_b16 v[16:17], v248 offset:63776
    ds_read_b64_tr_b16 v[18:19], v248 offset:64160
    s_waitcnt lgkmcnt(6)
    v_mfma_f32_32x32x16_bf16 v[56:71], v[20:23], v[200:203], v[56:71]
    v_rcp_f32 v79, v79
    s_nop 0
    v_mul_f32 v72, v72, v80
    v_mul_f32 v73, v73, v81
    v_mul_f32 v74, v74, v82
    ds_read_b64_tr_b16 v[20:21], v248 offset:42048
    ds_read_b64_tr_b16 v[22:23], v248 offset:42432
    s_waitcnt lgkmcnt(6)
    v_mfma_f32_32x32x16_bf16 v[40:55], v[8:11], v[236:239], v[40:55]
    v_mul_f32 v75, v75, v83
    v_mul_f32 v76, v76, v84
    v_mul_f32 v77, v77, v85
    v_mul_f32 v78, v78, v86
    v_mul_f32 v79, v79, v87
    s_waitcnt vmcnt(6)
    s_barrier
    s_mov_b32 s51, 138240
    s_add_u32 m0, s49, 130816
    s_nop 0
    buffer_load_dwordx4 v244, s[12:15], s51 offen lds
    s_mov_b32 s51, 139264
    s_add_u32 m0, s49, 131840
    s_nop 0
    buffer_load_dwordx4 v244, s[12:15], s51 offen lds
    s_mov_b64 exec, 0xffff
    s_mov_b32 s51, 140288
    s_add_u32 m0, s49, 132864
    s_nop 0
    buffer_load_dwordx4 v244, s[12:15], s51 offen lds
    s_mov_b64 exec, -1
    ds_read_b64_tr_b16 v[8:9], v251 offset:0
    ds_read_b64_tr_b16 v[10:11], v251 offset:384
    s_waitcnt lgkmcnt(6)
    v_mfma_f32_32x32x16_bf16 v[56:71], v[12:15], v[204:207], v[56:71]
    v_cvt_pk_bf16_f32 v88, v72, v73
    v_cvt_pk_bf16_f32 v89, v74, v75
    v_cvt_pk_bf16_f32 v90, v76, v77
    v_cvt_pk_bf16_f32 v91, v78, v79
    s_nop 1
    ds_read_b64_tr_b16 v[12:13], v248 offset:43584
    ds_read_b64_tr_b16 v[14:15], v248 offset:43968
    s_waitcnt lgkmcnt(6)
    v_mfma_f32_32x32x16_bf16 v[40:55], v[16:19], v[240:243], v[40:55]
    v_permlane32_swap_b32 v88, v90
    v_permlane32_swap_b32 v89, v91
    buffer_store_dwordx4 v[88:91], v249, s[20:23], 0 offen offset:1536
    ds_read_b64_tr_b16 v[16:17], v251 offset:1536
    ds_read_b64_tr_b16 v[18:19], v251 offset:1920
    s_waitcnt lgkmcnt(6)
    v_mfma_f32_32x32x16_bf16 v[56:71], v[20:23], v[208:211], v[56:71]
    ds_read_b64_tr_b16 v[20:21], v248 offset:45120
    ds_read_b64_tr_b16 v[22:23], v248 offset:45504
    s_waitcnt lgkmcnt(6)
    v_mfma_f32_32x32x16_bf16 v[24:39], v[8:11], v[100:103], 0
    ds_read_b64_tr_b16 v[8:9], v251 offset:3072
    ds_read_b64_tr_b16 v[10:11], v251 offset:3456
    s_waitcnt lgkmcnt(6)
    v_mfma_f32_32x32x16_bf16 v[56:71], v[12:15], v[212:215], v[56:71]
    v_mul_f32 v72, v40, v40
    v_fma_f32 v72, v72, s53, v250
    v_mul_f32 v72, v72, v40
    v_mul_f32 v73, v41, v41
    v_fma_f32 v73, v73, s53, v250
    ds_read_b64_tr_b16 v[12:13], v248 offset:56128
    ds_read_b64_tr_b16 v[14:15], v248 offset:56512
    s_waitcnt lgkmcnt(6)
    v_mfma_f32_32x32x16_bf16 v[24:39], v[16:19], v[104:107], v[24:39]
    v_mul_f32 v73, v73, v41
    v_mul_f32 v74, v42, v42
    v_fma_f32 v74, v74, s53, v250
    v_mul_f32 v74, v74, v42
    v_mul_f32 v75, v43, v43
    ds_read_b64_tr_b16 v[16:17], v251 offset:4608
    ds_read_b64_tr_b16 v[18:19], v251 offset:4992
    s_waitcnt lgkmcnt(6)
    v_mfma_f32_32x32x16_bf16 v[56:71], v[20:23], v[216:219], v[56:71]
    v_fma_f32 v75, v75, s53, v250
    v_mul_f32 v75, v75, v43
    v_mul_f32 v76, v44, v44
    v_fma_f32 v76, v76, s53, v250
    v_mul_f32 v76, v76, v44
    ds_read_b64_tr_b16 v[20:21], v248 offset:57664
    ds_read_b64_tr_b16 v[22:23], v248 offset:58048
    s_waitcnt lgkmcnt(6)
    v_mfma_f32_32x32x16_bf16 v[24:39], v[8:11], v[108:111], v[24:39]
    v_mul_f32 v77, v45, v45
    v_fma_f32 v77, v77, s53, v250
    v_mul_f32 v77, v77, v45
    v_mul_f32 v78, v46, v46
    v_fma_f32 v78, v78, s53, v250
    ds_read_b64_tr_b16 v[8:9], v251 offset:6144
    ds_read_b64_tr_b16 v[10:11], v251 offset:6528
    s_waitcnt lgkmcnt(6)
    v_mfma_f32_32x32x16_bf16 v[56:71], v[12:15], v[220:223], v[56:71]
    v_mul_f32 v78, v78, v46
    v_mul_f32 v79, v47, v47
    v_fma_f32 v79, v79, s53, v250
    v_mul_f32 v79, v79, v47
    v_exp_f32 v72, v72
    ds_read_b64_tr_b16 v[12:13], v248 offset:59200
    ds_read_b64_tr_b16 v[14:15], v248 offset:59584
    s_waitcnt lgkmcnt(6)
    v_mfma_f32_32x32x16_bf16 v[24:39], v[16:19], v[112:115], v[24:39]
    v_exp_f32 v73, v73
    v_exp_f32 v74, v74
    v_exp_f32 v75, v75
    v_exp_f32 v76, v76
    v_exp_f32 v77, v77
    ds_read_b64_tr_b16 v[16:17], v251 offset:7680
    ds_read_b64_tr_b16 v[18:19], v251 offset:8064
    s_waitcnt lgkmcnt(6)
    v_mfma_f32_32x32x16_bf16 v[56:71], v[20:23], v[224:227], v[56:71]
    v_exp_f32 v78, v78
    v_exp_f32 v79, v79
    v_mul_f32 v80, v40, v48
    v_mul_f32 v81, v41, v49
    v_mul_f32 v82, v42, v50
    ds_read_b64_tr_b16 v[20:21], v248 offset:60736
    ds_read_b64_tr_b16 v[22:23], v248 offset:61120
    s_waitcnt lgkmcnt(6)
    v_mfma_f32_32x32x16_bf16 v[24:39], v[8:11], v[116:119], v[24:39]
    v_mul_f32 v83, v43, v51
    v_mul_f32 v84, v44, v52
    v_mul_f32 v85, v45, v53
    v_mul_f32 v86, v46, v54
    v_mul_f32 v87, v47, v55
    s_waitcnt vmcnt(7)
    s_barrier
    s_mov_b32 s51, 147456
    s_add_u32 m0, s49, 0
    s_nop 0
    buffer_load_dwordx4 v244, s[12:15], s51 offen lds
    s_mov_b32 s51, 148480
    s_add_u32 m0, s49, 1024
    s_nop 0
    buffer_load_dwordx4 v244, s[12:15], s51 offen lds
    s_mov_b64 exec, 0xffff
    s_mov_b32 s51, 149504
    s_add_u32 m0, s49, 2048
    s_nop 0
    buffer_load_dwordx4 v244, s[12:15], s51 offen lds
    s_mov_b64 exec, -1
    ds_read_b64_tr_b16 v[8:9], v251 offset:18688
    ds_read_b64_tr_b16 v[10:11], v251 offset:19072
    s_waitcnt lgkmcnt(6)
    v_mfma_f32_32x32x16_bf16 v[56:71], v[12:15], v[228:231], v[56:71]
    v_add_f32 v72, 1.0, v72
    v_add_f32 v73, 1.0, v73
    v_add_f32 v74, 1.0, v74
    v_add_f32 v75, 1.0, v75
    v_add_f32 v76, 1.0, v76
    ds_read_b64_tr_b16 v[12:13], v248 offset:62272
    ds_read_b64_tr_b16 v[14:15], v248 offset:62656
    s_waitcnt lgkmcnt(6)
    v_mfma_f32_32x32x16_bf16 v[24:39], v[16:19], v[120:123], v[24:39]
    v_add_f32 v77, 1.0, v77
    v_add_f32 v78, 1.0, v78
    v_add_f32 v79, 1.0, v79
    v_rcp_f32 v72, v72
    v_rcp_f32 v73, v73
    ds_read_b64_tr_b16 v[16:17], v251 offset:20224
    ds_read_b64_tr_b16 v[18:19], v251 offset:20608
    s_waitcnt lgkmcnt(6)
    v_mfma_f32_32x32x16_bf16 v[56:71], v[20:23], v[232:235], v[56:71]
    v_rcp_f32 v74, v74
    v_rcp_f32 v75, v75
    v_rcp_f32 v76, v76
    v_rcp_f32 v77, v77
    v_rcp_f32 v78, v78
    ds_read_b64_tr_b16 v[20:21], v248 offset:63808
    ds_read_b64_tr_b16 v[22:23], v248 offset:64192
    s_waitcnt lgkmcnt(6)
    v_mfma_f32_32x32x16_bf16 v[24:39], v[8:11], v[124:127], v[24:39]
    v_rcp_f32 v79, v79
    s_nop 0
    v_mul_f32 v72, v72, v80
    v_mul_f32 v73, v73, v81
    v_mul_f32 v74, v74, v82
    ds_read_b64_tr_b16 v[8:9], v251 offset:21760
    ds_read_b64_tr_b16 v[10:11], v251 offset:22144
    s_waitcnt lgkmcnt(6)
    v_mfma_f32_32x32x16_bf16 v[56:71], v[12:15], v[236:239], v[56:71]
    v_mul_f32 v75, v75, v83
    v_mul_f32 v76, v76, v84
    v_mul_f32 v77, v77, v85
    v_mul_f32 v78, v78, v86
    v_mul_f32 v79, v79, v87
    ds_read_b64_tr_b16 v[12:13], v251 offset:32
    ds_read_b64_tr_b16 v[14:15], v251 offset:416
    s_waitcnt lgkmcnt(6)
    v_mfma_f32_32x32x16_bf16 v[24:39], v[16:19], v[128:131], v[24:39]
    v_cvt_pk_bf16_f32 v88, v72, v73
    v_cvt_pk_bf16_f32 v89, v74, v75
    v_cvt_pk_bf16_f32 v90, v76, v77
    v_cvt_pk_bf16_f32 v91, v78, v79
    s_nop 1
    ds_read_b64_tr_b16 v[16:17], v251 offset:23296
    ds_read_b64_tr_b16 v[18:19], v251 offset:23680
    s_waitcnt lgkmcnt(6)
    v_mfma_f32_32x32x16_bf16 v[56:71], v[20:23], v[240:243], v[56:71]
    v_permlane32_swap_b32 v88, v90
    v_permlane32_swap_b32 v89, v91
    buffer_store_dwordx4 v[88:91], v249, s[20:23], s54 offen offset:0
    ds_read_b64_tr_b16 v[20:21], v251 offset:1568
    ds_read_b64_tr_b16 v[22:23], v251 offset:1952
    s_waitcnt lgkmcnt(6)
    v_mfma_f32_32x32x16_bf16 v[24:39], v[8:11], v[132:135], v[24:39]
    ds_read_b64_tr_b16 v[8:9], v251 offset:24832
    ds_read_b64_tr_b16 v[10:11], v251 offset:25216
    s_waitcnt lgkmcnt(6)
    v_mfma_f32_32x32x16_bf16 v[40:55], v[12:15], v[100:103], 0
    ds_read_b64_tr_b16 v[12:13], v251 offset:3104
    ds_read_b64_tr_b16 v[14:15], v251 offset:3488
    s_waitcnt lgkmcnt(6)
    v_mfma_f32_32x32x16_bf16 v[24:39], v[16:19], v[136:139], v[24:39]
    v_mul_f32 v72, v56, v56
    v_fma_f32 v72, v72, s53, v250
    v_mul_f32 v72, v72, v56
    v_mul_f32 v73, v57, v57
    v_fma_f32 v73, v73, s53, v250
    ds_read_b64_tr_b16 v[16:17], v251 offset:26368
    ds_read_b64_tr_b16 v[18:19], v251 offset:26752
    s_waitcnt lgkmcnt(6)
    v_mfma_f32_32x32x16_bf16 v[40:55], v[20:23], v[104:107], v[40:55]
    v_mul_f32 v73, v73, v57
    v_mul_f32 v74, v58, v58
    v_fma_f32 v74, v74, s53, v250
    v_mul_f32 v74, v74, v58
    v_mul_f32 v75, v59, v59
    ds_read_b64_tr_b16 v[20:21], v251 offset:4640
    ds_read_b64_tr_b16 v[22:23], v251 offset:5024
    s_waitcnt lgkmcnt(6)
    v_mfma_f32_32x32x16_bf16 v[24:39], v[8:11], v[140:143], v[24:39]
    v_fma_f32 v75, v75, s53, v250
    v_mul_f32 v75, v75, v59
    v_mul_f32 v76, v60, v60
    v_fma_f32 v76, v76, s53, v250
    v_mul_f32 v76, v76, v60
    s_waitcnt vmcnt(8)
    s_barrier
    s_mov_b32 s51, 156672
    s_add_u32 m0, s49, 18688
    s_nop 0
    buffer_load_dwordx4 v244, s[12:15], s51 offen lds
    s_mov_b32 s51, 157696
    s_add_u32 m0, s49, 19712
    s_nop 0
    buffer_load_dwordx4 v244, s[12:15], s51 offen lds
    s_mov_b64 exec, 0xffff
    s_mov_b32 s51, 158720
    s_add_u32 m0, s49, 20736
    s_nop 0
    buffer_load_dwordx4 v244, s[12:15], s51 offen lds
    s_mov_b64 exec, -1
    ds_read_b64_tr_b16 v[8:9], v251 offset:37376
    ds_read_b64_tr_b16 v[10:11], v251 offset:37760
    s_waitcnt lgkmcnt(6)
    v_mfma_f32_32x32x16_bf16 v[40:55], v[12:15], v[108:111], v[40:55]
    v_mul_f32 v77, v61, v61
    v_fma_f32 v77, v77, s53, v250
    v_mul_f32 v77, v77, v61
    v_mul_f32 v78, v62, v62
    v_fma_f32 v78, v78, s53, v250
    ds_read_b64_tr_b16 v[12:13], v251 offset:6176
    ds_read_b64_tr_b16 v[14:15], v251 offset:6560
    s_waitcnt lgkmcnt(6)
    v_mfma_f32_32x32x16_bf16 v[24:39], v[16:19], v[144:147], v[24:39]
    v_mul_f32 v78, v78, v62
    v_mul_f32 v79, v63, v63
    v_fma_f32 v79, v79, s53, v250
    v_mul_f32 v79, v79, v63
    v_exp_f32 v72, v72
    ds_read_b64_tr_b16 v[16:17], v251 offset:38912
    ds_read_b64_tr_b16 v[18:19], v251 offset:39296
    s_waitcnt lgkmcnt(6)
    v_mfma_f32_32x32x16_bf16 v[40:55], v[20:23], v[112:115], v[40:55]
    v_exp_f32 v73, v73
    v_exp_f32 v74, v74
    v_exp_f32 v75, v75
    v_exp_f32 v76, v76
    v_exp_f32 v77, v77
    ds_read_b64_tr_b16 v[20:21], v251 offset:7712
    ds_read_b64_tr_b16 v[22:23], v251 offset:8096
    s_waitcnt lgkmcnt(6)
    v_mfma_f32_32x32x16_bf16 v[24:39], v[8:11], v[148:151], v[24:39]
    v_exp_f32 v78, v78
    v_exp_f32 v79, v79
    v_mul_f32 v80, v56, v64
    v_mul_f32 v81, v57, v65
    v_mul_f32 v82, v58, v66
    ds_read_b64_tr_b16 v[8:9], v251 offset:40448
    ds_read_b64_tr_b16 v[10:11], v251 offset:40832
    s_waitcnt lgkmcnt(6)
    v_mfma_f32_32x32x16_bf16 v[40:55], v[12:15], v[116:119], v[40:55]
    v_mul_f32 v83, v59, v67
    v_mul_f32 v84, v60, v68
    v_mul_f32 v85, v61, v69
    v_mul_f32 v86, v62, v70
    v_mul_f32 v87, v63, v71
    ds_read_b64_tr_b16 v[12:13], v251 offset:18720
    ds_read_b64_tr_b16 v[14:15], v251 offset:19104
    s_waitcnt lgkmcnt(6)
    v_mfma_f32_32x32x16_bf16 v[24:39], v[16:19], v[152:155], v[24:39]
    v_add_f32 v72, 1.0, v72
    v_add_f32 v73, 1.0, v73
    v_add_f32 v74, 1.0, v74
    v_add_f32 v75, 1.0, v75
    v_add_f32 v76, 1.0, v76
    ds_read_b64_tr_b16 v[16:17], v251 offset:41984
    ds_read_b64_tr_b16 v[18:19], v251 offset:42368
    s_waitcnt lgkmcnt(6)
    v_mfma_f32_32x32x16_bf16 v[40:55], v[20:23], v[120:123], v[40:55]
    v_add_f32 v77, 1.0, v77
    v_add_f32 v78, 1.0, v78
    v_add_f32 v79, 1.0, v79
    v_rcp_f32 v72, v72
    v_rcp_f32 v73, v73
    ds_read_b64_tr_b16 v[20:21], v251 offset:20256
    ds_read_b64_tr_b16 v[22:23], v251 offset:20640
    s_waitcnt lgkmcnt(6)
    v_mfma_f32_32x32x16_bf16 v[24:39], v[8:11], v[156:159], v[24:39]
    v_rcp_f32 v74, v74
    v_rcp_f32 v75, v75
    v_rcp_f32 v76, v76
    v_rcp_f32 v77, v77
    v_rcp_f32 v78, v78
    ds_read_b64_tr_b16 v[8:9], v251 offset:43520
    ds_read_b64_tr_b16 v[10:11], v251 offset:43904
    s_waitcnt lgkmcnt(6)
    v_mfma_f32_32x32x16_bf16 v[40:55], v[12:15], v[124:127], v[40:55]
    v_rcp_f32 v79, v79
    s_nop 0
    v_mul_f32 v72, v72, v80
    v_mul_f32 v73, v73, v81
    v_mul_f32 v74, v74, v82
    ds_read_b64_tr_b16 v[12:13], v251 offset:21792
    ds_read_b64_tr_b16 v[14:15], v251 offset:22176
    s_waitcnt lgkmcnt(6)
    v_mfma_f32_32x32x16_bf16 v[24:39], v[16:19], v[160:163], v[24:39]
    v_mul_f32 v75, v75, v83
    v_mul_f32 v76, v76, v84
    v_mul_f32 v77, v77, v85
    v_mul_f32 v78, v78, v86
    v_mul_f32 v79, v79, v87
    ds_read_b64_tr_b16 v[16:17], v251 offset:64
    ds_read_b64_tr_b16 v[18:19], v251 offset:448
    s_waitcnt lgkmcnt(6)
    v_mfma_f32_32x32x16_bf16 v[40:55], v[20:23], v[128:131], v[40:55]
    v_cvt_pk_bf16_f32 v88, v72, v73
    v_cvt_pk_bf16_f32 v89, v74, v75
    v_cvt_pk_bf16_f32 v90, v76, v77
    v_cvt_pk_bf16_f32 v91, v78, v79
    s_nop 1
    ds_read_b64_tr_b16 v[20:21], v251 offset:45056
    ds_read_b64_tr_b16 v[22:23], v251 offset:45440
    s_waitcnt lgkmcnt(6)
    v_mfma_f32_32x32x16_bf16 v[24:39], v[8:11], v[164:167], v[24:39]
    v_permlane32_swap_b32 v88, v90
    v_permlane32_swap_b32 v89, v91
    buffer_store_dwordx4 v[88:91], v249, s[20:23], s54 offen offset:512
    ds_read_b64_tr_b16 v[8:9], v251 offset:23328
    ds_read_b64_tr_b16 v[10:11], v251 offset:23712
    s_waitcnt lgkmcnt(6)
    v_mfma_f32_32x32x16_bf16 v[40:55], v[12:15], v[132:135], v[40:55]
    ds_read_b64_tr_b16 v[12:13], v251 offset:1600
    ds_read_b64_tr_b16 v[14:15], v251 offset:1984
    s_waitcnt lgkmcnt(6)
    v_mfma_f32_32x32x16_bf16 v[56:71], v[16:19], v[100:103], 0
    s_waitcnt vmcnt(9)
    s_barrier
    ds_read_b64_tr_b16 v[16:17], v251 offset:56064
    ds_read_b64_tr_b16 v[18:19], v251 offset:56448
    s_waitcnt lgkmcnt(6)
    v_mfma_f32_32x32x16_bf16 v[24:39], v[20:23], v[168:171], v[24:39]
    ds_read_b64_tr_b16 v[20:21], v251 offset:24864
    ds_read_b64_tr_b16 v[22:23], v251 offset:25248
    s_waitcnt lgkmcnt(6)
    v_mfma_f32_32x32x16_bf16 v[40:55], v[8:11], v[136:139], v[40:55]
    ds_read_b64_tr_b16 v[8:9], v251 offset:3136
    ds_read_b64_tr_b16 v[10:11], v251 offset:3520
    s_waitcnt lgkmcnt(6)
    v_mfma_f32_32x32x16_bf16 v[56:71], v[12:15], v[104:107], v[56:71]
    ds_read_b64_tr_b16 v[12:13], v251 offset:57600
    ds_read_b64_tr_b16 v[14:15], v251 offset:57984
    s_waitcnt lgkmcnt(6)
    v_mfma_f32_32x32x16_bf16 v[24:39], v[16:19], v[172:175], v[24:39]
    ds_read_b64_tr_b16 v[16:17], v251 offset:26400
    ds_read_b64_tr_b16 v[18:19], v251 offset:26784
    s_waitcnt lgkmcnt(6)
    v_mfma_f32_32x32x16_bf16 v[40:55], v[20:23], v[140:143], v[40:55]
    ds_read_b64_tr_b16 v[20:21], v251 offset:4672
    ds_read_b64_tr_b16 v[22:23], v251 offset:5056
    s_waitcnt lgkmcnt(6)
    v_mfma_f32_32x32x16_bf16 v[56:71], v[8:11], v[108:111], v[56:71]
    ds_read_b64_tr_b16 v[8:9], v251 offset:59136
    ds_read_b64_tr_b16 v[10:11], v251 offset:59520
    s_waitcnt lgkmcnt(6)
    v_mfma_f32_32x32x16_bf16 v[24:39], v[12:15], v[176:179], v[24:39]
    ds_read_b64_tr_b16 v[12:13], v251 offset:37408
    ds_read_b64_tr_b16 v[14:15], v251 offset:37792
    s_waitcnt lgkmcnt(6)
    v_mfma_f32_32x32x16_bf16 v[40:55], v[16:19], v[144:147], v[40:55]
    ds_read_b64_tr_b16 v[16:17], v251 offset:6208
    ds_read_b64_tr_b16 v[18:19], v251 offset:6592
    s_waitcnt lgkmcnt(6)
    v_mfma_f32_32x32x16_bf16 v[56:71], v[20:23], v[112:115], v[56:71]
    ds_read_b64_tr_b16 v[20:21], v251 offset:60672
    ds_read_b64_tr_b16 v[22:23], v251 offset:61056
    s_waitcnt lgkmcnt(6)
    v_mfma_f32_32x32x16_bf16 v[24:39], v[8:11], v[180:183], v[24:39]
    ds_read_b64_tr_b16 v[8:9], v251 offset:38944
    ds_read_b64_tr_b16 v[10:11], v251 offset:39328
    s_waitcnt lgkmcnt(6)
    v_mfma_f32_32x32x16_bf16 v[40:55], v[12:15], v[148:151], v[40:55]
    ds_read_b64_tr_b16 v[12:13], v251 offset:7744
    ds_read_b64_tr_b16 v[14:15], v251 offset:8128
    s_waitcnt lgkmcnt(6)
    v_mfma_f32_32x32x16_bf16 v[56:71], v[16:19], v[116:119], v[56:71]
    ds_read_b64_tr_b16 v[16:17], v251 offset:62208
    ds_read_b64_tr_b16 v[18:19], v251 offset:62592
    s_waitcnt lgkmcnt(6)
    v_mfma_f32_32x32x16_bf16 v[24:39], v[20:23], v[184:187], v[24:39]
    ds_read_b64_tr_b16 v[20:21], v251 offset:40480
    ds_read_b64_tr_b16 v[22:23], v251 offset:40864
    s_waitcnt lgkmcnt(6)
    v_mfma_f32_32x32x16_bf16 v[40:55], v[8:11], v[152:155], v[40:55]
    ds_read_b64_tr_b16 v[8:9], v251 offset:18752
    ds_read_b64_tr_b16 v[10:11], v251 offset:19136
    s_waitcnt lgkmcnt(6)
    v_mfma_f32_32x32x16_bf16 v[56:71], v[12:15], v[120:123], v[56:71]
    ds_read_b64_tr_b16 v[12:13], v251 offset:63744
    ds_read_b64_tr_b16 v[14:15], v251 offset:64128
    s_waitcnt lgkmcnt(6)
    v_mfma_f32_32x32x16_bf16 v[24:39], v[16:19], v[188:191], v[24:39]
    ds_read_b64_tr_b16 v[16:17], v251 offset:42016
    ds_read_b64_tr_b16 v[18:19], v251 offset:42400
    s_waitcnt lgkmcnt(6)
    v_mfma_f32_32x32x16_bf16 v[40:55], v[20:23], v[156:159], v[40:55]
    ds_read_b64_tr_b16 v[20:21], v251 offset:20288
    ds_read_b64_tr_b16 v[22:23], v251 offset:20672
    s_waitcnt lgkmcnt(6)
    v_mfma_f32_32x32x16_bf16 v[56:71], v[8:11], v[124:127], v[56:71]
    s_waitcnt vmcnt(5)
    s_barrier
    ds_read_b64_tr_b16 v[8:9], v248 offset:0
    ds_read_b64_tr_b16 v[10:11], v248 offset:384
    s_waitcnt lgkmcnt(6)
    v_mfma_f32_32x32x16_bf16 v[24:39], v[12:15], v[192:195], v[24:39]
    ds_read_b64_tr_b16 v[12:13], v251 offset:43552
    ds_read_b64_tr_b16 v[14:15], v251 offset:43936
    s_waitcnt lgkmcnt(6)
    v_mfma_f32_32x32x16_bf16 v[40:55], v[16:19], v[160:163], v[40:55]
    ds_read_b64_tr_b16 v[16:17], v251 offset:21824
    ds_read_b64_tr_b16 v[18:19], v251 offset:22208
    s_waitcnt lgkmcnt(6)
    v_mfma_f32_32x32x16_bf16 v[56:71], v[20:23], v[128:131], v[56:71]
    ds_read_b64_tr_b16 v[20:21], v248 offset:1536
    ds_read_b64_tr_b16 v[22:23], v248 offset:1920
    s_waitcnt lgkmcnt(6)
    v_mfma_f32_32x32x16_bf16 v[24:39], v[8:11], v[196:199], v[24:39]
    ds_read_b64_tr_b16 v[8:9], v251 offset:45088
    ds_read_b64_tr_b16 v[10:11], v251 offset:45472
    s_waitcnt lgkmcnt(6)
    v_mfma_f32_32x32x16_bf16 v[40:55], v[12:15], v[164:167], v[40:55]
    ds_read_b64_tr_b16 v[12:13], v251 offset:23360
    ds_read_b64_tr_b16 v[14:15], v251 offset:23744
    s_waitcnt lgkmcnt(6)
    v_mfma_f32_32x32x16_bf16 v[56:71], v[16:19], v[132:135], v[56:71]
    ds_read_b64_tr_b16 v[16:17], v248 offset:3072
    ds_read_b64_tr_b16 v[18:19], v248 offset:3456
    s_waitcnt lgkmcnt(6)
    v_mfma_f32_32x32x16_bf16 v[24:39], v[20:23], v[200:203], v[24:39]
    ds_read_b64_tr_b16 v[20:21], v251 offset:56096
    ds_read_b64_tr_b16 v[22:23], v251 offset:56480
    s_waitcnt lgkmcnt(6)
    v_mfma_f32_32x32x16_bf16 v[40:55], v[8:11], v[168:171], v[40:55]
    ds_read_b64_tr_b16 v[8:9], v251 offset:24896
    ds_read_b64_tr_b16 v[10:11], v251 offset:25280
    s_waitcnt lgkmcnt(6)
    v_mfma_f32_32x32x16_bf16 v[56:71], v[12:15], v[136:139], v[56:71]
    ds_read_b64_tr_b16 v[12:13], v248 offset:4608
    ds_read_b64_tr_b16 v[14:15], v248 offset:4992
    s_waitcnt lgkmcnt(6)
    v_mfma_f32_32x32x16_bf16 v[24:39], v[16:19], v[204:207], v[24:39]
    ds_read_b64_tr_b16 v[16:17], v251 offset:57632
    ds_read_b64_tr_b16 v[18:19], v251 offset:58016
    s_waitcnt lgkmcnt(6)
    v_mfma_f32_32x32x16_bf16 v[40:55], v[20:23], v[172:175], v[40:55]
    ds_read_b64_tr_b16 v[20:21], v251 offset:26432
    ds_read_b64_tr_b16 v[22:23], v251 offset:26816
    s_waitcnt lgkmcnt(6)
    v_mfma_f32_32x32x16_bf16 v[56:71], v[8:11], v[140:143], v[56:71]
    ds_read_b64_tr_b16 v[8:9], v248 offset:6144
    ds_read_b64_tr_b16 v[10:11], v248 offset:6528
    s_waitcnt lgkmcnt(6)
    v_mfma_f32_32x32x16_bf16 v[24:39], v[12:15], v[208:211], v[24:39]
    ds_read_b64_tr_b16 v[12:13], v251 offset:59168
    ds_read_b64_tr_b16 v[14:15], v251 offset:59552
    s_waitcnt lgkmcnt(6)
    v_mfma_f32_32x32x16_bf16 v[40:55], v[16:19], v[176:179], v[40:55]
    ds_read_b64_tr_b16 v[16:17], v251 offset:37440
    ds_read_b64_tr_b16 v[18:19], v251 offset:37824
    s_waitcnt lgkmcnt(6)
    v_mfma_f32_32x32x16_bf16 v[56:71], v[20:23], v[144:147], v[56:71]
    ds_read_b64_tr_b16 v[20:21], v248 offset:7680
    ds_read_b64_tr_b16 v[22:23], v248 offset:8064
    s_waitcnt lgkmcnt(6)
    v_mfma_f32_32x32x16_bf16 v[24:39], v[8:11], v[212:215], v[24:39]
    ds_read_b64_tr_b16 v[8:9], v251 offset:60704
    ds_read_b64_tr_b16 v[10:11], v251 offset:61088
    s_waitcnt lgkmcnt(6)
    v_mfma_f32_32x32x16_bf16 v[40:55], v[12:15], v[180:183], v[40:55]
    ds_read_b64_tr_b16 v[12:13], v251 offset:38976
    ds_read_b64_tr_b16 v[14:15], v251 offset:39360
    s_waitcnt lgkmcnt(6)
    v_mfma_f32_32x32x16_bf16 v[56:71], v[16:19], v[148:151], v[56:71]
    s_waitcnt vmcnt(1)
    s_barrier
    ds_read_b64_tr_b16 v[16:17], v248 offset:18688
    ds_read_b64_tr_b16 v[18:19], v248 offset:19072
    s_waitcnt lgkmcnt(6)
    v_mfma_f32_32x32x16_bf16 v[24:39], v[20:23], v[216:219], v[24:39]
    ds_read_b64_tr_b16 v[20:21], v251 offset:62240
    ds_read_b64_tr_b16 v[22:23], v251 offset:62624
    s_waitcnt lgkmcnt(6)
    v_mfma_f32_32x32x16_bf16 v[40:55], v[8:11], v[184:187], v[40:55]
    ds_read_b64_tr_b16 v[8:9], v251 offset:40512
    ds_read_b64_tr_b16 v[10:11], v251 offset:40896
    s_waitcnt lgkmcnt(6)
    v_mfma_f32_32x32x16_bf16 v[56:71], v[12:15], v[152:155], v[56:71]
    ds_read_b64_tr_b16 v[12:13], v248 offset:20224
    ds_read_b64_tr_b16 v[14:15], v248 offset:20608
    s_waitcnt lgkmcnt(6)
    v_mfma_f32_32x32x16_bf16 v[24:39], v[16:19], v[220:223], v[24:39]
    ds_read_b64_tr_b16 v[16:17], v251 offset:63776
    ds_read_b64_tr_b16 v[18:19], v251 offset:64160
    s_waitcnt lgkmcnt(6)
    v_mfma_f32_32x32x16_bf16 v[40:55], v[20:23], v[188:191], v[40:55]
    ds_read_b64_tr_b16 v[20:21], v251 offset:42048
    ds_read_b64_tr_b16 v[22:23], v251 offset:42432
    s_waitcnt lgkmcnt(6)
    v_mfma_f32_32x32x16_bf16 v[56:71], v[8:11], v[156:159], v[56:71]
    ds_read_b64_tr_b16 v[8:9], v248 offset:21760
    ds_read_b64_tr_b16 v[10:11], v248 offset:22144
    s_waitcnt lgkmcnt(6)
    v_mfma_f32_32x32x16_bf16 v[24:39], v[12:15], v[224:227], v[24:39]
    ds_read_b64_tr_b16 v[12:13], v248 offset:32
    ds_read_b64_tr_b16 v[14:15], v248 offset:416
    s_waitcnt lgkmcnt(6)
    v_mfma_f32_32x32x16_bf16 v[40:55], v[16:19], v[192:195], v[40:55]
    ds_read_b64_tr_b16 v[16:17], v251 offset:43584
    ds_read_b64_tr_b16 v[18:19], v251 offset:43968
    s_waitcnt lgkmcnt(6)
    v_mfma_f32_32x32x16_bf16 v[56:71], v[20:23], v[160:163], v[56:71]
    ds_read_b64_tr_b16 v[20:21], v248 offset:23296
    ds_read_b64_tr_b16 v[22:23], v248 offset:23680
    s_waitcnt lgkmcnt(6)
    v_mfma_f32_32x32x16_bf16 v[24:39], v[8:11], v[228:231], v[24:39]
    ds_read_b64_tr_b16 v[8:9], v248 offset:1568
    ds_read_b64_tr_b16 v[10:11], v248 offset:1952
    s_waitcnt lgkmcnt(6)
    v_mfma_f32_32x32x16_bf16 v[40:55], v[12:15], v[196:199], v[40:55]
    ds_read_b64_tr_b16 v[12:13], v251 offset:45120
    ds_read_b64_tr_b16 v[14:15], v251 offset:45504
    s_waitcnt lgkmcnt(6)
    v_mfma_f32_32x32x16_bf16 v[56:71], v[16:19], v[164:167], v[56:71]
    ds_read_b64_tr_b16 v[16:17], v248 offset:24832
    ds_read_b64_tr_b16 v[18:19], v248 offset:25216
    s_waitcnt lgkmcnt(6)
    v_mfma_f32_32x32x16_bf16 v[24:39], v[20:23], v[232:235], v[24:39]
    ds_read_b64_tr_b16 v[20:21], v248 offset:3104
    ds_read_b64_tr_b16 v[22:23], v248 offset:3488
    s_waitcnt lgkmcnt(6)
    v_mfma_f32_32x32x16_bf16 v[40:55], v[8:11], v[200:203], v[40:55]
    ds_read_b64_tr_b16 v[8:9], v251 offset:56128
    ds_read_b64_tr_b16 v[10:11], v251 offset:56512
    s_waitcnt lgkmcnt(6)
    v_mfma_f32_32x32x16_bf16 v[56:71], v[12:15], v[168:171], v[56:71]
    ds_read_b64_tr_b16 v[12:13], v248 offset:26368
    ds_read_b64_tr_b16 v[14:15], v248 offset:26752
    s_waitcnt lgkmcnt(6)
    v_mfma_f32_32x32x16_bf16 v[24:39], v[16:19], v[236:239], v[24:39]
    ds_read_b64_tr_b16 v[16:17], v248 offset:4640
    ds_read_b64_tr_b16 v[18:19], v248 offset:5024
    s_waitcnt lgkmcnt(6)
    v_mfma_f32_32x32x16_bf16 v[40:55], v[20:23], v[204:207], v[40:55]
    ds_read_b64_tr_b16 v[20:21], v251 offset:57664
    ds_read_b64_tr_b16 v[22:23], v251 offset:58048
    s_waitcnt lgkmcnt(6)
    v_mfma_f32_32x32x16_bf16 v[56:71], v[8:11], v[172:175], v[56:71]
    ds_read_b64_tr_b16 v[8:9], v248 offset:6176
    ds_read_b64_tr_b16 v[10:11], v248 offset:6560
    s_waitcnt lgkmcnt(6)
    v_mfma_f32_32x32x16_bf16 v[24:39], v[12:15], v[240:243], v[24:39]
    ds_read_b64_tr_b16 v[12:13], v251 offset:59200
    ds_read_b64_tr_b16 v[14:15], v251 offset:59584
    s_waitcnt lgkmcnt(6)
    v_mfma_f32_32x32x16_bf16 v[40:55], v[16:19], v[208:211], v[40:55]
    ds_read_b64_tr_b16 v[16:17], v248 offset:7712
    ds_read_b64_tr_b16 v[18:19], v248 offset:8096
    s_waitcnt lgkmcnt(6)
    v_mfma_f32_32x32x16_bf16 v[56:71], v[20:23], v[176:179], v[56:71]
    ds_read_b64_tr_b16 v[20:21], v251 offset:60736
    ds_read_b64_tr_b16 v[22:23], v251 offset:61120
    s_waitcnt lgkmcnt(6)
    v_mfma_f32_32x32x16_bf16 v[40:55], v[8:11], v[212:215], v[40:55]
    v_mul_f32 v72, v24, v24
    v_fma_f32 v72, v72, s53, v250
    v_mul_f32 v72, v72, v24
    v_mul_f32 v73, v25, v25
    v_fma_f32 v73, v73, s53, v250
    ds_read_b64_tr_b16 v[8:9], v248 offset:18720
    ds_read_b64_tr_b16 v[10:11], v248 offset:19104
    s_waitcnt lgkmcnt(6)
    v_mfma_f32_32x32x16_bf16 v[56:71], v[12:15], v[180:183], v[56:71]
    v_mul_f32 v73, v73, v25
    v_mul_f32 v74, v26, v26
    v_fma_f32 v74, v74, s53, v250
    v_mul_f32 v74, v74, v26
    v_mul_f32 v75, v27, v27
    ds_read_b64_tr_b16 v[12:13], v251 offset:62272
    ds_read_b64_tr_b16 v[14:15], v251 offset:62656
    s_waitcnt lgkmcnt(6)
    v_mfma_f32_32x32x16_bf16 v[40:55], v[16:19], v[216:219], v[40:55]
    v_fma_f32 v75, v75, s53, v250
    v_mul_f32 v75, v75, v27
    v_mul_f32 v76, v28, v28
    v_fma_f32 v76, v76, s53, v250
    v_mul_f32 v76, v76, v28
    ds_read_b64_tr_b16 v[16:17], v248 offset:20256
    ds_read_b64_tr_b16 v[18:19], v248 offset:20640
    s_waitcnt lgkmcnt(6)
    v_mfma_f32_32x32x16_bf16 v[56:71], v[20:23], v[184:187], v[56:71]
    v_mul_f32 v77, v29, v29
    v_fma_f32 v77, v77, s53, v250
    v_mul_f32 v77, v77, v29
    v_mul_f32 v78, v30, v30
    v_fma_f32 v78, v78, s53, v250
    ds_read_b64_tr_b16 v[20:21], v251 offset:63808
    ds_read_b64_tr_b16 v[22:23], v251 offset:64192
    s_waitcnt lgkmcnt(6)
    v_mfma_f32_32x32x16_bf16 v[40:55], v[8:11], v[220:223], v[40:55]
    v_mul_f32 v78, v78, v30
    v_mul_f32 v79, v31, v31
    v_fma_f32 v79, v79, s53, v250
    v_mul_f32 v79, v79, v31
    v_exp_f32 v72, v72
    ds_read_b64_tr_b16 v[8:9], v248 offset:21792
    ds_read_b64_tr_b16 v[10:11], v248 offset:22176
    s_waitcnt lgkmcnt(6)
    v_mfma_f32_32x32x16_bf16 v[56:71], v[12:15], v[188:191], v[56:71]
    v_exp_f32 v73, v73
    v_exp_f32 v74, v74
    v_exp_f32 v75, v75
    v_exp_f32 v76, v76
    v_exp_f32 v77, v77
    ds_read_b64_tr_b16 v[12:13], v248 offset:64
    ds_read_b64_tr_b16 v[14:15], v248 offset:448
    s_waitcnt lgkmcnt(6)
    v_mfma_f32_32x32x16_bf16 v[40:55], v[16:19], v[224:227], v[40:55]
    v_exp_f32 v78, v78
    v_exp_f32 v79, v79
    v_mul_f32 v80, v24, v32
    v_mul_f32 v81, v25, v33
    v_mul_f32 v82, v26, v34
    ds_read_b64_tr_b16 v[16:17], v248 offset:23328
    ds_read_b64_tr_b16 v[18:19], v248 offset:23712
    s_waitcnt lgkmcnt(6)
    v_mfma_f32_32x32x16_bf16 v[56:71], v[20:23], v[192:195], v[56:71]
    v_mul_f32 v83, v27, v35
    v_mul_f32 v84, v28, v36
    v_mul_f32 v85, v29, v37
    v_mul_f32 v86, v30, v38
    v_mul_f32 v87, v31, v39
    ds_read_b64_tr_b16 v[20:21], v248 offset:1600
    ds_read_b64_tr_b16 v[22:23], v248 offset:1984
    s_waitcnt lgkmcnt(6)
    v_mfma_f32_32x32x16_bf16 v[40:55], v[8:11], v[228:231], v[40:55]
    v_add_f32 v72, 1.0, v72
    v_add_f32 v73, 1.0, v73
    v_add_f32 v74, 1.0, v74
    v_add_f32 v75, 1.0, v75
    v_add_f32 v76, 1.0, v76
    ds_read_b64_tr_b16 v[8:9], v248 offset:24864
    ds_read_b64_tr_b16 v[10:11], v248 offset:25248
    s_waitcnt lgkmcnt(6)
    v_mfma_f32_32x32x16_bf16 v[56:71], v[12:15], v[196:199], v[56:71]
    v_add_f32 v77, 1.0, v77
    v_add_f32 v78, 1.0, v78
    v_add_f32 v79, 1.0, v79
    v_rcp_f32 v72, v72
    v_rcp_f32 v73, v73
    ds_read_b64_tr_b16 v[12:13], v248 offset:3136
    ds_read_b64_tr_b16 v[14:15], v248 offset:3520
    s_waitcnt lgkmcnt(6)
    v_mfma_f32_32x32x16_bf16 v[40:55], v[16:19], v[232:235], v[40:55]
    v_rcp_f32 v74, v74
    v_rcp_f32 v75, v75
    v_rcp_f32 v76, v76
    v_rcp_f32 v77, v77
    v_rcp_f32 v78, v78
    ds_read_b64_tr_b16 v[16:17], v248 offset:26400
    ds_read_b64_tr_b16 v[18:19], v248 offset:26784
    s_waitcnt lgkmcnt(6)
    v_mfma_f32_32x32x16_bf16 v[56:71], v[20:23], v[200:203], v[56:71]
    v_rcp_f32 v79, v79
    s_nop 0
    v_mul_f32 v72, v72, v80
    v_mul_f32 v73, v73, v81
    v_mul_f32 v74, v74, v82
    ds_read_b64_tr_b16 v[20:21], v248 offset:4672
    ds_read_b64_tr_b16 v[22:23], v248 offset:5056
    s_waitcnt lgkmcnt(6)
    v_mfma_f32_32x32x16_bf16 v[40:55], v[8:11], v[236:239], v[40:55]
    v_mul_f32 v75, v75, v83
    v_mul_f32 v76, v76, v84
    v_mul_f32 v77, v77, v85
    v_mul_f32 v78, v78, v86
    v_mul_f32 v79, v79, v87
    ds_read_b64_tr_b16 v[8:9], v248 offset:6208
    ds_read_b64_tr_b16 v[10:11], v248 offset:6592
    s_waitcnt lgkmcnt(6)
    v_mfma_f32_32x32x16_bf16 v[56:71], v[12:15], v[204:207], v[56:71]
    v_cvt_pk_bf16_f32 v88, v72, v73
    v_cvt_pk_bf16_f32 v89, v74, v75
    v_cvt_pk_bf16_f32 v90, v76, v77
    v_cvt_pk_bf16_f32 v91, v78, v79
    s_nop 1
    ds_read_b64_tr_b16 v[12:13], v248 offset:7744
    ds_read_b64_tr_b16 v[14:15], v248 offset:8128
    s_waitcnt lgkmcnt(6)
    v_mfma_f32_32x32x16_bf16 v[40:55], v[16:19], v[240:243], v[40:55]
    v_permlane32_swap_b32 v88, v90
    v_permlane32_swap_b32 v89, v91
    buffer_store_dwordx4 v[88:91], v249, s[20:23], s54 offen offset:1024
    ds_read_b64_tr_b16 v[16:17], v248 offset:18752
    ds_read_b64_tr_b16 v[18:19], v248 offset:19136
    s_waitcnt lgkmcnt(6)
    v_mfma_f32_32x32x16_bf16 v[56:71], v[20:23], v[208:211], v[56:71]
    ds_read_b64_tr_b16 v[20:21], v248 offset:20288
    ds_read_b64_tr_b16 v[22:23], v248 offset:20672
    s_waitcnt lgkmcnt(6)
    v_mfma_f32_32x32x16_bf16 v[56:71], v[8:11], v[212:215], v[56:71]
    ds_read_b64_tr_b16 v[8:9], v248 offset:21824
    ds_read_b64_tr_b16 v[10:11], v248 offset:22208
    s_waitcnt lgkmcnt(6)
    v_mfma_f32_32x32x16_bf16 v[56:71], v[12:15], v[216:219], v[56:71]
    v_mul_f32 v72, v40, v40
    v_fma_f32 v72, v72, s53, v250
    v_mul_f32 v72, v72, v40
    v_mul_f32 v73, v41, v41
    v_fma_f32 v73, v73, s53, v250
    v_mul_f32 v73, v73, v41
    v_mul_f32 v74, v42, v42
    v_fma_f32 v74, v74, s53, v250
    v_mul_f32 v74, v74, v42
    v_mul_f32 v75, v43, v43
    v_fma_f32 v75, v75, s53, v250
    ds_read_b64_tr_b16 v[12:13], v248 offset:23360
    ds_read_b64_tr_b16 v[14:15], v248 offset:23744
    s_waitcnt lgkmcnt(6)
    v_mfma_f32_32x32x16_bf16 v[56:71], v[16:19], v[220:223], v[56:71]
    v_mul_f32 v75, v75, v43
    v_mul_f32 v76, v44, v44
    v_fma_f32 v76, v76, s53, v250
    v_mul_f32 v76, v76, v44
    v_mul_f32 v77, v45, v45
    v_fma_f32 v77, v77, s53, v250
    v_mul_f32 v77, v77, v45
    v_mul_f32 v78, v46, v46
    v_fma_f32 v78, v78, s53, v250
    v_mul_f32 v78, v78, v46
    v_mul_f32 v79, v47, v47
    ds_read_b64_tr_b16 v[16:17], v248 offset:24896
    ds_read_b64_tr_b16 v[18:19], v248 offset:25280
    s_waitcnt lgkmcnt(6)
    v_mfma_f32_32x32x16_bf16 v[56:71], v[20:23], v[224:227], v[56:71]
    v_fma_f32 v79, v79, s53, v250
    v_mul_f32 v79, v79, v47
    v_exp_f32 v72, v72
    v_exp_f32 v73, v73
    v_exp_f32 v74, v74
    v_exp_f32 v75, v75
    v_exp_f32 v76, v76
    v_exp_f32 v77, v77
    v_exp_f32 v78, v78
    v_exp_f32 v79, v79
    v_mul_f32 v80, v40, v48
    ds_read_b64_tr_b16 v[20:21], v248 offset:26432
    ds_read_b64_tr_b16 v[22:23], v248 offset:26816
    s_waitcnt lgkmcnt(6)
    v_mfma_f32_32x32x16_bf16 v[56:71], v[8:11], v[228:231], v[56:71]
    v_mul_f32 v81, v41, v49
    v_mul_f32 v82, v42, v50
    v_mul_f32 v83, v43, v51
    v_mul_f32 v84, v44, v52
    v_mul_f32 v85, v45, v53
    v_mul_f32 v86, v46, v54
    v_mul_f32 v87, v47, v55
    v_add_f32 v72, 1.0, v72
    v_add_f32 v73, 1.0, v73
    v_add_f32 v74, 1.0, v74
    v_add_f32 v75, 1.0, v75
    s_waitcnt lgkmcnt(4)
    v_mfma_f32_32x32x16_bf16 v[56:71], v[12:15], v[232:235], v[56:71]
    v_add_f32 v76, 1.0, v76
    v_add_f32 v77, 1.0, v77
    v_add_f32 v78, 1.0, v78
    v_add_f32 v79, 1.0, v79
    v_rcp_f32 v72, v72
    v_rcp_f32 v73, v73
    v_rcp_f32 v74, v74
    v_rcp_f32 v75, v75
    v_rcp_f32 v76, v76
    v_rcp_f32 v77, v77
    v_rcp_f32 v78, v78
    s_waitcnt lgkmcnt(2)
    v_mfma_f32_32x32x16_bf16 v[56:71], v[16:19], v[236:239], v[56:71]
    v_rcp_f32 v79, v79
    s_nop 0
    v_mul_f32 v72, v72, v80
    v_mul_f32 v73, v73, v81
    v_mul_f32 v74, v74, v82
    v_mul_f32 v75, v75, v83
    v_mul_f32 v76, v76, v84
    v_mul_f32 v77, v77, v85
    v_mul_f32 v78, v78, v86
    v_mul_f32 v79, v79, v87
    v_cvt_pk_bf16_f32 v88, v72, v73
    s_waitcnt lgkmcnt(0)
    v_mfma_f32_32x32x16_bf16 v[56:71], v[20:23], v[240:243], v[56:71]
    v_cvt_pk_bf16_f32 v89, v74, v75
    v_cvt_pk_bf16_f32 v90, v76, v77
    v_cvt_pk_bf16_f32 v91, v78, v79
    s_nop 1
    v_permlane32_swap_b32 v88, v90
    v_permlane32_swap_b32 v89, v91
    buffer_store_dwordx4 v[88:91], v249, s[20:23], s54 offen offset:1536
    s_nop 13
    v_mul_f32 v72, v56, v56
    v_fma_f32 v72, v72, s53, v250
    v_mul_f32 v72, v72, v56
    v_mul_f32 v73, v57, v57
    v_fma_f32 v73, v73, s53, v250
    v_mul_f32 v73, v73, v57
    v_mul_f32 v74, v58, v58
    v_fma_f32 v74, v74, s53, v250
    v_mul_f32 v74, v74, v58
    v_mul_f32 v75, v59, v59
    v_fma_f32 v75, v75, s53, v250
    v_mul_f32 v75, v75, v59
    v_mul_f32 v76, v60, v60
    v_fma_f32 v76, v76, s53, v250
    v_mul_f32 v76, v76, v60
    v_mul_f32 v77, v61, v61
    v_fma_f32 v77, v77, s53, v250
    v_mul_f32 v77, v77, v61
    v_mul_f32 v78, v62, v62
    v_fma_f32 v78, v78, s53, v250
    v_mul_f32 v78, v78, v62
    v_mul_f32 v79, v63, v63
    v_fma_f32 v79, v79, s53, v250
    v_mul_f32 v79, v79, v63
    v_exp_f32 v72, v72
    v_exp_f32 v73, v73
    v_exp_f32 v74, v74
    v_exp_f32 v75, v75
    v_exp_f32 v76, v76
    v_exp_f32 v77, v77
    v_exp_f32 v78, v78
    v_exp_f32 v79, v79
    v_mul_f32 v80, v56, v64
    v_mul_f32 v81, v57, v65
    v_mul_f32 v82, v58, v66
    v_mul_f32 v83, v59, v67
    v_mul_f32 v84, v60, v68
    v_mul_f32 v85, v61, v69
    v_mul_f32 v86, v62, v70
    v_mul_f32 v87, v63, v71
    v_add_f32 v72, 1.0, v72
    v_add_f32 v73, 1.0, v73
    v_add_f32 v74, 1.0, v74
    v_add_f32 v75, 1.0, v75
    v_add_f32 v76, 1.0, v76
    v_add_f32 v77, 1.0, v77
    v_add_f32 v78, 1.0, v78
    v_add_f32 v79, 1.0, v79
    v_rcp_f32 v72, v72
    v_rcp_f32 v73, v73
    v_rcp_f32 v74, v74
    v_rcp_f32 v75, v75
    v_rcp_f32 v76, v76
    v_rcp_f32 v77, v77
    v_rcp_f32 v78, v78
    v_rcp_f32 v79, v79
    s_nop 0
    v_mul_f32 v72, v72, v80
    v_mul_f32 v73, v73, v81
    v_mul_f32 v74, v74, v82
    v_mul_f32 v75, v75, v83
    v_mul_f32 v76, v76, v84
    v_mul_f32 v77, v77, v85
    v_mul_f32 v78, v78, v86
    v_mul_f32 v79, v79, v87
    v_cvt_pk_bf16_f32 v88, v72, v73
    v_cvt_pk_bf16_f32 v89, v74, v75
    v_cvt_pk_bf16_f32 v90, v76, v77
    v_cvt_pk_bf16_f32 v91, v78, v79
    s_nop 1
    v_permlane32_swap_b32 v88, v90
    v_permlane32_swap_b32 v89, v91
    buffer_store_dwordx4 v[88:91], v249, s[20:23], s54 offen offset:2048
K3_END:
    s_endpgm
.globl k4_kernel
.p2align 8
.type k4_kernel,@function
k4_kernel:
    s_cmp_ge_u32 s2, 256
    s_cbranch_scc1 K4_END
    s_load_dwordx2 s[4:5], s[0:1], 96
    s_load_dwordx2 s[6:7], s[0:1], 56
    v_lshrrev_b32 v2, 6, v0
    v_and_b32 v1, 63, v0
    s_nop 0
    v_readfirstlane_b32 s3, v2
    s_and_b32 s41, s2, 3
    s_lshr_b32 s40, s2, 2
    s_lshr_b32 s42, s40, 4
    s_and_b32 s40, s40, 15
    s_and_b32 s43, s3, 3
    s_lshr_b32 s44, s3, 2
    s_waitcnt lgkmcnt(0)
    s_add_u32 s12, s4, 63176704
    s_addc_u32 s13, s5, 0
    s_and_b32 s13, s13, 0xffff
    s_mov_b32 s14, 5308416
    s_mov_b32 s15, 0x00020000
    s_add_u32 s16, s4, 12451840
    s_addc_u32 s17, s5, 0
    s_and_b32 s17, s17, 0xffff
    s_mov_b32 s18, 18874368
    s_mov_b32 s19, 0x00020000
    s_add_u32 s20, s4, 31326208
    s_addc_u32 s21, s5, 0
    s_and_b32 s21, s21, 0xffff
    s_mov_b32 s22, 18874368
    s_mov_b32 s23, 0x00020000
    v_and_b32 v3, 15, v1
    v_lshrrev_b32 v4, 4, v1
    s_mul_i32 s47, s42, 1327104
    s_mul_i32 s48, s41, 331776
    s_add_u32 s47, s47, s48
    s_mul_i32 s48, s3, 4608
    s_add_u32 s47, s47, s48
    v_lshlrev_b32 v170, 4, v1
    v_add_u32 v170, s47, v170
    s_mul_i32 s49, s3, 4608
    s_lshl_b32 s45, s40, 7
    s_lshl_b32 s46, s43, 5
    s_add_u32 s45, s45, s46
    v_add_u32 v7, s45, v3
    s_lshr_b32 s46, s45, 4
    s_mul_i32 s46, s46, 147456
    s_mul_i32 s47, s41, 36864
    s_add_u32 s46, s46, s47
    s_lshl_b32 s47, s44, 11
    s_add_u32 s46, s46, s47
    v_lshlrev_b32 v5, 4, v1
    v_add_u32 v5, s46, v5
    v_add_u32 v6, 147456, v5
    s_mov_b32 s52, 0
    buffer_load_dwordx4 v[112:115], v5, s[16:19], s52 offen offset:0
    buffer_load_dwordx4 v[116:119], v6, s[16:19], s52 offen offset:0
    buffer_load_dwordx4 v[120:123], v5, s[16:19], s52 offen offset:1024
    buffer_load_dwordx4 v[124:127], v6, s[16:19], s52 offen offset:1024
    s_mov_b32 s51, 0
    s_add_u32 m0, s49, 0
    s_nop 0
    buffer_load_dwordx4 v170, s[12:15], s51 offen lds
    s_mov_b32 s51, 1024
    s_add_u32 m0, s49, 1024
    s_nop 0
    buffer_load_dwordx4 v170, s[12:15], s51 offen lds
    s_mov_b32 s51, 2048
    s_add_u32 m0, s49, 2048
    s_nop 0
    buffer_load_dwordx4 v170, s[12:15], s51 offen lds
    s_mov_b32 s51, 3072
    s_add_u32 m0, s49, 3072
    s_nop 0
    buffer_load_dwordx4 v170, s[12:15], s51 offen lds
    s_mov_b64 exec, 0xffffffff
    s_mov_b32 s51, 4096
    s_add_u32 m0, s49, 4096
    s_nop 0
    buffer_load_dwordx4 v170, s[12:15], s51 offen lds
    s_mov_b64 exec, -1
    s_mov_b32 s52, 4096
    buffer_load_dwordx4 v[128:131], v5, s[16:19], s52 offen offset:0
    buffer_load_dwordx4 v[132:135], v6, s[16:19], s52 offen offset:0
    buffer_load_dwordx4 v[136:139], v5, s[16:19], s52 offen offset:1024
    buffer_load_dwordx4 v[140:143], v6, s[16:19], s52 offen offset:1024
    s_mov_b32 s51, 36864
    s_add_u32 m0, s49, 36864
    s_nop 0
    buffer_load_dwordx4 v170, s[12:15], s51 offen lds
    s_mov_b32 s51, 37888
    s_add_u32 m0, s49, 37888
    s_nop 0
    buffer_load_dwordx4 v170, s[12:15], s51 offen lds
    s_mov_b32 s51, 38912
    s_add_u32 m0, s49, 38912
    s_nop 0
    buffer_load_dwordx4 v170, s[12:15], s51 offen lds
    s_mov_b32 s51, 39936
    s_add_u32 m0, s49, 39936
    s_nop 0
    buffer_load_dwordx4 v170, s[12:15], s51 offen lds
    s_mov_b64 exec, 0xffffffff
    s_mov_b32 s51, 40960
    s_add_u32 m0, s49, 40960
    s_nop 0
    buffer_load_dwordx4 v170, s[12:15], s51 offen lds
    s_mov_b64 exec, -1
    s_mov_b32 s51, 73728
    s_add_u32 m0, s49, 73728
    s_nop 0
    buffer_load_dwordx4 v170, s[12:15], s51 offen lds
    s_mov_b32 s51, 74752
    s_add_u32 m0, s49, 74752
    s_nop 0
    buffer_load_dwordx4 v170, s[12:15], s51 offen lds
    s_mov_b32 s51, 75776
    s_add_u32 m0, s49, 75776
    s_nop 0
    buffer_load_dwordx4 v170, s[12:15], s51 offen lds
    s_mov_b32 s51, 76800
    s_add_u32 m0, s49, 76800
    s_nop 0
    buffer_load_dwordx4 v170, s[12:15], s51 offen lds
    s_mov_b64 exec, 0xffffffff
    s_mov_b32 s51, 77824
    s_add_u32 m0, s49, 77824
    s_nop 0
    buffer_load_dwordx4 v170, s[12:15], s51 offen lds
    s_mov_b64 exec, -1
    v_lshrrev_b32 v9, 2, v3
    v_and_b32 v10, 3, v1
    v_lshl_add_u32 v11, v4, 3, v9
    s_lshl_b32 s46, s44, 6
    v_add_u32 v11, s46, v11
    v_mul_u32_u24 v11, 288, v11
    v_lshl_add_u32 v11, v10, 3, v11
    v_and_b32 v12, 1, v4
    v_lshl_add_u32 v13, v12, 7, v11
    v_mul_u32_u24 v12, 160, v12
    v_sub_u32 v14, v11, v12
    v_add_u32 v176, 0, v13
    v_add_u32 v177, 0, v14
    v_add_u32 v178, 36864, v13
    v_add_u32 v179, 36864, v14
    v_add_u32 v180, 73728, v13
    v_add_u32 v181, 73728, v14
    v_add_u32 v182, 110592, v13
    v_add_u32 v183, 110592, v14
    s_waitcnt vmcnt(14)
    s_barrier
    ds_read_b64_tr_b16 v[8:9], v176 offset:0
    ds_read_b64_tr_b16 v[10:11], v176 offset:1152
    ds_read_b64_tr_b16 v[12:13], v176 offset:32
    ds_read_b64_tr_b16 v[14:15], v176 offset:1184
    ds_read_b64_tr_b16 v[16:17], v176 offset:64
    ds_read_b64_tr_b16 v[18:19], v176 offset:1216
    ds_read_b64_tr_b16 v[20:21], v176 offset:96
    ds_read_b64_tr_b16 v[22:23], v176 offset:1248
    s_waitcnt vmcnt(5)
    s_barrier
    s_mov_b32 s52, 8192
    buffer_load_dwordx4 v[144:147], v5, s[16:19], s52 offen offset:0
    buffer_load_dwordx4 v[148:151], v6, s[16:19], s52 offen offset:0
    buffer_load_dwordx4 v[152:155], v5, s[16:19], s52 offen offset:1024
    buffer_load_dwordx4 v[156:159], v6, s[16:19], s52 offen offset:1024
    s_mov_b32 s51, 110592
    s_add_u32 m0, s49, 110592
    s_nop 0
    buffer_load_dwordx4 v170, s[12:15], s51 offen lds
    s_mov_b32 s51, 111616
    s_add_u32 m0, s49, 111616
    s_nop 0
    buffer_load_dwordx4 v170, s[12:15], s51 offen lds
    s_mov_b32 s51, 112640
    s_add_u32 m0, s49, 112640
    s_nop 0
    buffer_load_dwordx4 v170, s[12:15], s51 offen lds
    s_mov_b32 s51, 113664
    s_add_u32 m0, s49, 113664
    s_nop 0
    buffer_load_dwordx4 v170, s[12:15], s51 offen lds
    s_mov_b64 exec, 0xffffffff
    s_mov_b32 s51, 114688
    s_add_u32 m0, s49, 114688
    s_nop 0
    buffer_load_dwordx4 v170, s[12:15], s51 offen lds
    s_mov_b64 exec, -1
    ds_read_b64_tr_b16 v[24:25], v176 offset:128
    ds_read_b64_tr_b16 v[26:27], v176 offset:1280
    s_waitcnt lgkmcnt(8)
    v_mfma_f32_16x16x32_bf16 v[40:43], v[8:11], v[112:115], 0
    v_mfma_f32_16x16x32_bf16 v[44:47], v[8:11], v[116:119], 0
    ds_read_b64_tr_b16 v[28:29], v177 offset:160
    ds_read_b64_tr_b16 v[30:31], v177 offset:1312
    s_waitcnt lgkmcnt(8)
    v_mfma_f32_16x16x32_bf16 v[48:51], v[12:15], v[112:115], 0
    v_mfma_f32_16x16x32_bf16 v[52:55], v[12:15], v[116:119], 0
    ds_read_b64_tr_b16 v[8:9], v177 offset:192
    ds_read_b64_tr_b16 v[10:11], v177 offset:1344
    s_waitcnt lgkmcnt(8)
    v_mfma_f32_16x16x32_bf16 v[56:59], v[16:19], v[112:115], 0
    v_mfma_f32_16x16x32_bf16 v[60:63], v[16:19], v[116:119], 0
    ds_read_b64_tr_b16 v[12:13], v177 offset:224
    ds_read_b64_tr_b16 v[14:15], v177 offset:1376
    s_waitcnt lgkmcnt(8)
    v_mfma_f32_16x16x32_bf16 v[64:67], v[20:23], v[112:115], 0
    v_mfma_f32_16x16x32_bf16 v[68:71], v[20:23], v[116:119], 0
    ds_read_b64_tr_b16 v[16:17], v177 offset:256
    ds_read_b64_tr_b16 v[18:19], v177 offset:1408
    s_waitcnt lgkmcnt(8)
    v_mfma_f32_16x16x32_bf16 v[72:75], v[24:27], v[112:115], 0
    v_mfma_f32_16x16x32_bf16 v[76:79], v[24:27], v[116:119], 0
    ds_read_b64_tr_b16 v[20:21], v176 offset:9216
    ds_read_b64_tr_b16 v[22:23], v176 offset:10368
    s_waitcnt lgkmcnt(8)
    v_mfma_f32_16x16x32_bf16 v[80:83], v[28:31], v[112:115], 0
    v_mfma_f32_16x16x32_bf16 v[84:87], v[28:31], v[116:119], 0
    ds_read_b64_tr_b16 v[24:25], v176 offset:9248
    ds_read_b64_tr_b16 v[26:27], v176 offset:10400
    s_waitcnt lgkmcnt(8)
    v_mfma_f32_16x16x32_bf16 v[88:91], v[8:11], v[112:115], 0
    v_mfma_f32_16x16x32_bf16 v[92:95], v[8:11], v[116:119], 0
    ds_read_b64_tr_b16 v[28:29], v176 offset:9280
    ds_read_b64_tr_b16 v[30:31], v176 offset:10432
    s_waitcnt lgkmcnt(8)
    v_mfma_f32_16x16x32_bf16 v[96:99], v[12:15], v[112:115], 0
    v_mfma_f32_16x16x32_bf16 v[100:103], v[12:15], v[116:119], 0
    ds_read_b64_tr_b16 v[8:9], v176 offset:9312
    ds_read_b64_tr_b16 v[10:11], v176 offset:10464
    s_waitcnt lgkmcnt(8)
    v_mfma_f32_16x16x32_bf16 v[104:107], v[16:19], v[112:115], 0
    v_mfma_f32_16x16x32_bf16 v[108:111], v[16:19], v[116:119], 0
    ds_read_b64_tr_b16 v[12:13], v176 offset:9344
    ds_read_b64_tr_b16 v[14:15], v176 offset:10496
    s_waitcnt lgkmcnt(8)
    v_mfma_f32_16x16x32_bf16 v[40:43], v[20:23], v[120:123], v[40:43]
    v_mfma_f32_16x16x32_bf16 v[44:47], v[20:23], v[124:127], v[44:47]
    ds_read_b64_tr_b16 v[16:17], v177 offset:9376
    ds_read_b64_tr_b16 v[18:19], v177 offset:10528
    s_waitcnt lgkmcnt(8)
    v_mfma_f32_16x16x32_bf16 v[48:51], v[24:27], v[120:123], v[48:51]
    v_mfma_f32_16x16x32_bf16 v[52:55], v[24:27], v[124:127], v[52:55]
    ds_read_b64_tr_b16 v[20:21], v177 offset:9408
    ds_read_b64_tr_b16 v[22:23], v177 offset:10560
    s_waitcnt lgkmcnt(8)
    v_mfma_f32_16x16x32_bf16 v[56:59], v[28:31], v[120:123], v[56:59]
    v_mfma_f32_16x16x32_bf16 v[60:63], v[28:31], v[124:127], v[60:63]
    ds_read_b64_tr_b16 v[24:25], v177 offset:9440
    ds_read_b64_tr_b16 v[26:27], v177 offset:10592
    s_waitcnt lgkmcnt(8)
    v_mfma_f32_16x16x32_bf16 v[64:67], v[8:11], v[120:123], v[64:67]
    v_mfma_f32_16x16x32_bf16 v[68:71], v[8:11], v[124:127], v[68:71]
    ds_read_b64_tr_b16 v[28:29], v177 offset:9472
    ds_read_b64_tr_b16 v[30:31], v177 offset:10624
    s_waitcnt lgkmcnt(8)
    v_mfma_f32_16x16x32_bf16 v[72:75], v[12:15], v[120:123], v[72:75]
    v_mfma_f32_16x16x32_bf16 v[76:79], v[12:15], v[124:127], v[76:79]
    ds_read_b64_tr_b16 v[8:9], v178 offset:0
    ds_read_b64_tr_b16 v[10:11], v178 offset:1152
    s_waitcnt lgkmcnt(8)
    v_mfma_f32_16x16x32_bf16 v[80:83], v[16:19], v[120:123], v[80:83]
    v_mfma_f32_16x16x32_bf16 v[84:87], v[16:19], v[124:127], v[84:87]
    ds_read_b64_tr_b16 v[12:13], v178 offset:32
    ds_read_b64_tr_b16 v[14:15], v178 offset:1184
    s_waitcnt lgkmcnt(8)
    v_mfma_f32_16x16x32_bf16 v[88:91], v[20:23], v[120:123], v[88:91]
    v_mfma_f32_16x16x32_bf16 v[92:95], v[20:23], v[124:127], v[92:95]
    ds_read_b64_tr_b16 v[16:17], v178 offset:64
    ds_read_b64_tr_b16 v[18:19], v178 offset:1216
    s_waitcnt lgkmcnt(8)
    v_mfma_f32_16x16x32_bf16 v[96:99], v[24:27], v[120:123], v[96:99]
    v_mfma_f32_16x16x32_bf16 v[100:103], v[24:27], v[124:127], v[100:103]
    ds_read_b64_tr_b16 v[20:21], v178 offset:96
    ds_read_b64_tr_b16 v[22:23], v178 offset:1248
    s_waitcnt lgkmcnt(8)
    v_mfma_f32_16x16x32_bf16 v[104:107], v[28:31], v[120:123], v[104:107]
    v_mfma_f32_16x16x32_bf16 v[108:111], v[28:31], v[124:127], v[108:111]
    s_waitcnt vmcnt(9)
    s_barrier
    s_mov_b32 s52, 12288
    buffer_load_dwordx4 v[112:115], v5, s[16:19], s52 offen offset:0
    buffer_load_dwordx4 v[116:119], v6, s[16:19], s52 offen offset:0
    buffer_load_dwordx4 v[120:123], v5, s[16:19], s52 offen offset:1024
    buffer_load_dwordx4 v[124:127], v6, s[16:19], s52 offen offset:1024
    s_mov_b32 s51, 147456
    s_add_u32 m0, s49, 0
    s_nop 0
    buffer_load_dwordx4 v170, s[12:15], s51 offen lds
    s_mov_b32 s51, 148480
    s_add_u32 m0, s49, 1024
    s_nop 0
    buffer_load_dwordx4 v170, s[12:15], s51 offen lds
    s_mov_b32 s51, 149504
    s_add_u32 m0, s49, 2048
    s_nop 0
    buffer_load_dwordx4 v170, s[12:15], s51 offen lds
    s_mov_b32 s51, 150528
    s_add_u32 m0, s49, 3072
    s_nop 0
    buffer_load_dwordx4 v170, s[12:15], s51 offen lds
    s_mov_b64 exec, 0xffffffff
    s_mov_b32 s51, 151552
    s_add_u32 m0, s49, 4096
    s_nop 0
    buffer_load_dwordx4 v170, s[12:15], s51 offen lds
    s_mov_b64 exec, -1
    ds_read_b64_tr_b16 v[24:25], v178 offset:128
    ds_read_b64_tr_b16 v[26:27], v178 offset:1280
    s_waitcnt lgkmcnt(8)
    v_mfma_f32_16x16x32_bf16 v[40:43], v[8:11], v[128:131], v[40:43]
    v_mfma_f32_16x16x32_bf16 v[44:47], v[8:11], v[132:135], v[44:47]
    ds_read_b64_tr_b16 v[28:29], v179 offset:160
    ds_read_b64_tr_b16 v[30:31], v179 offset:1312
    s_waitcnt lgkmcnt(8)
    v_mfma_f32_16x16x32_bf16 v[48:51], v[12:15], v[128:131], v[48:51]
    v_mfma_f32_16x16x32_bf16 v[52:55], v[12:15], v[132:135], v[52:55]
    ds_read_b64_tr_b16 v[8:9], v179 offset:192
    ds_read_b64_tr_b16 v[10:11], v179 offset:1344
    s_waitcnt lgkmcnt(8)
    v_mfma_f32_16x16x32_bf16 v[56:59], v[16:19], v[128:131], v[56:59]
    v_mfma_f32_16x16x32_bf16 v[60:63], v[16:19], v[132:135], v[60:63]
    ds_read_b64_tr_b16 v[12:13], v179 offset:224
    ds_read_b64_tr_b16 v[14:15], v179 offset:1376
    s_waitcnt lgkmcnt(8)
    v_mfma_f32_16x16x32_bf16 v[64:67], v[20:23], v[128:131], v[64:67]
    v_mfma_f32_16x16x32_bf16 v[68:71], v[20:23], v[132:135], v[68:71]
    ds_read_b64_tr_b16 v[16:17], v179 offset:256
    ds_read_b64_tr_b16 v[18:19], v179 offset:1408
    s_waitcnt lgkmcnt(8)
    v_mfma_f32_16x16x32_bf16 v[72:75], v[24:27], v[128:131], v[72:75]
    v_mfma_f32_16x16x32_bf16 v[76:79], v[24:27], v[132:135], v[76:79]
    ds_read_b64_tr_b16 v[20:21], v178 offset:9216
    ds_read_b64_tr_b16 v[22:23], v178 offset:10368
    s_waitcnt lgkmcnt(8)
    v_mfma_f32_16x16x32_bf16 v[80:83], v[28:31], v[128:131], v[80:83]
    v_mfma_f32_16x16x32_bf16 v[84:87], v[28:31], v[132:135], v[84:87]
    ds_read_b64_tr_b16 v[24:25], v178 offset:9248
    ds_read_b64_tr_b16 v[26:27], v178 offset:10400
    s_waitcnt lgkmcnt(8)
    v_mfma_f32_16x16x32_bf16 v[88:91], v[8:11], v[128:131], v[88:91]
    v_mfma_f32_16x16x32_bf16 v[92:95], v[8:11], v[132:135], v[92:95]
    ds_read_b64_tr_b16 v[28:29], v178 offset:9280
    ds_read_b64_tr_b16 v[30:31], v178 offset:10432
    s_waitcnt lgkmcnt(8)
    v_mfma_f32_16x16x32_bf16 v[96:99], v[12:15], v[128:131], v[96:99]
    v_mfma_f32_16x16x32_bf16 v[100:103], v[12:15], v[132:135], v[100:103]
    ds_read_b64_tr_b16 v[8:9], v178 offset:9312
    ds_read_b64_tr_b16 v[10:11], v178 offset:10464
    s_waitcnt lgkmcnt(8)
    v_mfma_f32_16x16x32_bf16 v[104:107], v[16:19], v[128:131], v[104:107]
    v_mfma_f32_16x16x32_bf16 v[108:111], v[16:19], v[132:135], v[108:111]
    ds_read_b64_tr_b16 v[12:13], v178 offset:9344
    ds_read_b64_tr_b16 v[14:15], v178 offset:10496
    s_waitcnt lgkmcnt(8)
    v_mfma_f32_16x16x32_bf16 v[40:43], v[20:23], v[136:139], v[40:43]
    v_mfma_f32_16x16x32_bf16 v[44:47], v[20:23], v[140:143], v[44:47]
    ds_read_b64_tr_b16 v[16:17], v179 offset:9376
    ds_read_b64_tr_b16 v[18:19], v179 offset:10528
    s_waitcnt lgkmcnt(8)
    v_mfma_f32_16x16x32_bf16 v[48:51], v[24:27], v[136:139], v[48:51]
    v_mfma_f32_16x16x32_bf16 v[52:55], v[24:27], v[140:143], v[52:55]
    ds_read_b64_tr_b16 v[20:21], v179 offset:9408
    ds_read_b64_tr_b16 v[22:23], v179 offset:10560
    s_waitcnt lgkmcnt(8)
    v_mfma_f32_16x16x32_bf16 v[56:59], v[28:31], v[136:139], v[56:59]
    v_mfma_f32_16x16x32_bf16 v[60:63], v[28:31], v[140:143], v[60:63]
    ds_read_b64_tr_b16 v[24:25], v179 offset:9440
    ds_read_b64_tr_b16 v[26:27], v179 offset:10592
    s_waitcnt lgkmcnt(8)
    v_mfma_f32_16x16x32_bf16 v[64:67], v[8:11], v[136:139], v[64:67]
    v_mfma_f32_16x16x32_bf16 v[68:71], v[8:11], v[140:143], v[68:71]
    ds_read_b64_tr_b16 v[28:29], v179 offset:9472
    ds_read_b64_tr_b16 v[30:31], v179 offset:10624
    s_waitcnt lgkmcnt(8)
    v_mfma_f32_16x16x32_bf16 v[72:75], v[12:15], v[136:139], v[72:75]
    v_mfma_f32_16x16x32_bf16 v[76:79], v[12:15], v[140:143], v[76:79]
    ds_read_b64_tr_b16 v[8:9], v180 offset:0
    ds_read_b64_tr_b16 v[10:11], v180 offset:1152
    s_waitcnt lgkmcnt(8)
    v_mfma_f32_16x16x32_bf16 v[80:83], v[16:19], v[136:139], v[80:83]
    v_mfma_f32_16x16x32_bf16 v[84:87], v[16:19], v[140:143], v[84:87]
    ds_read_b64_tr_b16 v[12:13], v180 offset:32
    ds_read_b64_tr_b16 v[14:15], v180 offset:1184
    s_waitcnt lgkmcnt(8)
    v_mfma_f32_16x16x32_bf16 v[88:91], v[20:23], v[136:139], v[88:91]
    v_mfma_f32_16x16x32_bf16 v[92:95], v[20:23], v[140:143], v[92:95]
    ds_read_b64_tr_b16 v[16:17], v180 offset:64
    ds_read_b64_tr_b16 v[18:19], v180 offset:1216
    s_waitcnt lgkmcnt(8)
    v_mfma_f32_16x16x32_bf16 v[96:99], v[24:27], v[136:139], v[96:99]
    v_mfma_f32_16x16x32_bf16 v[100:103], v[24:27], v[140:143], v[100:103]
    ds_read_b64_tr_b16 v[20:21], v180 offset:96
    ds_read_b64_tr_b16 v[22:23], v180 offset:1248
    s_waitcnt lgkmcnt(8)
    v_mfma_f32_16x16x32_bf16 v[104:107], v[28:31], v[136:139], v[104:107]
    v_mfma_f32_16x16x32_bf16 v[108:111], v[28:31], v[140:143], v[108:111]
    s_waitcnt vmcnt(9)
    s_barrier
    s_mov_b32 s52, 16384
    buffer_load_dwordx4 v[128:131], v5, s[16:19], s52 offen offset:0
    buffer_load_dwordx4 v[132:135], v6, s[16:19], s52 offen offset:0
    buffer_load_dwordx4 v[136:139], v5, s[16:19], s52 offen offset:1024
    buffer_load_dwordx4 v[140:143], v6, s[16:19], s52 offen offset:1024
    s_mov_b32 s51, 184320
    s_add_u32 m0, s49, 36864
    s_nop 0
    buffer_load_dwordx4 v170, s[12:15], s51 offen lds
    s_mov_b32 s51, 185344
    s_add_u32 m0, s49, 37888
    s_nop 0
    buffer_load_dwordx4 v170, s[12:15], s51 offen lds
    s_mov_b32 s51, 186368
    s_add_u32 m0, s49, 38912
    s_nop 0
    buffer_load_dwordx4 v170, s[12:15], s51 offen lds
    s_mov_b32 s51, 187392
    s_add_u32 m0, s49, 39936
    s_nop 0
    buffer_load_dwordx4 v170, s[12:15], s51 offen lds
    s_mov_b64 exec, 0xffffffff
    s_mov_b32 s51, 188416
    s_add_u32 m0, s49, 40960
    s_nop 0
    buffer_load_dwordx4 v170, s[12:15], s51 offen lds
    s_mov_b64 exec, -1
    ds_read_b64_tr_b16 v[24:25], v180 offset:128
    ds_read_b64_tr_b16 v[26:27], v180 offset:1280
    s_waitcnt lgkmcnt(8)
    v_mfma_f32_16x16x32_bf16 v[40:43], v[8:11], v[144:147], v[40:43]
    v_mfma_f32_16x16x32_bf16 v[44:47], v[8:11], v[148:151], v[44:47]
    ds_read_b64_tr_b16 v[28:29], v181 offset:160
    ds_read_b64_tr_b16 v[30:31], v181 offset:1312
    s_waitcnt lgkmcnt(8)
    v_mfma_f32_16x16x32_bf16 v[48:51], v[12:15], v[144:147], v[48:51]
    v_mfma_f32_16x16x32_bf16 v[52:55], v[12:15], v[148:151], v[52:55]
    ds_read_b64_tr_b16 v[8:9], v181 offset:192
    ds_read_b64_tr_b16 v[10:11], v181 offset:1344
    s_waitcnt lgkmcnt(8)
    v_mfma_f32_16x16x32_bf16 v[56:59], v[16:19], v[144:147], v[56:59]
    v_mfma_f32_16x16x32_bf16 v[60:63], v[16:19], v[148:151], v[60:63]
    ds_read_b64_tr_b16 v[12:13], v181 offset:224
    ds_read_b64_tr_b16 v[14:15], v181 offset:1376
    s_waitcnt lgkmcnt(8)
    v_mfma_f32_16x16x32_bf16 v[64:67], v[20:23], v[144:147], v[64:67]
    v_mfma_f32_16x16x32_bf16 v[68:71], v[20:23], v[148:151], v[68:71]
    ds_read_b64_tr_b16 v[16:17], v181 offset:256
    ds_read_b64_tr_b16 v[18:19], v181 offset:1408
    s_waitcnt lgkmcnt(8)
    v_mfma_f32_16x16x32_bf16 v[72:75], v[24:27], v[144:147], v[72:75]
    v_mfma_f32_16x16x32_bf16 v[76:79], v[24:27], v[148:151], v[76:79]
    ds_read_b64_tr_b16 v[20:21], v180 offset:9216
    ds_read_b64_tr_b16 v[22:23], v180 offset:10368
    s_waitcnt lgkmcnt(8)
    v_mfma_f32_16x16x32_bf16 v[80:83], v[28:31], v[144:147], v[80:83]
    v_mfma_f32_16x16x32_bf16 v[84:87], v[28:31], v[148:151], v[84:87]
    ds_read_b64_tr_b16 v[24:25], v180 offset:9248
    ds_read_b64_tr_b16 v[26:27], v180 offset:10400
    s_waitcnt lgkmcnt(8)
    v_mfma_f32_16x16x32_bf16 v[88:91], v[8:11], v[144:147], v[88:91]
    v_mfma_f32_16x16x32_bf16 v[92:95], v[8:11], v[148:151], v[92:95]
    ds_read_b64_tr_b16 v[28:29], v180 offset:9280
    ds_read_b64_tr_b16 v[30:31], v180 offset:10432
    s_waitcnt lgkmcnt(8)
    v_mfma_f32_16x16x32_bf16 v[96:99], v[12:15], v[144:147], v[96:99]
    v_mfma_f32_16x16x32_bf16 v[100:103], v[12:15], v[148:151], v[100:103]
    ds_read_b64_tr_b16 v[8:9], v180 offset:9312
    ds_read_b64_tr_b16 v[10:11], v180 offset:10464
    s_waitcnt lgkmcnt(8)
    v_mfma_f32_16x16x32_bf16 v[104:107], v[16:19], v[144:147], v[104:107]
    v_mfma_f32_16x16x32_bf16 v[108:111], v[16:19], v[148:151], v[108:111]
    ds_read_b64_tr_b16 v[12:13], v180 offset:9344
    ds_read_b64_tr_b16 v[14:15], v180 offset:10496
    s_waitcnt lgkmcnt(8)
    v_mfma_f32_16x16x32_bf16 v[40:43], v[20:23], v[152:155], v[40:43]
    v_mfma_f32_16x16x32_bf16 v[44:47], v[20:23], v[156:159], v[44:47]
    ds_read_b64_tr_b16 v[16:17], v181 offset:9376
    ds_read_b64_tr_b16 v[18:19], v181 offset:10528
    s_waitcnt lgkmcnt(8)
    v_mfma_f32_16x16x32_bf16 v[48:51], v[24:27], v[152:155], v[48:51]
    v_mfma_f32_16x16x32_bf16 v[52:55], v[24:27], v[156:159], v[52:55]
    ds_read_b64_tr_b16 v[20:21], v181 offset:9408
    ds_read_b64_tr_b16 v[22:23], v181 offset:10560
    s_waitcnt lgkmcnt(8)
    v_mfma_f32_16x16x32_bf16 v[56:59], v[28:31], v[152:155], v[56:59]
    v_mfma_f32_16x16x32_bf16 v[60:63], v[28:31], v[156:159], v[60:63]
    ds_read_b64_tr_b16 v[24:25], v181 offset:9440
    ds_read_b64_tr_b16 v[26:27], v181 offset:10592
    s_waitcnt lgkmcnt(8)
    v_mfma_f32_16x16x32_bf16 v[64:67], v[8:11], v[152:155], v[64:67]
    v_mfma_f32_16x16x32_bf16 v[68:71], v[8:11], v[156:159], v[68:71]
    ds_read_b64_tr_b16 v[28:29], v181 offset:9472
    ds_read_b64_tr_b16 v[30:31], v181 offset:10624
    s_waitcnt lgkmcnt(8)
    v_mfma_f32_16x16x32_bf16 v[72:75], v[12:15], v[152:155], v[72:75]
    v_mfma_f32_16x16x32_bf16 v[76:79], v[12:15], v[156:159], v[76:79]
    ds_read_b64_tr_b16 v[8:9], v182 offset:0
    ds_read_b64_tr_b16 v[10:11], v182 offset:1152
    s_waitcnt lgkmcnt(8)
    v_mfma_f32_16x16x32_bf16 v[80:83], v[16:19], v[152:155], v[80:83]
    v_mfma_f32_16x16x32_bf16 v[84:87], v[16:19], v[156:159], v[84:87]
    ds_read_b64_tr_b16 v[12:13], v182 offset:32
    ds_read_b64_tr_b16 v[14:15], v182 offset:1184
    s_waitcnt lgkmcnt(8)
    v_mfma_f32_16x16x32_bf16 v[88:91], v[20:23], v[152:155], v[88:91]
    v_mfma_f32_16x16x32_bf16 v[92:95], v[20:23], v[156:159], v[92:95]
    ds_read_b64_tr_b16 v[16:17], v182 offset:64
    ds_read_b64_tr_b16 v[18:19], v182 offset:1216
    s_waitcnt lgkmcnt(8)
    v_mfma_f32_16x16x32_bf16 v[96:99], v[24:27], v[152:155], v[96:99]
    v_mfma_f32_16x16x32_bf16 v[100:103], v[24:27], v[156:159], v[100:103]
    ds_read_b64_tr_b16 v[20:21], v182 offset:96
    ds_read_b64_tr_b16 v[22:23], v182 offset:1248
    s_waitcnt lgkmcnt(8)
    v_mfma_f32_16x16x32_bf16 v[104:107], v[28:31], v[152:155], v[104:107]
    v_mfma_f32_16x16x32_bf16 v[108:111], v[28:31], v[156:159], v[108:111]
    s_waitcnt vmcnt(9)
    s_barrier
    s_mov_b32 s52, 20480
    buffer_load_dwordx4 v[144:147], v5, s[16:19], s52 offen offset:0
    buffer_load_dwordx4 v[148:151], v6, s[16:19], s52 offen offset:0
    buffer_load_dwordx4 v[152:155], v5, s[16:19], s52 offen offset:1024
    buffer_load_dwordx4 v[156:159], v6, s[16:19], s52 offen offset:1024
    s_mov_b32 s51, 221184
    s_add_u32 m0, s49, 73728
    s_nop 0
    buffer_load_dwordx4 v170, s[12:15], s51 offen lds
    s_mov_b32 s51, 222208
    s_add_u32 m0, s49, 74752
    s_nop 0
    buffer_load_dwordx4 v170, s[12:15], s51 offen lds
    s_mov_b32 s51, 223232
    s_add_u32 m0, s49, 75776
    s_nop 0
    buffer_load_dwordx4 v170, s[12:15], s51 offen lds
    s_mov_b32 s51, 224256
    s_add_u32 m0, s49, 76800
    s_nop 0
    buffer_load_dwordx4 v170, s[12:15], s51 offen lds
    s_mov_b64 exec, 0xffffffff
    s_mov_b32 s51, 225280
    s_add_u32 m0, s49, 77824
    s_nop 0
    buffer_load_dwordx4 v170, s[12:15], s51 offen lds
    s_mov_b64 exec, -1
    ds_read_b64_tr_b16 v[24:25], v182 offset:128
    ds_read_b64_tr_b16 v[26:27], v182 offset:1280
    s_waitcnt lgkmcnt(8)
    v_mfma_f32_16x16x32_bf16 v[40:43], v[8:11], v[112:115], v[40:43]
    v_mfma_f32_16x16x32_bf16 v[44:47], v[8:11], v[116:119], v[44:47]
    ds_read_b64_tr_b16 v[28:29], v183 offset:160
    ds_read_b64_tr_b16 v[30:31], v183 offset:1312
    s_waitcnt lgkmcnt(8)
    v_mfma_f32_16x16x32_bf16 v[48:51], v[12:15], v[112:115], v[48:51]
    v_mfma_f32_16x16x32_bf16 v[52:55], v[12:15], v[116:119], v[52:55]
    ds_read_b64_tr_b16 v[8:9], v183 offset:192
    ds_read_b64_tr_b16 v[10:11], v183 offset:1344
    s_waitcnt lgkmcnt(8)
    v_mfma_f32_16x16x32_bf16 v[56:59], v[16:19], v[112:115], v[56:59]
    v_mfma_f32_16x16x32_bf16 v[60:63], v[16:19], v[116:119], v[60:63]
    ds_read_b64_tr_b16 v[12:13], v183 offset:224
    ds_read_b64_tr_b16 v[14:15], v183 offset:1376
    s_waitcnt lgkmcnt(8)
    v_mfma_f32_16x16x32_bf16 v[64:67], v[20:23], v[112:115], v[64:67]
    v_mfma_f32_16x16x32_bf16 v[68:71], v[20:23], v[116:119], v[68:71]
    ds_read_b64_tr_b16 v[16:17], v183 offset:256
    ds_read_b64_tr_b16 v[18:19], v183 offset:1408
    s_waitcnt lgkmcnt(8)
    v_mfma_f32_16x16x32_bf16 v[72:75], v[24:27], v[112:115], v[72:75]
    v_mfma_f32_16x16x32_bf16 v[76:79], v[24:27], v[116:119], v[76:79]
    ds_read_b64_tr_b16 v[20:21], v182 offset:9216
    ds_read_b64_tr_b16 v[22:23], v182 offset:10368
    s_waitcnt lgkmcnt(8)
    v_mfma_f32_16x16x32_bf16 v[80:83], v[28:31], v[112:115], v[80:83]
    v_mfma_f32_16x16x32_bf16 v[84:87], v[28:31], v[116:119], v[84:87]
    ds_read_b64_tr_b16 v[24:25], v182 offset:9248
    ds_read_b64_tr_b16 v[26:27], v182 offset:10400
    s_waitcnt lgkmcnt(8)
    v_mfma_f32_16x16x32_bf16 v[88:91], v[8:11], v[112:115], v[88:91]
    v_mfma_f32_16x16x32_bf16 v[92:95], v[8:11], v[116:119], v[92:95]
    ds_read_b64_tr_b16 v[28:29], v182 offset:9280
    ds_read_b64_tr_b16 v[30:31], v182 offset:10432
    s_waitcnt lgkmcnt(8)
    v_mfma_f32_16x16x32_bf16 v[96:99], v[12:15], v[112:115], v[96:99]
    v_mfma_f32_16x16x32_bf16 v[100:103], v[12:15], v[116:119], v[100:103]
    ds_read_b64_tr_b16 v[8:9], v182 offset:9312
    ds_read_b64_tr_b16 v[10:11], v182 offset:10464
    s_waitcnt lgkmcnt(8)
    v_mfma_f32_16x16x32_bf16 v[104:107], v[16:19], v[112:115], v[104:107]
    v_mfma_f32_16x16x32_bf16 v[108:111], v[16:19], v[116:119], v[108:111]
    ds_read_b64_tr_b16 v[12:13], v182 offset:9344
    ds_read_b64_tr_b16 v[14:15], v182 offset:10496
    s_waitcnt lgkmcnt(8)
    v_mfma_f32_16x16x32_bf16 v[40:43], v[20:23], v[120:123], v[40:43]
    v_mfma_f32_16x16x32_bf16 v[44:47], v[20:23], v[124:127], v[44:47]
    ds_read_b64_tr_b16 v[16:17], v183 offset:9376
    ds_read_b64_tr_b16 v[18:19], v183 offset:10528
    s_waitcnt lgkmcnt(8)
    v_mfma_f32_16x16x32_bf16 v[48:51], v[24:27], v[120:123], v[48:51]
    v_mfma_f32_16x16x32_bf16 v[52:55], v[24:27], v[124:127], v[52:55]
    ds_read_b64_tr_b16 v[20:21], v183 offset:9408
    ds_read_b64_tr_b16 v[22:23], v183 offset:10560
    s_waitcnt lgkmcnt(8)
    v_mfma_f32_16x16x32_bf16 v[56:59], v[28:31], v[120:123], v[56:59]
    v_mfma_f32_16x16x32_bf16 v[60:63], v[28:31], v[124:127], v[60:63]
    ds_read_b64_tr_b16 v[24:25], v183 offset:9440
    ds_read_b64_tr_b16 v[26:27], v183 offset:10592
    s_waitcnt lgkmcnt(8)
    v_mfma_f32_16x16x32_bf16 v[64:67], v[8:11], v[120:123], v[64:67]
    v_mfma_f32_16x16x32_bf16 v[68:71], v[8:11], v[124:127], v[68:71]
    ds_read_b64_tr_b16 v[28:29], v183 offset:9472
    ds_read_b64_tr_b16 v[30:31], v183 offset:10624
    s_waitcnt lgkmcnt(8)
    v_mfma_f32_16x16x32_bf16 v[72:75], v[12:15], v[120:123], v[72:75]
    v_mfma_f32_16x16x32_bf16 v[76:79], v[12:15], v[124:127], v[76:79]
    ds_read_b64_tr_b16 v[8:9], v176 offset:0
    ds_read_b64_tr_b16 v[10:11], v176 offset:1152
    s_waitcnt lgkmcnt(8)
    v_mfma_f32_16x16x32_bf16 v[80:83], v[16:19], v[120:123], v[80:83]
    v_mfma_f32_16x16x32_bf16 v[84:87], v[16:19], v[124:127], v[84:87]
    ds_read_b64_tr_b16 v[12:13], v176 offset:32
    ds_read_b64_tr_b16 v[14:15], v176 offset:1184
    s_waitcnt lgkmcnt(8)
    v_mfma_f32_16x16x32_bf16 v[88:91], v[20:23], v[120:123], v[88:91]
    v_mfma_f32_16x16x32_bf16 v[92:95], v[20:23], v[124:127], v[92:95]
    ds_read_b64_tr_b16 v[16:17], v176 offset:64
    ds_read_b64_tr_b16 v[18:19], v176 offset:1216
    s_waitcnt lgkmcnt(8)
    v_mfma_f32_16x16x32_bf16 v[96:99], v[24:27], v[120:123], v[96:99]
    v_mfma_f32_16x16x32_bf16 v[100:103], v[24:27], v[124:127], v[100:103]
    ds_read_b64_tr_b16 v[20:21], v176 offset:96
    ds_read_b64_tr_b16 v[22:23], v176 offset:1248
    s_waitcnt lgkmcnt(8)
    v_mfma_f32_16x16x32_bf16 v[104:107], v[28:31], v[120:123], v[104:107]
    v_mfma_f32_16x16x32_bf16 v[108:111], v[28:31], v[124:127], v[108:111]
    s_waitcnt vmcnt(9)
    s_barrier
    s_mov_b32 s52, 24576
    buffer_load_dwordx4 v[112:115], v5, s[16:19], s52 offen offset:0
    buffer_load_dwordx4 v[116:119], v6, s[16:19], s52 offen offset:0
    buffer_load_dwordx4 v[120:123], v5, s[16:19], s52 offen offset:1024
    buffer_load_dwordx4 v[124:127], v6, s[16:19], s52 offen offset:1024
    s_mov_b32 s51, 258048
    s_add_u32 m0, s49, 110592
    s_nop 0
    buffer_load_dwordx4 v170, s[12:15], s51 offen lds
    s_mov_b32 s51, 259072
    s_add_u32 m0, s49, 111616
    s_nop 0
    buffer_load_dwordx4 v170, s[12:15], s51 offen lds
    s_mov_b32 s51, 260096
    s_add_u32 m0, s49, 112640
    s_nop 0
    buffer_load_dwordx4 v170, s[12:15], s51 offen lds
    s_mov_b32 s51, 261120
    s_add_u32 m0, s49, 113664
    s_nop 0
    buffer_load_dwordx4 v170, s[12:15], s51 offen lds
    s_mov_b64 exec, 0xffffffff
    s_mov_b32 s51, 262144
    s_add_u32 m0, s49, 114688
    s_nop 0
    buffer_load_dwordx4 v170, s[12:15], s51 offen lds
    s_mov_b64 exec, -1
    ds_read_b64_tr_b16 v[24:25], v176 offset:128
    ds_read_b64_tr_b16 v[26:27], v176 offset:1280
    s_waitcnt lgkmcnt(8)
    v_mfma_f32_16x16x32_bf16 v[40:43], v[8:11], v[128:131], v[40:43]
    v_mfma_f32_16x16x32_bf16 v[44:47], v[8:11], v[132:135], v[44:47]
    ds_read_b64_tr_b16 v[28:29], v177 offset:160
    ds_read_b64_tr_b16 v[30:31], v177 offset:1312
    s_waitcnt lgkmcnt(8)
    v_mfma_f32_16x16x32_bf16 v[48:51], v[12:15], v[128:131], v[48:51]
    v_mfma_f32_16x16x32_bf16 v[52:55], v[12:15], v[132:135], v[52:55]
    ds_read_b64_tr_b16 v[8:9], v177 offset:192
    ds_read_b64_tr_b16 v[10:11], v177 offset:1344
    s_waitcnt lgkmcnt(8)
    v_mfma_f32_16x16x32_bf16 v[56:59], v[16:19], v[128:131], v[56:59]
    v_mfma_f32_16x16x32_bf16 v[60:63], v[16:19], v[132:135], v[60:63]
    ds_read_b64_tr_b16 v[12:13], v177 offset:224
    ds_read_b64_tr_b16 v[14:15], v177 offset:1376
    s_waitcnt lgkmcnt(8)
    v_mfma_f32_16x16x32_bf16 v[64:67], v[20:23], v[128:131], v[64:67]
    v_mfma_f32_16x16x32_bf16 v[68:71], v[20:23], v[132:135], v[68:71]
    ds_read_b64_tr_b16 v[16:17], v177 offset:256
    ds_read_b64_tr_b16 v[18:19], v177 offset:1408
    s_waitcnt lgkmcnt(8)
    v_mfma_f32_16x16x32_bf16 v[72:75], v[24:27], v[128:131], v[72:75]
    v_mfma_f32_16x16x32_bf16 v[76:79], v[24:27], v[132:135], v[76:79]
    ds_read_b64_tr_b16 v[20:21], v176 offset:9216
    ds_read_b64_tr_b16 v[22:23], v176 offset:10368
    s_waitcnt lgkmcnt(8)
    v_mfma_f32_16x16x32_bf16 v[80:83], v[28:31], v[128:131], v[80:83]
    v_mfma_f32_16x16x32_bf16 v[84:87], v[28:31], v[132:135], v[84:87]
    ds_read_b64_tr_b16 v[24:25], v176 offset:9248
    ds_read_b64_tr_b16 v[26:27], v176 offset:10400
    s_waitcnt lgkmcnt(8)
    v_mfma_f32_16x16x32_bf16 v[88:91], v[8:11], v[128:131], v[88:91]
    v_mfma_f32_16x16x32_bf16 v[92:95], v[8:11], v[132:135], v[92:95]
    ds_read_b64_tr_b16 v[28:29], v176 offset:9280
    ds_read_b64_tr_b16 v[30:31], v176 offset:10432
    s_waitcnt lgkmcnt(8)
    v_mfma_f32_16x16x32_bf16 v[96:99], v[12:15], v[128:131], v[96:99]
    v_mfma_f32_16x16x32_bf16 v[100:103], v[12:15], v[132:135], v[100:103]
    ds_read_b64_tr_b16 v[8:9], v176 offset:9312
    ds_read_b64_tr_b16 v[10:11], v176 offset:10464
    s_waitcnt lgkmcnt(8)
    v_mfma_f32_16x16x32_bf16 v[104:107], v[16:19], v[128:131], v[104:107]
    v_mfma_f32_16x16x32_bf16 v[108:111], v[16:19], v[132:135], v[108:111]
    ds_read_b64_tr_b16 v[12:13], v176 offset:9344
    ds_read_b64_tr_b16 v[14:15], v176 offset:10496
    s_waitcnt lgkmcnt(8)
    v_mfma_f32_16x16x32_bf16 v[40:43], v[20:23], v[136:139], v[40:43]
    v_mfma_f32_16x16x32_bf16 v[44:47], v[20:23], v[140:143], v[44:47]
    ds_read_b64_tr_b16 v[16:17], v177 offset:9376
    ds_read_b64_tr_b16 v[18:19], v177 offset:10528
    s_waitcnt lgkmcnt(8)
    v_mfma_f32_16x16x32_bf16 v[48:51], v[24:27], v[136:139], v[48:51]
    v_mfma_f32_16x16x32_bf16 v[52:55], v[24:27], v[140:143], v[52:55]
    ds_read_b64_tr_b16 v[20:21], v177 offset:9408
    ds_read_b64_tr_b16 v[22:23], v177 offset:10560
    s_waitcnt lgkmcnt(8)
    v_mfma_f32_16x16x32_bf16 v[56:59], v[28:31], v[136:139], v[56:59]
    v_mfma_f32_16x16x32_bf16 v[60:63], v[28:31], v[140:143], v[60:63]
    ds_read_b64_tr_b16 v[24:25], v177 offset:9440
    ds_read_b64_tr_b16 v[26:27], v177 offset:10592
    s_waitcnt lgkmcnt(8)
    v_mfma_f32_16x16x32_bf16 v[64:67], v[8:11], v[136:139], v[64:67]
    v_mfma_f32_16x16x32_bf16 v[68:71], v[8:11], v[140:143], v[68:71]
    ds_read_b64_tr_b16 v[28:29], v177 offset:9472
    ds_read_b64_tr_b16 v[30:31], v177 offset:10624
    s_waitcnt lgkmcnt(8)
    v_mfma_f32_16x16x32_bf16 v[72:75], v[12:15], v[136:139], v[72:75]
    v_mfma_f32_16x16x32_bf16 v[76:79], v[12:15], v[140:143], v[76:79]
    ds_read_b64_tr_b16 v[8:9], v178 offset:0
    ds_read_b64_tr_b16 v[10:11], v178 offset:1152
    s_waitcnt lgkmcnt(8)
    v_mfma_f32_16x16x32_bf16 v[80:83], v[16:19], v[136:139], v[80:83]
    v_mfma_f32_16x16x32_bf16 v[84:87], v[16:19], v[140:143], v[84:87]
    ds_read_b64_tr_b16 v[12:13], v178 offset:32
    ds_read_b64_tr_b16 v[14:15], v178 offset:1184
    s_waitcnt lgkmcnt(8)
    v_mfma_f32_16x16x32_bf16 v[88:91], v[20:23], v[136:139], v[88:91]
    v_mfma_f32_16x16x32_bf16 v[92:95], v[20:23], v[140:143], v[92:95]
    ds_read_b64_tr_b16 v[16:17], v178 offset:64
    ds_read_b64_tr_b16 v[18:19], v178 offset:1216
    s_waitcnt lgkmcnt(8)
    v_mfma_f32_16x16x32_bf16 v[96:99], v[24:27], v[136:139], v[96:99]
    v_mfma_f32_16x16x32_bf16 v[100:103], v[24:27], v[140:143], v[100:103]
    ds_read_b64_tr_b16 v[20:21], v178 offset:96
    ds_read_b64_tr_b16 v[22:23], v178 offset:1248
    s_waitcnt lgkmcnt(8)
    v_mfma_f32_16x16x32_bf16 v[104:107], v[28:31], v[136:139], v[104:107]
    v_mfma_f32_16x16x32_bf16 v[108:111], v[28:31], v[140:143], v[108:111]
    s_waitcnt vmcnt(9)
    s_barrier
    s_mov_b32 s52, 28672
    buffer_load_dwordx4 v[128:131], v5, s[16:19], s52 offen offset:0
    buffer_load_dwordx4 v[132:135], v6, s[16:19], s52 offen offset:0
    buffer_load_dwordx4 v[136:139], v5, s[16:19], s52 offen offset:1024
    buffer_load_dwordx4 v[140:143], v6, s[16:19], s52 offen offset:1024
    s_mov_b32 s51, 294912
    s_add_u32 m0, s49, 0
    s_nop 0
    buffer_load_dwordx4 v170, s[12:15], s51 offen lds
    s_mov_b32 s51, 295936
    s_add_u32 m0, s49, 1024
    s_nop 0
    buffer_load_dwordx4 v170, s[12:15], s51 offen lds
    s_mov_b32 s51, 296960
    s_add_u32 m0, s49, 2048
    s_nop 0
    buffer_load_dwordx4 v170, s[12:15], s51 offen lds
    s_mov_b32 s51, 297984
    s_add_u32 m0, s49, 3072
    s_nop 0
    buffer_load_dwordx4 v170, s[12:15], s51 offen lds
    s_mov_b64 exec, 0xffffffff
    s_mov_b32 s51, 299008
    s_add_u32 m0, s49, 4096
    s_nop 0
    buffer_load_dwordx4 v170, s[12:15], s51 offen lds
    s_mov_b64 exec, -1
    ds_read_b64_tr_b16 v[24:25], v178 offset:128
    ds_read_b64_tr_b16 v[26:27], v178 offset:1280
    s_waitcnt lgkmcnt(8)
    v_mfma_f32_16x16x32_bf16 v[40:43], v[8:11], v[144:147], v[40:43]
    v_mfma_f32_16x16x32_bf16 v[44:47], v[8:11], v[148:151], v[44:47]
    ds_read_b64_tr_b16 v[28:29], v179 offset:160
    ds_read_b64_tr_b16 v[30:31], v179 offset:1312
    s_waitcnt lgkmcnt(8)
    v_mfma_f32_16x16x32_bf16 v[48:51], v[12:15], v[144:147], v[48:51]
    v_mfma_f32_16x16x32_bf16 v[52:55], v[12:15], v[148:151], v[52:55]
    ds_read_b64_tr_b16 v[8:9], v179 offset:192
    ds_read_b64_tr_b16 v[10:11], v179 offset:1344
    s_waitcnt lgkmcnt(8)
    v_mfma_f32_16x16x32_bf16 v[56:59], v[16:19], v[144:147], v[56:59]
    v_mfma_f32_16x16x32_bf16 v[60:63], v[16:19], v[148:151], v[60:63]
    ds_read_b64_tr_b16 v[12:13], v179 offset:224
    ds_read_b64_tr_b16 v[14:15], v179 offset:1376
    s_waitcnt lgkmcnt(8)
    v_mfma_f32_16x16x32_bf16 v[64:67], v[20:23], v[144:147], v[64:67]
    v_mfma_f32_16x16x32_bf16 v[68:71], v[20:23], v[148:151], v[68:71]
    ds_read_b64_tr_b16 v[16:17], v179 offset:256
    ds_read_b64_tr_b16 v[18:19], v179 offset:1408
    s_waitcnt lgkmcnt(8)
    v_mfma_f32_16x16x32_bf16 v[72:75], v[24:27], v[144:147], v[72:75]
    v_mfma_f32_16x16x32_bf16 v[76:79], v[24:27], v[148:151], v[76:79]
    ds_read_b64_tr_b16 v[20:21], v178 offset:9216
    ds_read_b64_tr_b16 v[22:23], v178 offset:10368
    s_waitcnt lgkmcnt(8)
    v_mfma_f32_16x16x32_bf16 v[80:83], v[28:31], v[144:147], v[80:83]
    v_mfma_f32_16x16x32_bf16 v[84:87], v[28:31], v[148:151], v[84:87]
    ds_read_b64_tr_b16 v[24:25], v178 offset:9248
    ds_read_b64_tr_b16 v[26:27], v178 offset:10400
    s_waitcnt lgkmcnt(8)
    v_mfma_f32_16x16x32_bf16 v[88:91], v[8:11], v[144:147], v[88:91]
    v_mfma_f32_16x16x32_bf16 v[92:95], v[8:11], v[148:151], v[92:95]
    ds_read_b64_tr_b16 v[28:29], v178 offset:9280
    ds_read_b64_tr_b16 v[30:31], v178 offset:10432
    s_waitcnt lgkmcnt(8)
    v_mfma_f32_16x16x32_bf16 v[96:99], v[12:15], v[144:147], v[96:99]
    v_mfma_f32_16x16x32_bf16 v[100:103], v[12:15], v[148:151], v[100:103]
    ds_read_b64_tr_b16 v[8:9], v178 offset:9312
    ds_read_b64_tr_b16 v[10:11], v178 offset:10464
    s_waitcnt lgkmcnt(8)
    v_mfma_f32_16x16x32_bf16 v[104:107], v[16:19], v[144:147], v[104:107]
    v_mfma_f32_16x16x32_bf16 v[108:111], v[16:19], v[148:151], v[108:111]
    ds_read_b64_tr_b16 v[12:13], v178 offset:9344
    ds_read_b64_tr_b16 v[14:15], v178 offset:10496
    s_waitcnt lgkmcnt(8)
    v_mfma_f32_16x16x32_bf16 v[40:43], v[20:23], v[152:155], v[40:43]
    v_mfma_f32_16x16x32_bf16 v[44:47], v[20:23], v[156:159], v[44:47]
    ds_read_b64_tr_b16 v[16:17], v179 offset:9376
    ds_read_b64_tr_b16 v[18:19], v179 offset:10528
    s_waitcnt lgkmcnt(8)
    v_mfma_f32_16x16x32_bf16 v[48:51], v[24:27], v[152:155], v[48:51]
    v_mfma_f32_16x16x32_bf16 v[52:55], v[24:27], v[156:159], v[52:55]
    ds_read_b64_tr_b16 v[20:21], v179 offset:9408
    ds_read_b64_tr_b16 v[22:23], v179 offset:10560
    s_waitcnt lgkmcnt(8)
    v_mfma_f32_16x16x32_bf16 v[56:59], v[28:31], v[152:155], v[56:59]
    v_mfma_f32_16x16x32_bf16 v[60:63], v[28:31], v[156:159], v[60:63]
    ds_read_b64_tr_b16 v[24:25], v179 offset:9440
    ds_read_b64_tr_b16 v[26:27], v179 offset:10592
    s_waitcnt lgkmcnt(8)
    v_mfma_f32_16x16x32_bf16 v[64:67], v[8:11], v[152:155], v[64:67]
    v_mfma_f32_16x16x32_bf16 v[68:71], v[8:11], v[156:159], v[68:71]
    ds_read_b64_tr_b16 v[28:29], v179 offset:9472
    ds_read_b64_tr_b16 v[30:31], v179 offset:10624
    s_waitcnt lgkmcnt(8)
    v_mfma_f32_16x16x32_bf16 v[72:75], v[12:15], v[152:155], v[72:75]
    v_mfma_f32_16x16x32_bf16 v[76:79], v[12:15], v[156:159], v[76:79]
    ds_read_b64_tr_b16 v[8:9], v180 offset:0
    ds_read_b64_tr_b16 v[10:11], v180 offset:1152
    s_waitcnt lgkmcnt(8)
    v_mfma_f32_16x16x32_bf16 v[80:83], v[16:19], v[152:155], v[80:83]
    v_mfma_f32_16x16x32_bf16 v[84:87], v[16:19], v[156:159], v[84:87]
    ds_read_b64_tr_b16 v[12:13], v180 offset:32
    ds_read_b64_tr_b16 v[14:15], v180 offset:1184
    s_waitcnt lgkmcnt(8)
    v_mfma_f32_16x16x32_bf16 v[88:91], v[20:23], v[152:155], v[88:91]
    v_mfma_f32_16x16x32_bf16 v[92:95], v[20:23], v[156:159], v[92:95]
    ds_read_b64_tr_b16 v[16:17], v180 offset:64
    ds_read_b64_tr_b16 v[18:19], v180 offset:1216
    s_waitcnt lgkmcnt(8)
    v_mfma_f32_16x16x32_bf16 v[96:99], v[24:27], v[152:155], v[96:99]
    v_mfma_f32_16x16x32_bf16 v[100:103], v[24:27], v[156:159], v[100:103]
    ds_read_b64_tr_b16 v[20:21], v180 offset:96
    ds_read_b64_tr_b16 v[22:23], v180 offset:1248
    s_waitcnt lgkmcnt(8)
    v_mfma_f32_16x16x32_bf16 v[104:107], v[28:31], v[152:155], v[104:107]
    v_mfma_f32_16x16x32_bf16 v[108:111], v[28:31], v[156:159], v[108:111]
    s_waitcnt vmcnt(9)
    s_barrier
    s_mov_b32 s52, 32768
    buffer_load_dwordx4 v[144:147], v5, s[16:19], s52 offen offset:0
    buffer_load_dwordx4 v[148:151], v6, s[16:19], s52 offen offset:0
    buffer_load_dwordx4 v[152:155], v5, s[16:19], s52 offen offset:1024
    buffer_load_dwordx4 v[156:159], v6, s[16:19], s52 offen offset:1024
    ds_read_b64_tr_b16 v[24:25], v180 offset:128
    ds_read_b64_tr_b16 v[26:27], v180 offset:1280
    s_waitcnt lgkmcnt(8)
    v_mfma_f32_16x16x32_bf16 v[40:43], v[8:11], v[112:115], v[40:43]
    v_mfma_f32_16x16x32_bf16 v[44:47], v[8:11], v[116:119], v[44:47]
    ds_read_b64_tr_b16 v[28:29], v181 offset:160
    ds_read_b64_tr_b16 v[30:31], v181 offset:1312
    s_waitcnt lgkmcnt(8)
    v_mfma_f32_16x16x32_bf16 v[48:51], v[12:15], v[112:115], v[48:51]
    v_mfma_f32_16x16x32_bf16 v[52:55], v[12:15], v[116:119], v[52:55]
    ds_read_b64_tr_b16 v[8:9], v181 offset:192
    ds_read_b64_tr_b16 v[10:11], v181 offset:1344
    s_waitcnt lgkmcnt(8)
    v_mfma_f32_16x16x32_bf16 v[56:59], v[16:19], v[112:115], v[56:59]
    v_mfma_f32_16x16x32_bf16 v[60:63], v[16:19], v[116:119], v[60:63]
    ds_read_b64_tr_b16 v[12:13], v181 offset:224
    ds_read_b64_tr_b16 v[14:15], v181 offset:1376
    s_waitcnt lgkmcnt(8)
    v_mfma_f32_16x16x32_bf16 v[64:67], v[20:23], v[112:115], v[64:67]
    v_mfma_f32_16x16x32_bf16 v[68:71], v[20:23], v[116:119], v[68:71]
    ds_read_b64_tr_b16 v[16:17], v181 offset:256
    ds_read_b64_tr_b16 v[18:19], v181 offset:1408
    s_waitcnt lgkmcnt(8)
    v_mfma_f32_16x16x32_bf16 v[72:75], v[24:27], v[112:115], v[72:75]
    v_mfma_f32_16x16x32_bf16 v[76:79], v[24:27], v[116:119], v[76:79]
    ds_read_b64_tr_b16 v[20:21], v180 offset:9216
    ds_read_b64_tr_b16 v[22:23], v180 offset:10368
    s_waitcnt lgkmcnt(8)
    v_mfma_f32_16x16x32_bf16 v[80:83], v[28:31], v[112:115], v[80:83]
    v_mfma_f32_16x16x32_bf16 v[84:87], v[28:31], v[116:119], v[84:87]
    ds_read_b64_tr_b16 v[24:25], v180 offset:9248
    ds_read_b64_tr_b16 v[26:27], v180 offset:10400
    s_waitcnt lgkmcnt(8)
    v_mfma_f32_16x16x32_bf16 v[88:91], v[8:11], v[112:115], v[88:91]
    v_mfma_f32_16x16x32_bf16 v[92:95], v[8:11], v[116:119], v[92:95]
    ds_read_b64_tr_b16 v[28:29], v180 offset:9280
    ds_read_b64_tr_b16 v[30:31], v180 offset:10432
    s_waitcnt lgkmcnt(8)
    v_mfma_f32_16x16x32_bf16 v[96:99], v[12:15], v[112:115], v[96:99]
    v_mfma_f32_16x16x32_bf16 v[100:103], v[12:15], v[116:119], v[100:103]
    ds_read_b64_tr_b16 v[8:9], v180 offset:9312
    ds_read_b64_tr_b16 v[10:11], v180 offset:10464
    s_waitcnt lgkmcnt(8)
    v_mfma_f32_16x16x32_bf16 v[104:107], v[16:19], v[112:115], v[104:107]
    v_mfma_f32_16x16x32_bf16 v[108:111], v[16:19], v[116:119], v[108:111]
    ds_read_b64_tr_b16 v[12:13], v180 offset:9344
    ds_read_b64_tr_b16 v[14:15], v180 offset:10496
    s_waitcnt lgkmcnt(8)
    v_mfma_f32_16x16x32_bf16 v[40:43], v[20:23], v[120:123], v[40:43]
    v_mfma_f32_16x16x32_bf16 v[44:47], v[20:23], v[124:127], v[44:47]
    ds_read_b64_tr_b16 v[16:17], v181 offset:9376
    ds_read_b64_tr_b16 v[18:19], v181 offset:10528
    s_waitcnt lgkmcnt(8)
    v_mfma_f32_16x16x32_bf16 v[48:51], v[24:27], v[120:123], v[48:51]
    v_mfma_f32_16x16x32_bf16 v[52:55], v[24:27], v[124:127], v[52:55]
    ds_read_b64_tr_b16 v[20:21], v181 offset:9408
    ds_read_b64_tr_b16 v[22:23], v181 offset:10560
    s_waitcnt lgkmcnt(8)
    v_mfma_f32_16x16x32_bf16 v[56:59], v[28:31], v[120:123], v[56:59]
    v_mfma_f32_16x16x32_bf16 v[60:63], v[28:31], v[124:127], v[60:63]
    ds_read_b64_tr_b16 v[24:25], v181 offset:9440
    ds_read_b64_tr_b16 v[26:27], v181 offset:10592
    s_waitcnt lgkmcnt(8)
    v_mfma_f32_16x16x32_bf16 v[64:67], v[8:11], v[120:123], v[64:67]
    v_mfma_f32_16x16x32_bf16 v[68:71], v[8:11], v[124:127], v[68:71]
    ds_read_b64_tr_b16 v[28:29], v181 offset:9472
    ds_read_b64_tr_b16 v[30:31], v181 offset:10624
    s_waitcnt lgkmcnt(8)
    v_mfma_f32_16x16x32_bf16 v[72:75], v[12:15], v[120:123], v[72:75]
    v_mfma_f32_16x16x32_bf16 v[76:79], v[12:15], v[124:127], v[76:79]
    ds_read_b64_tr_b16 v[8:9], v182 offset:0
    ds_read_b64_tr_b16 v[10:11], v182 offset:1152
    s_waitcnt lgkmcnt(8)
    v_mfma_f32_16x16x32_bf16 v[80:83], v[16:19], v[120:123], v[80:83]
    v_mfma_f32_16x16x32_bf16 v[84:87], v[16:19], v[124:127], v[84:87]
    ds_read_b64_tr_b16 v[12:13], v182 offset:32
    ds_read_b64_tr_b16 v[14:15], v182 offset:1184
    s_waitcnt lgkmcnt(8)
    v_mfma_f32_16x16x32_bf16 v[88:91], v[20:23], v[120:123], v[88:91]
    v_mfma_f32_16x16x32_bf16 v[92:95], v[20:23], v[124:127], v[92:95]
    ds_read_b64_tr_b16 v[16:17], v182 offset:64
    ds_read_b64_tr_b16 v[18:19], v182 offset:1216
    s_waitcnt lgkmcnt(8)
    v_mfma_f32_16x16x32_bf16 v[96:99], v[24:27], v[120:123], v[96:99]
    v_mfma_f32_16x16x32_bf16 v[100:103], v[24:27], v[124:127], v[100:103]
    ds_read_b64_tr_b16 v[20:21], v182 offset:96
    ds_read_b64_tr_b16 v[22:23], v182 offset:1248
    s_waitcnt lgkmcnt(8)
    v_mfma_f32_16x16x32_bf16 v[104:107], v[28:31], v[120:123], v[104:107]
    v_mfma_f32_16x16x32_bf16 v[108:111], v[28:31], v[124:127], v[108:111]
    s_waitcnt vmcnt(4)
    s_barrier
    ds_read_b64_tr_b16 v[24:25], v182 offset:128
    ds_read_b64_tr_b16 v[26:27], v182 offset:1280
    s_waitcnt lgkmcnt(8)
    v_mfma_f32_16x16x32_bf16 v[40:43], v[8:11], v[128:131], v[40:43]
    v_mfma_f32_16x16x32_bf16 v[44:47], v[8:11], v[132:135], v[44:47]
    ds_read_b64_tr_b16 v[28:29], v183 offset:160
    ds_read_b64_tr_b16 v[30:31], v183 offset:1312
    s_waitcnt lgkmcnt(8)
    v_mfma_f32_16x16x32_bf16 v[48:51], v[12:15], v[128:131], v[48:51]
    v_mfma_f32_16x16x32_bf16 v[52:55], v[12:15], v[132:135], v[52:55]
    ds_read_b64_tr_b16 v[8:9], v183 offset:192
    ds_read_b64_tr_b16 v[10:11], v183 offset:1344
    s_waitcnt lgkmcnt(8)
    v_mfma_f32_16x16x32_bf16 v[56:59], v[16:19], v[128:131], v[56:59]
    v_mfma_f32_16x16x32_bf16 v[60:63], v[16:19], v[132:135], v[60:63]
    ds_read_b64_tr_b16 v[12:13], v183 offset:224
    ds_read_b64_tr_b16 v[14:15], v183 offset:1376
    s_waitcnt lgkmcnt(8)
    v_mfma_f32_16x16x32_bf16 v[64:67], v[20:23], v[128:131], v[64:67]
    v_mfma_f32_16x16x32_bf16 v[68:71], v[20:23], v[132:135], v[68:71]
    ds_read_b64_tr_b16 v[16:17], v183 offset:256
    ds_read_b64_tr_b16 v[18:19], v183 offset:1408
    s_waitcnt lgkmcnt(8)
    v_mfma_f32_16x16x32_bf16 v[72:75], v[24:27], v[128:131], v[72:75]
    v_mfma_f32_16x16x32_bf16 v[76:79], v[24:27], v[132:135], v[76:79]
    ds_read_b64_tr_b16 v[20:21], v182 offset:9216
    ds_read_b64_tr_b16 v[22:23], v182 offset:10368
    s_waitcnt lgkmcnt(8)
    v_mfma_f32_16x16x32_bf16 v[80:83], v[28:31], v[128:131], v[80:83]
    v_mfma_f32_16x16x32_bf16 v[84:87], v[28:31], v[132:135], v[84:87]
    ds_read_b64_tr_b16 v[24:25], v182 offset:9248
    ds_read_b64_tr_b16 v[26:27], v182 offset:10400
    s_waitcnt lgkmcnt(8)
    v_mfma_f32_16x16x32_bf16 v[88:91], v[8:11], v[128:131], v[88:91]
    v_mfma_f32_16x16x32_bf16 v[92:95], v[8:11], v[132:135], v[92:95]
    ds_read_b64_tr_b16 v[28:29], v182 offset:9280
    ds_read_b64_tr_b16 v[30:31], v182 offset:10432
    s_waitcnt lgkmcnt(8)
    v_mfma_f32_16x16x32_bf16 v[96:99], v[12:15], v[128:131], v[96:99]
    v_mfma_f32_16x16x32_bf16 v[100:103], v[12:15], v[132:135], v[100:103]
    ds_read_b64_tr_b16 v[8:9], v182 offset:9312
    ds_read_b64_tr_b16 v[10:11], v182 offset:10464
    s_waitcnt lgkmcnt(8)
    v_mfma_f32_16x16x32_bf16 v[104:107], v[16:19], v[128:131], v[104:107]
    v_mfma_f32_16x16x32_bf16 v[108:111], v[16:19], v[132:135], v[108:111]
    ds_read_b64_tr_b16 v[12:13], v182 offset:9344
    ds_read_b64_tr_b16 v[14:15], v182 offset:10496
    s_waitcnt lgkmcnt(8)
    v_mfma_f32_16x16x32_bf16 v[40:43], v[20:23], v[136:139], v[40:43]
    v_mfma_f32_16x16x32_bf16 v[44:47], v[20:23], v[140:143], v[44:47]
    ds_read_b64_tr_b16 v[16:17], v183 offset:9376
    ds_read_b64_tr_b16 v[18:19], v183 offset:10528
    s_waitcnt lgkmcnt(8)
    v_mfma_f32_16x16x32_bf16 v[48:51], v[24:27], v[136:139], v[48:51]
    v_mfma_f32_16x16x32_bf16 v[52:55], v[24:27], v[140:143], v[52:55]
    ds_read_b64_tr_b16 v[20:21], v183 offset:9408
    ds_read_b64_tr_b16 v[22:23], v183 offset:10560
    s_waitcnt lgkmcnt(8)
    v_mfma_f32_16x16x32_bf16 v[56:59], v[28:31], v[136:139], v[56:59]
    v_mfma_f32_16x16x32_bf16 v[60:63], v[28:31], v[140:143], v[60:63]
    ds_read_b64_tr_b16 v[24:25], v183 offset:9440
    ds_read_b64_tr_b16 v[26:27], v183 offset:10592
    s_waitcnt lgkmcnt(8)
    v_mfma_f32_16x16x32_bf16 v[64:67], v[8:11], v[136:139], v[64:67]
    v_mfma_f32_16x16x32_bf16 v[68:71], v[8:11], v[140:143], v[68:71]
    ds_read_b64_tr_b16 v[28:29], v183 offset:9472
    ds_read_b64_tr_b16 v[30:31], v183 offset:10624
    s_waitcnt lgkmcnt(8)
    v_mfma_f32_16x16x32_bf16 v[72:75], v[12:15], v[136:139], v[72:75]
    v_mfma_f32_16x16x32_bf16 v[76:79], v[12:15], v[140:143], v[76:79]
    ds_read_b64_tr_b16 v[8:9], v176 offset:0
    ds_read_b64_tr_b16 v[10:11], v176 offset:1152
    s_waitcnt lgkmcnt(8)
    v_mfma_f32_16x16x32_bf16 v[80:83], v[16:19], v[136:139], v[80:83]
    v_mfma_f32_16x16x32_bf16 v[84:87], v[16:19], v[140:143], v[84:87]
    ds_read_b64_tr_b16 v[12:13], v176 offset:32
    ds_read_b64_tr_b16 v[14:15], v176 offset:1184
    s_waitcnt lgkmcnt(8)
    v_mfma_f32_16x16x32_bf16 v[88:91], v[20:23], v[136:139], v[88:91]
    v_mfma_f32_16x16x32_bf16 v[92:95], v[20:23], v[140:143], v[92:95]
    ds_read_b64_tr_b16 v[16:17], v176 offset:64
    ds_read_b64_tr_b16 v[18:19], v176 offset:1216
    s_waitcnt lgkmcnt(8)
    v_mfma_f32_16x16x32_bf16 v[96:99], v[24:27], v[136:139], v[96:99]
    v_mfma_f32_16x16x32_bf16 v[100:103], v[24:27], v[140:143], v[100:103]
    ds_read_b64_tr_b16 v[20:21], v176 offset:96
    ds_read_b64_tr_b16 v[22:23], v176 offset:1248
    s_waitcnt lgkmcnt(8)
    v_mfma_f32_16x16x32_bf16 v[104:107], v[28:31], v[136:139], v[104:107]
    v_mfma_f32_16x16x32_bf16 v[108:111], v[28:31], v[140:143], v[108:111]
    s_waitcnt vmcnt(0)
    s_barrier
    ds_read_b64_tr_b16 v[24:25], v176 offset:128
    ds_read_b64_tr_b16 v[26:27], v176 offset:1280
    s_waitcnt lgkmcnt(8)
    v_mfma_f32_16x16x32_bf16 v[40:43], v[8:11], v[144:147], v[40:43]
    v_mfma_f32_16x16x32_bf16 v[44:47], v[8:11], v[148:151], v[44:47]
    ds_read_b64_tr_b16 v[28:29], v177 offset:160
    ds_read_b64_tr_b16 v[30:31], v177 offset:1312
    s_waitcnt lgkmcnt(8)
    v_mfma_f32_16x16x32_bf16 v[48:51], v[12:15], v[144:147], v[48:51]
    v_mfma_f32_16x16x32_bf16 v[52:55], v[12:15], v[148:151], v[52:55]
    ds_read_b64_tr_b16 v[8:9], v177 offset:192
    ds_read_b64_tr_b16 v[10:11], v177 offset:1344
    s_waitcnt lgkmcnt(8)
    v_mfma_f32_16x16x32_bf16 v[56:59], v[16:19], v[144:147], v[56:59]
    v_mfma_f32_16x16x32_bf16 v[60:63], v[16:19], v[148:151], v[60:63]
    ds_read_b64_tr_b16 v[12:13], v177 offset:224
    ds_read_b64_tr_b16 v[14:15], v177 offset:1376
    s_waitcnt lgkmcnt(8)
    v_mfma_f32_16x16x32_bf16 v[64:67], v[20:23], v[144:147], v[64:67]
    v_mfma_f32_16x16x32_bf16 v[68:71], v[20:23], v[148:151], v[68:71]
    ds_read_b64_tr_b16 v[16:17], v177 offset:256
    ds_read_b64_tr_b16 v[18:19], v177 offset:1408
    s_waitcnt lgkmcnt(8)
    v_mfma_f32_16x16x32_bf16 v[72:75], v[24:27], v[144:147], v[72:75]
    v_mfma_f32_16x16x32_bf16 v[76:79], v[24:27], v[148:151], v[76:79]
    ds_read_b64_tr_b16 v[20:21], v176 offset:9216
    ds_read_b64_tr_b16 v[22:23], v176 offset:10368
    s_waitcnt lgkmcnt(8)
    v_mfma_f32_16x16x32_bf16 v[80:83], v[28:31], v[144:147], v[80:83]
    v_mfma_f32_16x16x32_bf16 v[84:87], v[28:31], v[148:151], v[84:87]
    ds_read_b64_tr_b16 v[24:25], v176 offset:9248
    ds_read_b64_tr_b16 v[26:27], v176 offset:10400
    s_waitcnt lgkmcnt(8)
    v_mfma_f32_16x16x32_bf16 v[88:91], v[8:11], v[144:147], v[88:91]
    v_mfma_f32_16x16x32_bf16 v[92:95], v[8:11], v[148:151], v[92:95]
    ds_read_b64_tr_b16 v[28:29], v176 offset:9280
    ds_read_b64_tr_b16 v[30:31], v176 offset:10432
    s_waitcnt lgkmcnt(8)
    v_mfma_f32_16x16x32_bf16 v[96:99], v[12:15], v[144:147], v[96:99]
    v_mfma_f32_16x16x32_bf16 v[100:103], v[12:15], v[148:151], v[100:103]
    ds_read_b64_tr_b16 v[8:9], v176 offset:9312
    ds_read_b64_tr_b16 v[10:11], v176 offset:10464
    s_waitcnt lgkmcnt(8)
    v_mfma_f32_16x16x32_bf16 v[104:107], v[16:19], v[144:147], v[104:107]
    v_mfma_f32_16x16x32_bf16 v[108:111], v[16:19], v[148:151], v[108:111]
    ds_read_b64_tr_b16 v[12:13], v176 offset:9344
    ds_read_b64_tr_b16 v[14:15], v176 offset:10496
    s_waitcnt lgkmcnt(8)
    v_mfma_f32_16x16x32_bf16 v[40:43], v[20:23], v[152:155], v[40:43]
    v_mfma_f32_16x16x32_bf16 v[44:47], v[20:23], v[156:159], v[44:47]
    ds_read_b64_tr_b16 v[16:17], v177 offset:9376
    ds_read_b64_tr_b16 v[18:19], v177 offset:10528
    s_waitcnt lgkmcnt(8)
    v_mfma_f32_16x16x32_bf16 v[48:51], v[24:27], v[152:155], v[48:51]
    v_mfma_f32_16x16x32_bf16 v[52:55], v[24:27], v[156:159], v[52:55]
    ds_read_b64_tr_b16 v[20:21], v177 offset:9408
    ds_read_b64_tr_b16 v[22:23], v177 offset:10560
    s_waitcnt lgkmcnt(8)
    v_mfma_f32_16x16x32_bf16 v[56:59], v[28:31], v[152:155], v[56:59]
    v_mfma_f32_16x16x32_bf16 v[60:63], v[28:31], v[156:159], v[60:63]
    ds_read_b64_tr_b16 v[24:25], v177 offset:9440
    ds_read_b64_tr_b16 v[26:27], v177 offset:10592
    s_waitcnt lgkmcnt(8)
    v_mfma_f32_16x16x32_bf16 v[64:67], v[8:11], v[152:155], v[64:67]
    v_mfma_f32_16x16x32_bf16 v[68:71], v[8:11], v[156:159], v[68:71]
    ds_read_b64_tr_b16 v[28:29], v177 offset:9472
    ds_read_b64_tr_b16 v[30:31], v177 offset:10624
    s_waitcnt lgkmcnt(8)
    v_mfma_f32_16x16x32_bf16 v[72:75], v[12:15], v[152:155], v[72:75]
    v_mfma_f32_16x16x32_bf16 v[76:79], v[12:15], v[156:159], v[76:79]
    s_waitcnt lgkmcnt(6)
    v_mfma_f32_16x16x32_bf16 v[80:83], v[16:19], v[152:155], v[80:83]
    v_mfma_f32_16x16x32_bf16 v[84:87], v[16:19], v[156:159], v[84:87]
    s_waitcnt lgkmcnt(4)
    v_mfma_f32_16x16x32_bf16 v[88:91], v[20:23], v[152:155], v[88:91]
    v_mfma_f32_16x16x32_bf16 v[92:95], v[20:23], v[156:159], v[92:95]
    s_waitcnt lgkmcnt(2)
    v_mfma_f32_16x16x32_bf16 v[96:99], v[24:27], v[152:155], v[96:99]
    v_mfma_f32_16x16x32_bf16 v[100:103], v[24:27], v[156:159], v[100:103]
    s_waitcnt lgkmcnt(0)
    v_mfma_f32_16x16x32_bf16 v[104:107], v[28:31], v[152:155], v[104:107]
    v_mfma_f32_16x16x32_bf16 v[108:111], v[28:31], v[156:159], v[108:111]
    s_nop 9
    s_barrier
    s_lshl_b32 s46, s43, 5
    v_add_u32 v8, s46, v3
    v_mul_u32_u24 v8, 592, v8
    v_lshl_add_u32 v8, v4, 4, v8
    s_mul_i32 s46, s44, 75776
    v_add_u32 v8, s46, v8
    ds_write_b128 v8, v[40:43] offset:0
    ds_write_b128 v8, v[44:47] offset:9472
    ds_write_b128 v8, v[48:51] offset:64
    ds_write_b128 v8, v[52:55] offset:9536
    ds_write_b128 v8, v[56:59] offset:128
    ds_write_b128 v8, v[60:63] offset:9600
    ds_write_b128 v8, v[64:67] offset:192
    ds_write_b128 v8, v[68:71] offset:9664
    ds_write_b128 v8, v[72:75] offset:256
    ds_write_b128 v8, v[76:79] offset:9728
    ds_write_b128 v8, v[80:83] offset:320
    ds_write_b128 v8, v[84:87] offset:9792
    ds_write_b128 v8, v[88:91] offset:384
    ds_write_b128 v8, v[92:95] offset:9856
    ds_write_b128 v8, v[96:99] offset:448
    ds_write_b128 v8, v[100:103] offset:9920
    ds_write_b128 v8, v[104:107] offset:512
    ds_write_b128 v8, v[108:111] offset:9984
    s_mov_b32 s45, 119304648
    s_mul_i32 s46, s41, 4718592
    s_mul_i32 s47, s42, 576
    s_add_u32 s46, s46, s47
    s_mul_i32 s47, s40, 128*2304
    s_add_u32 s46, s46, s47
    v_add_u32 v9, 0, v0
    v_mul_hi_u32 v10, v9, s45
    v_mul_u32_u24 v11, 36, v10
    v_sub_u32 v11, v9, v11
    v_mul_u32_u24 v12, 592, v10
    v_lshl_add_u32 v20, v11, 4, v12
    v_mul_u32_u24 v12, 2304, v10
    v_lshl_add_u32 v30, v11, 4, v12
    v_add_u32 v9, 512, v0
    v_mul_hi_u32 v10, v9, s45
    v_mul_u32_u24 v11, 36, v10
    v_sub_u32 v11, v9, v11
    v_mul_u32_u24 v12, 592, v10
    v_lshl_add_u32 v21, v11, 4, v12
    v_mul_u32_u24 v12, 2304, v10
    v_lshl_add_u32 v31, v11, 4, v12
    v_add_u32 v9, 1024, v0
    v_mul_hi_u32 v10, v9, s45
    v_mul_u32_u24 v11, 36, v10
    v_sub_u32 v11, v9, v11
    v_mul_u32_u24 v12, 592, v10
    v_lshl_add_u32 v22, v11, 4, v12
    v_mul_u32_u24 v12, 2304, v10
    v_lshl_add_u32 v32, v11, 4, v12
    v_add_u32 v9, 1536, v0
    v_mul_hi_u32 v10, v9, s45
    v_mul_u32_u24 v11, 36, v10
    v_sub_u32 v11, v9, v11
    v_mul_u32_u24 v12, 592, v10
    v_lshl_add_u32 v23, v11, 4, v12
    v_mul_u32_u24 v12, 2304, v10
    v_lshl_add_u32 v33, v11, 4, v12
    v_add_u32 v9, 2048, v0
    v_mul_hi_u32 v10, v9, s45
    v_mul_u32_u24 v11, 36, v10
    v_sub_u32 v11, v9, v11
    v_mul_u32_u24 v12, 592, v10
    v_lshl_add_u32 v24, v11, 4, v12
    v_mul_u32_u24 v12, 2304, v10
    v_lshl_add_u32 v34, v11, 4, v12
    v_add_u32 v9, 2560, v0
    v_mul_hi_u32 v10, v9, s45
    v_mul_u32_u24 v11, 36, v10
    v_sub_u32 v11, v9, v11
    v_mul_u32_u24 v12, 592, v10
    v_lshl_add_u32 v25, v11, 4, v12
    v_mul_u32_u24 v12, 2304, v10
    v_lshl_add_u32 v35, v11, 4, v12
    v_add_u32 v9, 3072, v0
    v_mul_hi_u32 v10, v9, s45
    v_mul_u32_u24 v11, 36, v10
    v_sub_u32 v11, v9, v11
    v_mul_u32_u24 v12, 592, v10
    v_lshl_add_u32 v26, v11, 4, v12
    v_mul_u32_u24 v12, 2304, v10
    v_lshl_add_u32 v36, v11, 4, v12
    v_add_u32 v9, 3584, v0
    v_mul_hi_u32 v10, v9, s45
    v_mul_u32_u24 v11, 36, v10
    v_sub_u32 v11, v9, v11
    v_mul_u32_u24 v12, 592, v10
    v_lshl_add_u32 v27, v11, 4, v12
    v_mul_u32_u24 v12, 2304, v10
    v_lshl_add_u32 v37, v11, 4, v12
    v_add_u32 v9, 4096, v0
    v_mul_hi_u32 v10, v9, s45
    v_mul_u32_u24 v11, 36, v10
    v_sub_u32 v11, v9, v11
    v_mul_u32_u24 v12, 592, v10
    v_lshl_add_u32 v28, v11, 4, v12
    v_mul_u32_u24 v12, 2304, v10
    v_lshl_add_u32 v38, v11, 4, v12
    s_waitcnt lgkmcnt(0)
    s_barrier
    v_mov_b32 v9, 75776
    ds_read_b128 v[40:43], v20
    v_add_u32 v20, v9, v20
    ds_read_b128 v[44:47], v20
    ds_read_b128 v[48:51], v21
    v_add_u32 v21, v9, v21
    ds_read_b128 v[52:55], v21
    ds_read_b128 v[56:59], v22
    v_add_u32 v22, v9, v22
    ds_read_b128 v[60:63], v22
    ds_read_b128 v[64:67], v23
    v_add_u32 v23, v9, v23
    ds_read_b128 v[68:71], v23
    ds_read_b128 v[72:75], v24
    v_add_u32 v24, v9, v24
    ds_read_b128 v[76:79], v24
    ds_read_b128 v[80:83], v25
    v_add_u32 v25, v9, v25
    ds_read_b128 v[84:87], v25
    ds_read_b128 v[88:91], v26
    v_add_u32 v26, v9, v26
    ds_read_b128 v[92:95], v26
    ds_read_b128 v[96:99], v27
    v_add_u32 v27, v9, v27
    ds_read_b128 v[100:103], v27
    ds_read_b128 v[104:107], v28
    v_add_u32 v28, v9, v28
    ds_read_b128 v[108:111], v28
    s_waitcnt lgkmcnt(15)
    v_add_f32 v40, v40, v44
    v_add_f32 v41, v41, v45
    v_add_f32 v42, v42, v46
    v_add_f32 v43, v43, v47
    buffer_store_dwordx4 v[40:43], v30, s[20:23], s46 offen
    s_waitcnt lgkmcnt(14)
    v_add_f32 v48, v48, v52
    v_add_f32 v49, v49, v53
    v_add_f32 v50, v50, v54
    v_add_f32 v51, v51, v55
    buffer_store_dwordx4 v[48:51], v31, s[20:23], s46 offen
    s_waitcnt lgkmcnt(12)
    v_add_f32 v56, v56, v60
    v_add_f32 v57, v57, v61
    v_add_f32 v58, v58, v62
    v_add_f32 v59, v59, v63
    buffer_store_dwordx4 v[56:59], v32, s[20:23], s46 offen
    s_waitcnt lgkmcnt(10)
    v_add_f32 v64, v64, v68
    v_add_f32 v65, v65, v69
    v_add_f32 v66, v66, v70
    v_add_f32 v67, v67, v71
    buffer_store_dwordx4 v[64:67], v33, s[20:23], s46 offen
    s_waitcnt lgkmcnt(8)
    v_add_f32 v72, v72, v76
    v_add_f32 v73, v73, v77
    v_add_f32 v74, v74, v78
    v_add_f32 v75, v75, v79
    buffer_store_dwordx4 v[72:75], v34, s[20:23], s46 offen
    s_waitcnt lgkmcnt(6)
    v_add_f32 v80, v80, v84
    v_add_f32 v81, v81, v85
    v_add_f32 v82, v82, v86
    v_add_f32 v83, v83, v87
    buffer_store_dwordx4 v[80:83], v35, s[20:23], s46 offen
    s_waitcnt lgkmcnt(4)
    v_add_f32 v88, v88, v92
    v_add_f32 v89, v89, v93
    v_add_f32 v90, v90, v94
    v_add_f32 v91, v91, v95
    buffer_store_dwordx4 v[88:91], v36, s[20:23], s46 offen
    s_waitcnt lgkmcnt(2)
    v_add_f32 v96, v96, v100
    v_add_f32 v97, v97, v101
    v_add_f32 v98, v98, v102
    v_add_f32 v99, v99, v103
    buffer_store_dwordx4 v[96:99], v37, s[20:23], s46 offen
    s_waitcnt lgkmcnt(0)
    v_add_f32 v104, v104, v108
    v_add_f32 v105, v105, v109
    v_add_f32 v106, v106, v110
    v_add_f32 v107, v107, v111
    buffer_store_dwordx4 v[104:107], v38, s[20:23], s46 offen
K4_END:
    s_endpgm
.globl k5_kernel
.p2align 8
.type k5_kernel,@function
k5_kernel:
    s_cmp_ge_u32 s2, 1152
    s_cbranch_scc1 K5_END
    s_load_dwordx2 s[4:5], s[0:1], 96
    s_load_dwordx2 s[6:7], s[0:1], 80
    s_waitcnt lgkmcnt(0)
    s_add_u32 s8, s4, 31326208
    s_addc_u32 s9, s5, 0
    s_and_b32 s9, s9, 0xffff
    s_mov_b32 s10, 18874368
    s_mov_b32 s11, 0x00020000
    s_add_u32 s12, s4, 7733248
    s_addc_u32 s13, s5, 0
    s_and_b32 s13, s13, 0xffff
    s_mov_b32 s14, 2359296
    s_mov_b32 s15, 0x00020000
    s_add_u32 s16, s4, 0
    s_addc_u32 s17, s5, 0
    s_and_b32 s17, s17, 0xffff
    s_mov_b32 s18, 13824
    s_mov_b32 s19, 0x00020000
    s_mov_b32 s20, s6
    s_and_b32 s21, s7, 0xffff
    s_mov_b32 s22, 2359296
    s_mov_b32 s23, 0x00020000
    s_lshl_b32 s24, s2, 8
    v_add_u32 v1, s24, v0
    v_lshlrev_b32 v2, 4, v1
    v_lshlrev_b32 v3, 3, v1
    s_mov_b32 s25, 0
    buffer_load_dwordx4 v[8:11], v2, s[8:11], s25 offen
    s_mov_b32 s25, 4718592
    buffer_load_dwordx4 v[12:15], v2, s[8:11], s25 offen
    s_mov_b32 s25, 9437184
    buffer_load_dwordx4 v[16:19], v2, s[8:11], s25 offen
    s_mov_b32 s25, 14155776
    buffer_load_dwordx4 v[20:23], v2, s[8:11], s25 offen
    buffer_load_dwordx2 v[24:25], v3, s[12:15], 0 offen
    s_mov_b32 s26, 29826162
    v_mul_hi_u32 v4, v1, s26
    v_mul_u32_u24 v4, 144, v4
    v_sub_u32 v4, v1, v4
    v_lshlrev_b32 v4, 4, v4
    s_mov_b32 s25, 11520
    buffer_load_dwordx4 v[28:31], v4, s[16:19], s25 offen
    s_waitcnt vmcnt(0)
    v_add_f32 v8, v8, v12
    v_add_f32 v16, v16, v20
    v_add_f32 v8, v8, v16
    v_add_f32 v9, v9, v13
    v_add_f32 v17, v17, v21
    v_add_f32 v9, v9, v17
    v_add_f32 v10, v10, v14
    v_add_f32 v18, v18, v22
    v_add_f32 v10, v10, v18
    v_add_f32 v11, v11, v15
    v_add_f32 v19, v19, v23
    v_add_f32 v11, v11, v19
    v_cvt_pk_bf16_f32 v12, v8, v9
    v_cvt_pk_bf16_f32 v13, v10, v11
    v_lshlrev_b32 v8, 16, v12
    v_and_b32 v9, 0xffff0000, v12
    v_lshlrev_b32 v10, 16, v13
    v_and_b32 v11, 0xffff0000, v13
    v_mul_f32 v8, v8, v28
    v_mul_f32 v9, v9, v29
    v_mul_f32 v10, v10, v30
    v_mul_f32 v11, v11, v31
    v_cvt_pk_bf16_f32 v12, v8, v9
    v_cvt_pk_bf16_f32 v13, v10, v11
    v_lshlrev_b32 v8, 16, v12
    v_and_b32 v9, 0xffff0000, v12
    v_lshlrev_b32 v10, 16, v13
    v_and_b32 v11, 0xffff0000, v13
    v_lshlrev_b32 v16, 16, v24
    v_and_b32 v17, 0xffff0000, v24
    v_lshlrev_b32 v18, 16, v25
    v_and_b32 v19, 0xffff0000, v25
    v_add_f32 v8, v8, v16
    v_add_f32 v9, v9, v17
    v_add_f32 v10, v10, v18
    v_add_f32 v11, v11, v19
    v_cvt_pk_bf16_f32 v12, v8, v9
    v_cvt_pk_bf16_f32 v13, v10, v11
    buffer_store_dwordx2 v[12:13], v3, s[20:23], 0 offen
K5_END:
    s_endpgm
.section .rodata,"a"
.p2align 6
.amdhsa_kernel k0_kernel
  .amdhsa_next_free_vgpr 128
  .amdhsa_next_free_sgpr 48
  .amdhsa_accum_offset 128
  .amdhsa_group_segment_fixed_size 0
  .amdhsa_kernarg_size 104
  .amdhsa_user_sgpr_count 2
  .amdhsa_user_sgpr_kernarg_segment_ptr 1
  .amdhsa_system_sgpr_workgroup_id_x 1
  .amdhsa_float_denorm_mode_32 3
.end_amdhsa_kernel
.p2align 6
.amdhsa_kernel k1_kernel
  .amdhsa_next_free_vgpr 256
  .amdhsa_next_free_sgpr 64
  .amdhsa_accum_offset 256
  .amdhsa_group_segment_fixed_size 0
  .amdhsa_kernarg_size 104
  .amdhsa_user_sgpr_count 2
  .amdhsa_user_sgpr_kernarg_segment_ptr 1
  .amdhsa_system_sgpr_workgroup_id_x 1
  .amdhsa_float_denorm_mode_32 3
.end_amdhsa_kernel
.p2align 6
.amdhsa_kernel k2_kernel
  .amdhsa_next_free_vgpr 256
  .amdhsa_next_free_sgpr 64
  .amdhsa_accum_offset 256
  .amdhsa_group_segment_fixed_size 0
  .amdhsa_kernarg_size 104
  .amdhsa_user_sgpr_count 2
  .amdhsa_user_sgpr_kernarg_segment_ptr 1
  .amdhsa_system_sgpr_workgroup_id_x 1
  .amdhsa_float_denorm_mode_32 3
.end_amdhsa_kernel
.p2align 6
.amdhsa_kernel k3_kernel
  .amdhsa_next_free_vgpr 256
  .amdhsa_next_free_sgpr 96
  .amdhsa_accum_offset 256
  .amdhsa_group_segment_fixed_size 0
  .amdhsa_kernarg_size 104
  .amdhsa_user_sgpr_count 2
  .amdhsa_user_sgpr_kernarg_segment_ptr 1
  .amdhsa_system_sgpr_workgroup_id_x 1
  .amdhsa_float_denorm_mode_32 3
.end_amdhsa_kernel
.p2align 6
.amdhsa_kernel k4_kernel
  .amdhsa_next_free_vgpr 192
  .amdhsa_next_free_sgpr 64
  .amdhsa_accum_offset 192
  .amdhsa_group_segment_fixed_size 0
  .amdhsa_kernarg_size 104
  .amdhsa_user_sgpr_count 2
  .amdhsa_user_sgpr_kernarg_segment_ptr 1
  .amdhsa_system_sgpr_workgroup_id_x 1
  .amdhsa_float_denorm_mode_32 3
.end_amdhsa_kernel
.p2align 6
.amdhsa_kernel k5_kernel
  .amdhsa_next_free_vgpr 32
  .amdhsa_next_free_sgpr 32
  .amdhsa_accum_offset 32
  .amdhsa_group_segment_fixed_size 0
  .amdhsa_kernarg_size 104
  .amdhsa_user_sgpr_count 2
  .amdhsa_user_sgpr_kernarg_segment_ptr 1
  .amdhsa_system_sgpr_workgroup_id_x 1
  .amdhsa_float_denorm_mode_32 3
.end_amdhsa_kernel
```
